```python
import torch

def _softmax(x, axis=-1):
    return torch.softmax(x, dim=axis)
def _gelu(x):
    return torch.nn.functional.gelu(x, approximate="tanh")
def _silu(x):
    return torch.nn.functional.silu(x)
def _sigmoid(x):
    return torch.sigmoid(x)
def _layernorm(x, axis=-1, eps=1e-5):
    m = x.mean(dim=axis, keepdim=True)
    v = x.var(dim=axis, keepdim=True, unbiased=False)
    return (x - m) / torch.sqrt(v + eps)
def _scatter_add(tgt, idx, src, axis=0):
    return tgt.clone().index_add_(axis, idx, src)
def _segment_sum(src, seg, n):
    out = torch.zeros((n,) + src.shape[1:], dtype=src.dtype)
    return out.index_add_(0, seg, src)
def _pad(x, pw):
    flat = tuple(v for pair in reversed(pw) for v in pair)
    return torch.nn.functional.pad(x, flat)

kernel_name = 'recurrent_scan__mha_block_cached__glu_gated_reglu__prompt'

def setup_inputs():

    _w = (lambda a: (lambda t: t.to(torch.bfloat16) if t.is_floating_point() else t)(torch.as_tensor(a)))
    def _A_setup():
        B, Sq, D = 1, 2048, 1024
        H, Sk, Dh = 32, 2048, 128
        return {
            "x": _w((lambda *s: torch.randn(*s, dtype=torch.bfloat16) * 0.05)(B, Sq, D)),
            "k_cache": _w((lambda *s: torch.randn(*s, dtype=torch.bfloat16) * 1.6)(B, H, Sk, Dh)),
            "v_cache": _w((lambda *s: torch.randn(*s, dtype=torch.bfloat16) * 1.6)(B, H, Sk, Dh)),
            "wq": _w((lambda *s: torch.randn(*s, dtype=torch.bfloat16) * 1.6)(D, H * Dh) * (D ** -0.5)),
            "wo": _w((lambda *s: torch.randn(*s, dtype=torch.bfloat16) * 1.6)(H * Dh, D) * ((H * Dh) ** -0.5)),
        }
    _A_in = _A_setup()

    def _B_setup():
        B, S, D, F = 1, 2048, 1024, 3584
        return {
            "x": _w((lambda *s: torch.randn(*s, dtype=torch.bfloat16) * 0.05)(B, S, D)),
            "W_gate": _w((lambda *s: torch.randn(*s, dtype=torch.bfloat16) * 0.2)(D, F) * (2.0 / D) ** 0.5),
            "W_up": _w((lambda *s: torch.randn(*s, dtype=torch.bfloat16) * 0.2)(D, F) * (2.0 / D) ** 0.5),
            "W_down": _w((lambda *s: torch.randn(*s, dtype=torch.bfloat16) * 0.2)(F, D) * (1.0 / F) ** 0.5),
        }
    _B_in = _B_setup()

    return {
        "A_x": _A_in["x"],
        "A_k_cache": _A_in["k_cache"],
        "A_v_cache": _A_in["v_cache"],
        "A_wq": _A_in["wq"],
        "A_wo": _A_in["wo"],
        "B_x": _B_in["x"],
        "B_W_gate": _B_in["W_gate"],
        "B_W_up": _B_in["W_up"],
        "B_W_down": _B_in["W_down"],
    }

def reference(A_x, A_k_cache, A_v_cache, A_wq, A_wo, B_x, B_W_gate, B_W_up, B_W_down):
    def _A_ref(x, k_cache, v_cache, wq, wo):
        B, Sq, D = x.shape
        H, Dh = 32, 128
        q = (lambda x, *d: x.permute(*d))((x @ wq).reshape(B, Sq, H, Dh), 0, 2, 1, 3)
        scores = torch.einsum("bhqd,bhkd->bhqk", q, k_cache) * (Dh ** -0.5)
        p = _softmax(scores, axis=-1)
        o = torch.einsum("bhqk,bhkd->bhqd", p, v_cache)
        return (lambda x, *d: x.permute(*d))(o, 0, 2, 1, 3).reshape(B, Sq, H * Dh) @ wo

    def _B_ref(x, W_gate, W_up, W_down):
        gate = torch.einsum("bsd,df->bsf", x, W_gate)
        up = torch.einsum("bsd,df->bsf", x, W_up)
        gate = gate * (lambda x, dt: x.to(dt))(gate > 0, gate.dtype)
        h = gate * up
        return torch.einsum("bsf,fd->bsd", h, W_down)

    x = A_x
    xn = _layernorm(x, axis=-1)
    s = _A_ref(xn, A_k_cache, A_v_cache, A_wq, A_wo)
    g = _silu(_B_ref(xn, B_W_gate, B_W_up, B_W_down))
    return x + s * g
```

```asm
; @launch kernel=ln_kernel grid=(256,1,1) block=(256,1,1) lds=0
; @launch kernel=fused_kernel grid=(256,1,1) block=(256,1,1) lds=155648
; @launch kernel=gemm2_kernel grid=(256,1,1) block=(256,1,1) lds=131072
; @launch kernel=final_kernel grid=(1024,1,1) block=(256,1,1) lds=0
.amdgcn_target "amdgcn-amd-amdhsa--gfx950"
.text
.globl ln_kernel
.p2align 8
.type ln_kernel,@function
ln_kernel:
    s_cmp_ge_u32 s2, 256
    s_cbranch_scc1 ln_done
    s_load_dwordx2 s[4:5], s[0:1], 0
    s_load_dwordx2 s[6:7], s[0:1], 88
    s_load_dwordx2 s[24:25], s[0:1], 24
    s_load_dwordx4 s[28:31], s[0:1], 48
    v_lshrrev_b32 v1, 6, v0
    v_and_b32 v2, 63, v0
    s_lshl_b32 s3, s2, 3
    v_lshl_add_u32 v3, v1, 1, s3
    v_lshlrev_b32 v3, 11, v3
    v_lshl_add_u32 v3, v2, 4, v3
    s_waitcnt lgkmcnt(0)
    s_mov_b32 s8, s4
    s_mov_b32 s9, s5
    s_mov_b32 s10, 0x400000
    s_mov_b32 s11, 0x20000
    s_mov_b32 s12, s6
    s_mov_b32 s13, s7
    s_mov_b32 s14, 0x400000
    s_mov_b32 s15, 0x20000
    s_mov_b32 s32, s24
    s_mov_b32 s33, s25
    s_mov_b32 s34, 0x80000
    s_mov_b32 s35, 0x20000
    s_mov_b32 s36, s28
    s_mov_b32 s37, s29
    s_mov_b32 s38, 0x70000
    s_mov_b32 s39, 0x20000
    s_mov_b32 s40, s30
    s_mov_b32 s41, s31
    s_mov_b32 s42, 0x70000
    s_mov_b32 s43, 0x20000
    s_mul_i32 s3, s2, 4096
    v_lshl_add_u32 v4, v0, 4, s3
    buffer_load_dwordx4 v[8:11], v3, s[8:11], 0 offen offset:0
    buffer_load_dwordx4 v[12:15], v3, s[8:11], 0 offen offset:1024
    buffer_load_dwordx4 v[16:19], v3, s[8:11], 0 offen offset:2048
    buffer_load_dwordx4 v[20:23], v3, s[8:11], 0 offen offset:3072
    s_movk_i32 s44, 0
    buffer_load_dwordx4 v[24:27], v4, s[32:35], s44 offen
    buffer_load_dwordx4 v[24:27], v4, s[36:39], s44 offen
    buffer_load_dwordx4 v[24:27], v4, s[40:43], s44 offen
    s_mov_b32 s16, 0xffff0000
    s_mov_b32 s17, 0x3a800000
    s_mov_b32 s18, 0x3727c5ac
    s_waitcnt vmcnt(5)
    v_lshlrev_b32 v32, 16, v8
    v_and_b32 v33, s16, v8
    v_lshlrev_b32 v34, 16, v9
    v_and_b32 v35, s16, v9
    v_lshlrev_b32 v36, 16, v10
    v_and_b32 v37, s16, v10
    v_lshlrev_b32 v38, 16, v11
    v_and_b32 v39, s16, v11
    v_lshlrev_b32 v40, 16, v12
    v_and_b32 v41, s16, v12
    v_lshlrev_b32 v42, 16, v13
    v_and_b32 v43, s16, v13
    v_lshlrev_b32 v44, 16, v14
    v_and_b32 v45, s16, v14
    v_lshlrev_b32 v46, 16, v15
    v_and_b32 v47, s16, v15
    v_add_f32 v48, v32, v33
    v_add_f32 v48, v48, v34
    v_add_f32 v48, v48, v35
    v_add_f32 v48, v48, v36
    v_add_f32 v48, v48, v37
    v_add_f32 v48, v48, v38
    v_add_f32 v48, v48, v39
    v_add_f32 v48, v48, v40
    v_add_f32 v48, v48, v41
    v_add_f32 v48, v48, v42
    v_add_f32 v48, v48, v43
    v_add_f32 v48, v48, v44
    v_add_f32 v48, v48, v45
    v_add_f32 v48, v48, v46
    v_add_f32 v48, v48, v47
    s_nop 1
    v_add_f32_dpp v48, v48, v48 row_ror:8 row_mask:0xf bank_mask:0xf
    s_nop 1
    v_add_f32_dpp v48, v48, v48 row_ror:4 row_mask:0xf bank_mask:0xf
    s_nop 1
    v_add_f32_dpp v48, v48, v48 row_ror:2 row_mask:0xf bank_mask:0xf
    s_nop 1
    v_add_f32_dpp v48, v48, v48 row_ror:1 row_mask:0xf bank_mask:0xf
    s_nop 1
    v_readlane_b32 s20, v48, 0
    v_readlane_b32 s21, v48, 16
    v_readlane_b32 s22, v48, 32
    v_readlane_b32 s23, v48, 48
    s_nop 1
    v_mov_b32 v49, s20
    v_add_f32 v49, s21, v49
    v_add_f32 v49, s22, v49
    v_add_f32 v49, s23, v49
    v_mul_f32 v49, s17, v49
    v_sub_f32 v50, v32, v49
    v_mul_f32 v48, v50, v50
    v_sub_f32 v50, v33, v49
    v_fmac_f32 v48, v50, v50
    v_sub_f32 v50, v34, v49
    v_fmac_f32 v48, v50, v50
    v_sub_f32 v50, v35, v49
    v_fmac_f32 v48, v50, v50
    v_sub_f32 v50, v36, v49
    v_fmac_f32 v48, v50, v50
    v_sub_f32 v50, v37, v49
    v_fmac_f32 v48, v50, v50
    v_sub_f32 v50, v38, v49
    v_fmac_f32 v48, v50, v50
    v_sub_f32 v50, v39, v49
    v_fmac_f32 v48, v50, v50
    v_sub_f32 v50, v40, v49
    v_fmac_f32 v48, v50, v50
    v_sub_f32 v50, v41, v49
    v_fmac_f32 v48, v50, v50
    v_sub_f32 v50, v42, v49
    v_fmac_f32 v48, v50, v50
    v_sub_f32 v50, v43, v49
    v_fmac_f32 v48, v50, v50
    v_sub_f32 v50, v44, v49
    v_fmac_f32 v48, v50, v50
    v_sub_f32 v50, v45, v49
    v_fmac_f32 v48, v50, v50
    v_sub_f32 v50, v46, v49
    v_fmac_f32 v48, v50, v50
    v_sub_f32 v50, v47, v49
    v_fmac_f32 v48, v50, v50
    s_nop 1
    v_add_f32_dpp v48, v48, v48 row_ror:8 row_mask:0xf bank_mask:0xf
    s_nop 1
    v_add_f32_dpp v48, v48, v48 row_ror:4 row_mask:0xf bank_mask:0xf
    s_nop 1
    v_add_f32_dpp v48, v48, v48 row_ror:2 row_mask:0xf bank_mask:0xf
    s_nop 1
    v_add_f32_dpp v48, v48, v48 row_ror:1 row_mask:0xf bank_mask:0xf
    s_nop 1
    v_readlane_b32 s20, v48, 0
    v_readlane_b32 s21, v48, 16
    v_readlane_b32 s22, v48, 32
    v_readlane_b32 s23, v48, 48
    s_nop 1
    v_mov_b32 v51, s20
    v_add_f32 v51, s21, v51
    v_add_f32 v51, s22, v51
    v_add_f32 v51, s23, v51
    v_mul_f32 v51, s17, v51
    v_cvt_pk_bf16_f32 v52, v49, v49
    v_lshlrev_b32 v52, 16, v52
    v_cvt_pk_bf16_f32 v53, v51, v51
    v_lshlrev_b32 v53, 16, v53
    v_add_f32 v53, s18, v53
    v_cvt_pk_bf16_f32 v53, v53, v53
    v_lshlrev_b32 v53, 16, v53
    v_sqrt_f32 v53, v53
    s_nop 0
    v_cvt_pk_bf16_f32 v53, v53, v53
    v_lshlrev_b32 v53, 16, v53
    v_rcp_f32 v54, v53
    s_nop 0
    v_fma_f32 v55, -v53, v54, 2.0
    v_mul_f32 v54, v54, v55
    v_sub_f32 v32, v32, v52
    v_sub_f32 v33, v33, v52
    v_sub_f32 v34, v34, v52
    v_sub_f32 v35, v35, v52
    v_sub_f32 v36, v36, v52
    v_sub_f32 v37, v37, v52
    v_sub_f32 v38, v38, v52
    v_sub_f32 v39, v39, v52
    v_sub_f32 v40, v40, v52
    v_sub_f32 v41, v41, v52
    v_sub_f32 v42, v42, v52
    v_sub_f32 v43, v43, v52
    v_sub_f32 v44, v44, v52
    v_sub_f32 v45, v45, v52
    v_sub_f32 v46, v46, v52
    v_sub_f32 v47, v47, v52
    v_cvt_pk_bf16_f32 v56, v32, v33
    v_cvt_pk_bf16_f32 v57, v34, v35
    v_cvt_pk_bf16_f32 v58, v36, v37
    v_cvt_pk_bf16_f32 v59, v38, v39
    v_cvt_pk_bf16_f32 v60, v40, v41
    v_cvt_pk_bf16_f32 v61, v42, v43
    v_cvt_pk_bf16_f32 v62, v44, v45
    v_cvt_pk_bf16_f32 v63, v46, v47
    v_lshlrev_b32 v32, 16, v56
    v_and_b32 v33, s16, v56
    v_lshlrev_b32 v34, 16, v57
    v_and_b32 v35, s16, v57
    v_lshlrev_b32 v36, 16, v58
    v_and_b32 v37, s16, v58
    v_lshlrev_b32 v38, 16, v59
    v_and_b32 v39, s16, v59
    v_lshlrev_b32 v40, 16, v60
    v_and_b32 v41, s16, v60
    v_lshlrev_b32 v42, 16, v61
    v_and_b32 v43, s16, v61
    v_lshlrev_b32 v44, 16, v62
    v_and_b32 v45, s16, v62
    v_lshlrev_b32 v46, 16, v63
    v_and_b32 v47, s16, v63
    v_mul_f32 v32, v32, v54
    v_mul_f32 v33, v33, v54
    v_mul_f32 v34, v34, v54
    v_mul_f32 v35, v35, v54
    v_mul_f32 v36, v36, v54
    v_mul_f32 v37, v37, v54
    v_mul_f32 v38, v38, v54
    v_mul_f32 v39, v39, v54
    v_mul_f32 v40, v40, v54
    v_mul_f32 v41, v41, v54
    v_mul_f32 v42, v42, v54
    v_mul_f32 v43, v43, v54
    v_mul_f32 v44, v44, v54
    v_mul_f32 v45, v45, v54
    v_mul_f32 v46, v46, v54
    v_mul_f32 v47, v47, v54
    v_cvt_pk_bf16_f32 v64, v32, v33
    v_cvt_pk_bf16_f32 v65, v34, v35
    v_cvt_pk_bf16_f32 v66, v36, v37
    v_cvt_pk_bf16_f32 v67, v38, v39
    v_cvt_pk_bf16_f32 v68, v40, v41
    v_cvt_pk_bf16_f32 v69, v42, v43
    v_cvt_pk_bf16_f32 v70, v44, v45
    v_cvt_pk_bf16_f32 v71, v46, v47
    buffer_store_dwordx4 v[64:67], v3, s[12:15], 0 offen offset:0
    buffer_store_dwordx4 v[68:71], v3, s[12:15], 0 offen offset:1024
    s_waitcnt vmcnt(5)
    v_lshlrev_b32 v32, 16, v16
    v_and_b32 v33, s16, v16
    v_lshlrev_b32 v34, 16, v17
    v_and_b32 v35, s16, v17
    v_lshlrev_b32 v36, 16, v18
    v_and_b32 v37, s16, v18
    v_lshlrev_b32 v38, 16, v19
    v_and_b32 v39, s16, v19
    v_lshlrev_b32 v40, 16, v20
    v_and_b32 v41, s16, v20
    v_lshlrev_b32 v42, 16, v21
    v_and_b32 v43, s16, v21
    v_lshlrev_b32 v44, 16, v22
    v_and_b32 v45, s16, v22
    v_lshlrev_b32 v46, 16, v23
    v_and_b32 v47, s16, v23
    v_add_f32 v48, v32, v33
    v_add_f32 v48, v48, v34
    v_add_f32 v48, v48, v35
    v_add_f32 v48, v48, v36
    v_add_f32 v48, v48, v37
    v_add_f32 v48, v48, v38
    v_add_f32 v48, v48, v39
    v_add_f32 v48, v48, v40
    v_add_f32 v48, v48, v41
    v_add_f32 v48, v48, v42
    v_add_f32 v48, v48, v43
    v_add_f32 v48, v48, v44
    v_add_f32 v48, v48, v45
    v_add_f32 v48, v48, v46
    v_add_f32 v48, v48, v47
    s_nop 1
    v_add_f32_dpp v48, v48, v48 row_ror:8 row_mask:0xf bank_mask:0xf
    s_nop 1
    v_add_f32_dpp v48, v48, v48 row_ror:4 row_mask:0xf bank_mask:0xf
    s_nop 1
    v_add_f32_dpp v48, v48, v48 row_ror:2 row_mask:0xf bank_mask:0xf
    s_nop 1
    v_add_f32_dpp v48, v48, v48 row_ror:1 row_mask:0xf bank_mask:0xf
    s_nop 1
    v_readlane_b32 s20, v48, 0
    v_readlane_b32 s21, v48, 16
    v_readlane_b32 s22, v48, 32
    v_readlane_b32 s23, v48, 48
    s_nop 1
    v_mov_b32 v49, s20
    v_add_f32 v49, s21, v49
    v_add_f32 v49, s22, v49
    v_add_f32 v49, s23, v49
    v_mul_f32 v49, s17, v49
    v_sub_f32 v50, v32, v49
    v_mul_f32 v48, v50, v50
    v_sub_f32 v50, v33, v49
    v_fmac_f32 v48, v50, v50
    v_sub_f32 v50, v34, v49
    v_fmac_f32 v48, v50, v50
    v_sub_f32 v50, v35, v49
    v_fmac_f32 v48, v50, v50
    v_sub_f32 v50, v36, v49
    v_fmac_f32 v48, v50, v50
    v_sub_f32 v50, v37, v49
    v_fmac_f32 v48, v50, v50
    v_sub_f32 v50, v38, v49
    v_fmac_f32 v48, v50, v50
    v_sub_f32 v50, v39, v49
    v_fmac_f32 v48, v50, v50
    v_sub_f32 v50, v40, v49
    v_fmac_f32 v48, v50, v50
    v_sub_f32 v50, v41, v49
    v_fmac_f32 v48, v50, v50
    v_sub_f32 v50, v42, v49
    v_fmac_f32 v48, v50, v50
    v_sub_f32 v50, v43, v49
    v_fmac_f32 v48, v50, v50
    v_sub_f32 v50, v44, v49
    v_fmac_f32 v48, v50, v50
    v_sub_f32 v50, v45, v49
    v_fmac_f32 v48, v50, v50
    v_sub_f32 v50, v46, v49
    v_fmac_f32 v48, v50, v50
    v_sub_f32 v50, v47, v49
    v_fmac_f32 v48, v50, v50
    s_nop 1
    v_add_f32_dpp v48, v48, v48 row_ror:8 row_mask:0xf bank_mask:0xf
    s_nop 1
    v_add_f32_dpp v48, v48, v48 row_ror:4 row_mask:0xf bank_mask:0xf
    s_nop 1
    v_add_f32_dpp v48, v48, v48 row_ror:2 row_mask:0xf bank_mask:0xf
    s_nop 1
    v_add_f32_dpp v48, v48, v48 row_ror:1 row_mask:0xf bank_mask:0xf
    s_nop 1
    v_readlane_b32 s20, v48, 0
    v_readlane_b32 s21, v48, 16
    v_readlane_b32 s22, v48, 32
    v_readlane_b32 s23, v48, 48
    s_nop 1
    v_mov_b32 v51, s20
    v_add_f32 v51, s21, v51
    v_add_f32 v51, s22, v51
    v_add_f32 v51, s23, v51
    v_mul_f32 v51, s17, v51
    v_cvt_pk_bf16_f32 v52, v49, v49
    v_lshlrev_b32 v52, 16, v52
    v_cvt_pk_bf16_f32 v53, v51, v51
    v_lshlrev_b32 v53, 16, v53
    v_add_f32 v53, s18, v53
    v_cvt_pk_bf16_f32 v53, v53, v53
    v_lshlrev_b32 v53, 16, v53
    v_sqrt_f32 v53, v53
    s_nop 0
    v_cvt_pk_bf16_f32 v53, v53, v53
    v_lshlrev_b32 v53, 16, v53
    v_rcp_f32 v54, v53
    s_nop 0
    v_fma_f32 v55, -v53, v54, 2.0
    v_mul_f32 v54, v54, v55
    v_sub_f32 v32, v32, v52
    v_sub_f32 v33, v33, v52
    v_sub_f32 v34, v34, v52
    v_sub_f32 v35, v35, v52
    v_sub_f32 v36, v36, v52
    v_sub_f32 v37, v37, v52
    v_sub_f32 v38, v38, v52
    v_sub_f32 v39, v39, v52
    v_sub_f32 v40, v40, v52
    v_sub_f32 v41, v41, v52
    v_sub_f32 v42, v42, v52
    v_sub_f32 v43, v43, v52
    v_sub_f32 v44, v44, v52
    v_sub_f32 v45, v45, v52
    v_sub_f32 v46, v46, v52
    v_sub_f32 v47, v47, v52
    v_cvt_pk_bf16_f32 v56, v32, v33
    v_cvt_pk_bf16_f32 v57, v34, v35
    v_cvt_pk_bf16_f32 v58, v36, v37
    v_cvt_pk_bf16_f32 v59, v38, v39
    v_cvt_pk_bf16_f32 v60, v40, v41
    v_cvt_pk_bf16_f32 v61, v42, v43
    v_cvt_pk_bf16_f32 v62, v44, v45
    v_cvt_pk_bf16_f32 v63, v46, v47
    v_lshlrev_b32 v32, 16, v56
    v_and_b32 v33, s16, v56
    v_lshlrev_b32 v34, 16, v57
    v_and_b32 v35, s16, v57
    v_lshlrev_b32 v36, 16, v58
    v_and_b32 v37, s16, v58
    v_lshlrev_b32 v38, 16, v59
    v_and_b32 v39, s16, v59
    v_lshlrev_b32 v40, 16, v60
    v_and_b32 v41, s16, v60
    v_lshlrev_b32 v42, 16, v61
    v_and_b32 v43, s16, v61
    v_lshlrev_b32 v44, 16, v62
    v_and_b32 v45, s16, v62
    v_lshlrev_b32 v46, 16, v63
    v_and_b32 v47, s16, v63
    v_mul_f32 v32, v32, v54
    v_mul_f32 v33, v33, v54
    v_mul_f32 v34, v34, v54
    v_mul_f32 v35, v35, v54
    v_mul_f32 v36, v36, v54
    v_mul_f32 v37, v37, v54
    v_mul_f32 v38, v38, v54
    v_mul_f32 v39, v39, v54
    v_mul_f32 v40, v40, v54
    v_mul_f32 v41, v41, v54
    v_mul_f32 v42, v42, v54
    v_mul_f32 v43, v43, v54
    v_mul_f32 v44, v44, v54
    v_mul_f32 v45, v45, v54
    v_mul_f32 v46, v46, v54
    v_mul_f32 v47, v47, v54
    v_cvt_pk_bf16_f32 v72, v32, v33
    v_cvt_pk_bf16_f32 v73, v34, v35
    v_cvt_pk_bf16_f32 v74, v36, v37
    v_cvt_pk_bf16_f32 v75, v38, v39
    v_cvt_pk_bf16_f32 v76, v40, v41
    v_cvt_pk_bf16_f32 v77, v42, v43
    v_cvt_pk_bf16_f32 v78, v44, v45
    v_cvt_pk_bf16_f32 v79, v46, v47
    buffer_store_dwordx4 v[72:75], v3, s[12:15], 0 offen offset:2048
    buffer_store_dwordx4 v[76:79], v3, s[12:15], 0 offen offset:3072
ln_done:
    s_endpgm

.globl fused_kernel
.p2align 8
.type fused_kernel,@function
fused_kernel:
    s_cmp_ge_u32 s2, 256
    s_cbranch_scc1 at_done
    s_load_dwordx2 s[4:5], s[0:1], 88
    s_load_dwordx2 s[6:7], s[0:1], 24
    s_load_dwordx4 s[28:31], s[0:1], 48
    s_load_dwordx4 s[84:87], s[0:1], 8
    s_load_dwordx2 s[88:89], s[0:1], 32
    s_load_dwordx2 s[82:83], s[0:1], 64
    v_lshrrev_b32 v1, 6, v0
    v_and_b32 v2, 63, v0
    s_nop 0
    v_readfirstlane_b32 s32, v1
    s_and_b32 s42, s2, 7
    s_lshr_b32 s43, s2, 3
    s_and_b32 s34, s43, 3
    s_lshl_b32 s42, s42, 2
    s_add_u32 s34, s34, s42
    s_lshr_b32 s33, s43, 2
    v_and_b32 v3, 15, v2
    v_lshrrev_b32 v92, 4, v2
    v_lshrrev_b32 v93, 2, v3
    v_and_b32 v94, 3, v3
    v_lshrrev_b32 v95, 3, v2
    v_lshlrev_b32 v95, 11, v95
    v_and_b32 v96, 7, v2
    v_or_b32 v97, 0, v92
    v_xor_b32 v97, v97, v96
    v_lshl_add_u32 v80, v97, 4, v95
    v_or_b32 v97, 4, v92
    v_xor_b32 v97, v97, v96
    v_lshl_add_u32 v81, v97, 4, v95
    s_lshl_b32 s42, s34, 8
    v_lshlrev_b32 v95, 13, v92
    v_add_u32 v95, s42, v95
    v_or_b32 v97, 0, v92
    v_lshlrev_b32 v97, 1, v97
    v_xor_b32 v97, v97, v3
    v_lshl_add_u32 v82, v97, 4, v95
    v_or_b32 v97, 4, v92
    v_lshlrev_b32 v97, 1, v97
    v_xor_b32 v97, v97, v3
    v_lshl_add_u32 v83, v97, 4, v95
    s_and_b32 s42, s32, 1
    s_mul_i32 s42, s42, 448
    s_mul_i32 s43, s34, 224
    s_movk_i32 s44, 4682
    s_movk_i32 s45, 7168
    v_add_u32 v95, s42, v2
    v_mul_u32_u24 v96, s44, v95
    v_lshrrev_b32 v96, 16, v96
    v_mul_u32_u24 v97, 14, v96
    v_sub_u32 v97, v95, v97
    v_and_b32 v98, 0x70, v96
    v_and_b32 v99, 1, v96
    v_lshl_add_u32 v98, v99, 3, v98
    v_bfe_u32 v99, v96, 3, 1
    v_lshl_add_u32 v98, v99, 2, v98
    v_bfe_u32 v99, v96, 1, 2
    v_add_u32 v98, v98, v99
    v_mul_u32_u24 v98, s45, v98
    v_lshl_add_u32 v98, v97, 4, v98
    v_add_u32 v84, s43, v98
    v_add_u32 v95, s42, v2
    v_add_u32 v95, 64, v95
    v_mul_u32_u24 v96, s44, v95
    v_lshrrev_b32 v96, 16, v96
    v_mul_u32_u24 v97, 14, v96
    v_sub_u32 v97, v95, v97
    v_and_b32 v98, 0x70, v96
    v_and_b32 v99, 1, v96
    v_lshl_add_u32 v98, v99, 3, v98
    v_bfe_u32 v99, v96, 3, 1
    v_lshl_add_u32 v98, v99, 2, v98
    v_bfe_u32 v99, v96, 1, 2
    v_add_u32 v98, v98, v99
    v_mul_u32_u24 v98, s45, v98
    v_lshl_add_u32 v98, v97, 4, v98
    v_add_u32 v85, s43, v98
    v_add_u32 v95, s42, v2
    v_add_u32 v95, 128, v95
    v_mul_u32_u24 v96, s44, v95
    v_lshrrev_b32 v96, 16, v96
    v_mul_u32_u24 v97, 14, v96
    v_sub_u32 v97, v95, v97
    v_and_b32 v98, 0x70, v96
    v_and_b32 v99, 1, v96
    v_lshl_add_u32 v98, v99, 3, v98
    v_bfe_u32 v99, v96, 3, 1
    v_lshl_add_u32 v98, v99, 2, v98
    v_bfe_u32 v99, v96, 1, 2
    v_add_u32 v98, v98, v99
    v_mul_u32_u24 v98, s45, v98
    v_lshl_add_u32 v98, v97, 4, v98
    v_add_u32 v86, s43, v98
    v_add_u32 v95, s42, v2
    v_add_u32 v95, 192, v95
    v_mul_u32_u24 v96, s44, v95
    v_lshrrev_b32 v96, 16, v96
    v_mul_u32_u24 v97, 14, v96
    v_sub_u32 v97, v95, v97
    v_and_b32 v98, 0x70, v96
    v_and_b32 v99, 1, v96
    v_lshl_add_u32 v98, v99, 3, v98
    v_bfe_u32 v99, v96, 3, 1
    v_lshl_add_u32 v98, v99, 2, v98
    v_bfe_u32 v99, v96, 1, 2
    v_add_u32 v98, v98, v99
    v_mul_u32_u24 v98, s45, v98
    v_lshl_add_u32 v98, v97, 4, v98
    v_add_u32 v87, s43, v98
    v_add_u32 v95, s42, v2
    v_add_u32 v95, 256, v95
    v_mul_u32_u24 v96, s44, v95
    v_lshrrev_b32 v96, 16, v96
    v_mul_u32_u24 v97, 14, v96
    v_sub_u32 v97, v95, v97
    v_and_b32 v98, 0x70, v96
    v_and_b32 v99, 1, v96
    v_lshl_add_u32 v98, v99, 3, v98
    v_bfe_u32 v99, v96, 3, 1
    v_lshl_add_u32 v98, v99, 2, v98
    v_bfe_u32 v99, v96, 1, 2
    v_add_u32 v98, v98, v99
    v_mul_u32_u24 v98, s45, v98
    v_lshl_add_u32 v98, v97, 4, v98
    v_add_u32 v88, s43, v98
    v_add_u32 v95, s42, v2
    v_add_u32 v95, 320, v95
    v_mul_u32_u24 v96, s44, v95
    v_lshrrev_b32 v96, 16, v96
    v_mul_u32_u24 v97, 14, v96
    v_sub_u32 v97, v95, v97
    v_and_b32 v98, 0x70, v96
    v_and_b32 v99, 1, v96
    v_lshl_add_u32 v98, v99, 3, v98
    v_bfe_u32 v99, v96, 3, 1
    v_lshl_add_u32 v98, v99, 2, v98
    v_bfe_u32 v99, v96, 1, 2
    v_add_u32 v98, v98, v99
    v_mul_u32_u24 v98, s45, v98
    v_lshl_add_u32 v98, v97, 4, v98
    v_add_u32 v89, s43, v98
    v_add_u32 v95, s42, v2
    v_add_u32 v95, 384, v95
    v_mul_u32_u24 v96, s44, v95
    v_lshrrev_b32 v96, 16, v96
    v_mul_u32_u24 v97, 14, v96
    v_sub_u32 v97, v95, v97
    v_and_b32 v98, 0x70, v96
    v_and_b32 v99, 1, v96
    v_lshl_add_u32 v98, v99, 3, v98
    v_bfe_u32 v99, v96, 3, 1
    v_lshl_add_u32 v98, v99, 2, v98
    v_bfe_u32 v99, v96, 1, 2
    v_add_u32 v98, v98, v99
    v_mul_u32_u24 v98, s45, v98
    v_lshl_add_u32 v98, v97, 4, v98
    v_add_u32 v90, s43, v98
    s_waitcnt lgkmcnt(0)
    s_mov_b32 s8, s4
    s_mov_b32 s9, s5
    s_mov_b32 s10, 0x400000
    s_mov_b32 s11, 0x20000
    s_mov_b32 s12, s6
    s_mov_b32 s13, s7
    s_mov_b32 s14, 0x800000
    s_mov_b32 s15, 0x20000
    s_cmp_lt_u32 s32, 2
    s_cselect_b32 s16, s28, s30
    s_cselect_b32 s17, s29, s31
    s_mov_b32 s18, 0x700000
    s_mov_b32 s19, 0x20000
    s_add_u32 s20, s4, 0x400000
    s_addc_u32 s21, s5, 0
    s_mov_b32 s22, 0x1000000
    s_mov_b32 s23, 0x20000
    s_add_u32 s24, s4, 0x1400000
    s_addc_u32 s25, s5, 0
    s_mov_b32 s26, 0xe00000
    s_mov_b32 s27, 0x20000
    s_lshl_b32 s42, s33, 8
    s_lshl_b32 s43, s32, 6
    s_add_u32 s46, s42, s43
    s_lshl_b32 s35, s46, 11
    s_lshl_b32 s36, s32, 17
    s_mov_b32 s37, 0
    s_mul_i32 s52, s33, 2
    s_and_b32 s52, s52, 15
    s_lshl_b32 s42, s52, 7
    s_add_u32 s35, s35, s42
    s_lshl_b32 s42, s52, 19
    s_add_u32 s36, s36, s42
    s_mul_i32 s37, s52, 458752
    s_lshl_b32 s38, s32, 13
    s_lshl_b32 s39, s32, 12
    s_add_u32 s39, s39, 0x10000
    s_mul_i32 s40, s32, 7168
    s_add_u32 s40, s40, 0x18000
    s_add_u32 m0, s38, 0x0
    s_add_u32 s42, s35, 0x0
    buffer_load_dwordx4 v80, s[8:11], s42 offen lds
    s_add_u32 m0, s38, 0x400
    s_add_u32 s42, s35, 0x4000
    buffer_load_dwordx4 v81, s[8:11], s42 offen lds
    s_add_u32 m0, s38, 0x800
    s_add_u32 s42, s35, 0x8000
    buffer_load_dwordx4 v80, s[8:11], s42 offen lds
    s_add_u32 m0, s38, 0xc00
    s_add_u32 s42, s35, 0xc000
    buffer_load_dwordx4 v81, s[8:11], s42 offen lds
    s_add_u32 m0, s38, 0x1000
    s_add_u32 s42, s35, 0x10000
    buffer_load_dwordx4 v80, s[8:11], s42 offen lds
    s_add_u32 m0, s38, 0x1400
    s_add_u32 s42, s35, 0x14000
    buffer_load_dwordx4 v81, s[8:11], s42 offen lds
    s_add_u32 m0, s38, 0x1800
    s_add_u32 s42, s35, 0x18000
    buffer_load_dwordx4 v80, s[8:11], s42 offen lds
    s_add_u32 m0, s38, 0x1c00
    s_add_u32 s42, s35, 0x1c000
    buffer_load_dwordx4 v81, s[8:11], s42 offen lds
    s_add_u32 m0, s39, 0x0
    s_add_u32 s42, s36, 0x0
    buffer_load_dwordx4 v82, s[12:15], s42 offen lds
    s_add_u32 m0, s39, 0x400
    s_add_u32 s42, s36, 0x8000
    buffer_load_dwordx4 v82, s[12:15], s42 offen lds
    s_add_u32 m0, s39, 0x800
    s_add_u32 s42, s36, 0x10000
    buffer_load_dwordx4 v83, s[12:15], s42 offen lds
    s_add_u32 m0, s39, 0xc00
    s_add_u32 s42, s36, 0x18000
    buffer_load_dwordx4 v83, s[12:15], s42 offen lds
    s_add_u32 m0, s40, 0x0
    s_nop 0
    buffer_load_dwordx4 v84, s[16:19], s37 offen lds
    s_add_u32 m0, s40, 0x400
    s_nop 0
    buffer_load_dwordx4 v85, s[16:19], s37 offen lds
    s_add_u32 m0, s40, 0x800
    s_nop 0
    buffer_load_dwordx4 v86, s[16:19], s37 offen lds
    s_add_u32 m0, s40, 0xc00
    s_nop 0
    buffer_load_dwordx4 v87, s[16:19], s37 offen lds
    s_add_u32 m0, s40, 0x1000
    s_nop 0
    buffer_load_dwordx4 v88, s[16:19], s37 offen lds
    s_add_u32 m0, s40, 0x1400
    s_nop 0
    buffer_load_dwordx4 v89, s[16:19], s37 offen lds
    s_add_u32 m0, s40, 0x1800
    s_nop 0
    buffer_load_dwordx4 v90, s[16:19], s37 offen lds
    s_add_u32 s35, s35, 128
    s_add_u32 s36, s36, 0x80000
    s_add_u32 s37, s37, 0x70000
    s_add_u32 s52, s52, 1
    s_cmp_eq_u32 s52, 16
    s_cselect_b32 s52, 0, s52
    s_cselect_b32 s42, 0x800, 0
    s_sub_u32 s35, s35, s42
    s_cmp_eq_u32 s52, 0
    s_cselect_b32 s42, 0x800000, 0
    s_cselect_b32 s43, 0x700000, 0
    s_sub_u32 s36, s36, s42
    s_sub_u32 s37, s37, s43
    v_lshrrev_b32 v95, 1, v3
    v_lshlrev_b32 v96, 7, v3
    s_lshl_b32 s42, s32, 13
    v_add_u32 v96, s42, v96
    v_or_b32 v97, 0, v92
    v_xor_b32 v97, v97, v95
    v_lshl_add_u32 v68, v97, 4, v96
    v_or_b32 v97, 4, v92
    v_xor_b32 v97, v97, v95
    v_lshl_add_u32 v69, v97, 4, v96
    v_and_b32 v95, 1, v92
    v_lshl_or_b32 v95, v95, 2, v93
    v_lshl_add_u32 v96, v92, 3, v93
    v_lshlrev_b32 v96, 8, v96
    v_lshl_add_u32 v96, v94, 3, v96
    v_add_u32 v96, 0x10000, v96
    v_xor_b32 v97, 0, v95
    v_lshl_add_u32 v70, v97, 5, v96
    v_xor_b32 v97, 1, v95
    v_lshl_add_u32 v71, v97, 5, v96
    v_xor_b32 v97, 2, v95
    v_lshl_add_u32 v72, v97, 5, v96
    v_xor_b32 v97, 3, v95
    v_lshl_add_u32 v73, v97, 5, v96
    v_xor_b32 v97, 4, v95
    v_lshl_add_u32 v74, v97, 5, v96
    v_xor_b32 v97, 5, v95
    v_lshl_add_u32 v75, v97, 5, v96
    v_xor_b32 v97, 6, v95
    v_lshl_add_u32 v76, v97, 5, v96
    v_xor_b32 v97, 7, v95
    v_lshl_add_u32 v77, v97, 5, v96
    v_lshrrev_b32 v95, 1, v92
    v_lshlrev_b32 v95, 4, v95
    v_lshl_add_u32 v95, v93, 1, v95
    v_and_b32 v96, 1, v92
    v_add_u32 v95, v95, v96
    v_mul_u32_u24 v95, 224, v95
    v_lshl_add_u32 v95, v94, 3, v95
    v_add_u32 v78, 0x18000, v95
    v_lshrrev_b32 v128, 4, v2
    v_lshlrev_b32 v129, 8, v128
    v_or_b32 v130, 0, v128
    v_xor_b32 v130, v130, v3
    v_lshl_add_u32 v116, v130, 4, v129
    v_or_b32 v130, 4, v128
    v_xor_b32 v130, v130, v3
    v_lshl_add_u32 v117, v130, 4, v129
    v_or_b32 v130, 8, v128
    v_xor_b32 v130, v130, v3
    v_lshl_add_u32 v118, v130, 4, v129
    v_or_b32 v130, 12, v128
    v_xor_b32 v130, v130, v3
    v_lshl_add_u32 v119, v130, 4, v129
    v_or_b32 v130, 0, v128
    v_lshlrev_b32 v130, 1, v130
    v_xor_b32 v130, v130, v3
    v_lshl_add_u32 v120, v130, 4, v129
    v_or_b32 v130, 4, v128
    v_lshlrev_b32 v130, 1, v130
    v_xor_b32 v130, v130, v3
    v_lshl_add_u32 v121, v130, 4, v129
    s_lshl_b32 s42, s34, 19
    s_add_u32 s56, s84, s42
    s_addc_u32 s57, s85, 0
    s_mov_b32 s58, 0x80000
    s_mov_b32 s59, 0x20000
    s_add_u32 s60, s86, s42
    s_addc_u32 s61, s87, 0
    s_mov_b32 s62, 0x80000
    s_mov_b32 s63, 0x20000
    s_lshl_b32 s78, s32, 12
    s_add_u32 s76, s78, 0x10000
    s_add_u32 s77, s78, 0xc000
    s_lshl_b32 s42, s33, 8
    s_lshl_b32 s43, s32, 6
    s_add_u32 s42, s42, s43
    s_mul_i32 s81, s42, 8192
    s_lshl_b32 s43, s34, 8
    s_add_u32 s81, s81, s43
    s_add_u32 s64, s4, 0x4800000
    s_addc_u32 s65, s5, 0
    s_mov_b32 s66, 0x1000000
    s_mov_b32 s67, 0x20000
    s_mov_b32 s68, s88
    s_mov_b32 s69, s89
    s_mov_b32 s70, 0x800000
    s_mov_b32 s71, 0x20000
    s_mov_b32 s72, s82
    s_mov_b32 s73, s83
    s_mov_b32 s74, 0x700000
    s_mov_b32 s75, 0x20000
    s_mov_b32 s79, 0x42000000
    s_lshl_b32 s42, s2, 2
    s_add_u32 s42, s42, s32
    s_lshl_b32 s42, s42, 12
    v_lshl_add_u32 v122, v2, 6, s42
    v_and_b32 v129, 1, v128
    v_lshrrev_b32 v130, 1, v128
    v_lshl_or_b32 v127, v129, 1, v130
    v_lshlrev_b32 v129, 8, v3
    v_or_b32 v130, 0, v127
    v_xor_b32 v130, v130, v3
    v_lshl_add_u32 v104, v130, 4, v129
    v_or_b32 v130, 4, v127
    v_xor_b32 v130, v130, v3
    v_lshl_add_u32 v105, v130, 4, v129
    v_or_b32 v130, 8, v127
    v_xor_b32 v130, v130, v3
    v_lshl_add_u32 v106, v130, 4, v129
    v_or_b32 v130, 12, v127
    v_xor_b32 v130, v130, v3
    v_lshl_add_u32 v107, v130, 4, v129
    v_lshrrev_b32 v129, 2, v3
    v_lshl_add_u32 v130, v128, 2, v129
    v_and_b32 v132, 7, v130
    v_lshlrev_b32 v130, 8, v130
    v_and_b32 v131, 3, v3
    v_lshl_add_u32 v130, v131, 3, v130
    v_add_u32 v130, 0x10000, v130
    v_xor_b32 v131, 0, v132
    v_lshl_add_u32 v108, v131, 5, v130
    v_xor_b32 v131, 1, v132
    v_lshl_add_u32 v109, v131, 5, v130
    v_xor_b32 v131, 2, v132
    v_lshl_add_u32 v110, v131, 5, v130
    v_xor_b32 v131, 3, v132
    v_lshl_add_u32 v111, v131, 5, v130
    v_xor_b32 v131, 4, v132
    v_lshl_add_u32 v112, v131, 5, v130
    v_xor_b32 v131, 5, v132
    v_lshl_add_u32 v113, v131, 5, v130
    v_xor_b32 v131, 6, v132
    v_lshl_add_u32 v114, v131, 5, v130
    v_xor_b32 v131, 7, v132
    v_lshl_add_u32 v115, v131, 5, v130
    s_lshl_b32 s42, s33, 2
    s_add_u32 s42, s42, s32
    s_lshl_b32 s42, s42, 11
    v_and_b32 v100, 31, v2
    v_lshl_add_u32 v100, v100, 6, s42
    s_mov_b32 s51, 0x80000
    v_mov_b32 v4, 0
    v_mov_b32 v5, 0
    v_mov_b32 v6, 0
    v_mov_b32 v7, 0
    s_nop 1
    v_mfma_f32_32x32x16_bf16 a[0:15], v[4:7], v[4:7], 0
    v_mfma_f32_32x32x16_bf16 a[16:31], v[4:7], v[4:7], 0
    v_mfma_f32_32x32x16_bf16 a[32:47], v[4:7], v[4:7], 0
    v_mfma_f32_32x32x16_bf16 a[48:63], v[4:7], v[4:7], 0
    v_mfma_f32_32x32x16_bf16 a[64:79], v[4:7], v[4:7], 0
    v_mfma_f32_32x32x16_bf16 a[80:95], v[4:7], v[4:7], 0
    v_mfma_f32_32x32x16_bf16 a[96:111], v[4:7], v[4:7], 0
    v_mfma_f32_32x32x16_bf16 a[112:127], v[4:7], v[4:7], 0
    v_mfma_f32_32x32x16_bf16 a[128:143], v[4:7], v[4:7], 0
    v_mfma_f32_32x32x16_bf16 a[144:159], v[4:7], v[4:7], 0
    v_mfma_f32_32x32x16_bf16 a[160:175], v[4:7], v[4:7], 0
    v_mfma_f32_32x32x16_bf16 a[176:191], v[4:7], v[4:7], 0
    v_mfma_f32_32x32x16_bf16 a[192:207], v[4:7], v[4:7], 0
    v_mfma_f32_32x32x16_bf16 a[208:223], v[4:7], v[4:7], 0
    v_mfma_f32_32x32x16_bf16 a[224:239], v[4:7], v[4:7], 0
    v_mfma_f32_32x32x16_bf16 a[240:255], v[4:7], v[4:7], 0
    v_mfma_f32_32x32x16_bf16 v[160:175], v[4:7], v[4:7], 0
    v_mfma_f32_32x32x16_bf16 v[176:191], v[4:7], v[4:7], 0
    v_mfma_f32_32x32x16_bf16 v[192:207], v[4:7], v[4:7], 0
    v_mfma_f32_32x32x16_bf16 v[208:223], v[4:7], v[4:7], 0
    v_mfma_f32_32x32x16_bf16 v[224:239], v[4:7], v[4:7], 0
    v_mfma_f32_32x32x16_bf16 v[240:255], v[4:7], v[4:7], 0
    s_nop 7
    s_nop 7
    s_waitcnt vmcnt(0) lgkmcnt(0)
    s_barrier
    ds_read_b64_tr_b16 v[36:37], v70 offset:0
    ds_read_b64_tr_b16 v[38:39], v70 offset:1024
    ds_read_b128 v[4:7], v68 offset:0
    ds_read_b64_tr_b16 v[40:41], v71 offset:0
    ds_read_b64_tr_b16 v[42:43], v71 offset:1024
    ds_read_b128 v[8:11], v68 offset:2048
    s_add_u32 m0, s38, 0x8000
    s_add_u32 s42, s35, 0x0
    buffer_load_dwordx4 v80, s[8:11], s42 offen lds
    ds_read_b64_tr_b16 v[44:45], v72 offset:0
    ds_read_b64_tr_b16 v[46:47], v72 offset:1024
    ds_read_b128 v[12:15], v68 offset:4096
    s_add_u32 m0, s38, 0x8400
    s_add_u32 s42, s35, 0x4000
    buffer_load_dwordx4 v81, s[8:11], s42 offen lds
    ds_read_b64_tr_b16 v[48:49], v73 offset:0
    ds_read_b64_tr_b16 v[50:51], v73 offset:1024
    ds_read_b128 v[16:19], v68 offset:6144
    s_add_u32 m0, s38, 0x8800
    s_add_u32 s42, s35, 0x8000
    buffer_load_dwordx4 v80, s[8:11], s42 offen lds
    ds_read_b64_tr_b16 v[52:53], v74 offset:0
    ds_read_b64_tr_b16 v[54:55], v74 offset:1024
    s_add_u32 m0, s38, 0x8c00
    s_add_u32 s42, s35, 0xc000
    buffer_load_dwordx4 v81, s[8:11], s42 offen lds
    ds_read_b64_tr_b16 v[56:57], v75 offset:0
    ds_read_b64_tr_b16 v[58:59], v75 offset:1024
    s_add_u32 m0, s38, 0x9000
    s_add_u32 s42, s35, 0x10000
    buffer_load_dwordx4 v80, s[8:11], s42 offen lds
    s_mov_b32 s41, 0
g1_loop:
    s_waitcnt lgkmcnt(5)
    s_waitcnt lgkmcnt(4)
    v_mfma_f32_16x16x32_bf16 a[0:3], v[36:39], v[4:7], a[0:3]
    ds_read_b64_tr_b16 v[60:61], v76 offset:0
    ds_read_b64_tr_b16 v[62:63], v76 offset:1024
    v_mfma_f32_16x16x32_bf16 a[4:7], v[36:39], v[8:11], a[4:7]
    v_mfma_f32_16x16x32_bf16 a[8:11], v[36:39], v[12:15], a[8:11]
    s_add_u32 m0, s38, 0x9400
    s_add_u32 s42, s35, 0x14000
    v_mfma_f32_16x16x32_bf16 a[12:15], v[36:39], v[16:19], a[12:15]
    buffer_load_dwordx4 v81, s[8:11], s42 offen lds
    v_mfma_f32_16x16x32_bf16 a[16:19], v[40:43], v[4:7], a[16:19]
    ds_read_b64_tr_b16 v[64:65], v77 offset:0
    ds_read_b64_tr_b16 v[66:67], v77 offset:1024
    v_mfma_f32_16x16x32_bf16 a[20:23], v[40:43], v[8:11], a[20:23]
    v_mfma_f32_16x16x32_bf16 a[24:27], v[40:43], v[12:15], a[24:27]
    s_add_u32 m0, s38, 0x9800
    s_add_u32 s42, s35, 0x18000
    v_mfma_f32_16x16x32_bf16 a[28:31], v[40:43], v[16:19], a[28:31]
    buffer_load_dwordx4 v80, s[8:11], s42 offen lds
    v_mfma_f32_16x16x32_bf16 a[32:35], v[44:47], v[4:7], a[32:35]
    ds_read_b64_tr_b16 v[36:37], v78 offset:0
    ds_read_b64_tr_b16 v[38:39], v78 offset:1792
    v_mfma_f32_16x16x32_bf16 a[36:39], v[44:47], v[8:11], a[36:39]
    v_mfma_f32_16x16x32_bf16 a[40:43], v[44:47], v[12:15], a[40:43]
    s_add_u32 m0, s38, 0x9c00
    s_add_u32 s42, s35, 0x1c000
    v_mfma_f32_16x16x32_bf16 a[44:47], v[44:47], v[16:19], a[44:47]
    buffer_load_dwordx4 v81, s[8:11], s42 offen lds
    v_mfma_f32_16x16x32_bf16 a[48:51], v[48:51], v[4:7], a[48:51]
    ds_read_b64_tr_b16 v[40:41], v78 offset:32
    ds_read_b64_tr_b16 v[42:43], v78 offset:1824
    v_mfma_f32_16x16x32_bf16 a[52:55], v[48:51], v[8:11], a[52:55]
    v_mfma_f32_16x16x32_bf16 a[56:59], v[48:51], v[12:15], a[56:59]
    s_add_u32 m0, s39, 0x4000
    s_add_u32 s42, s36, 0x0
    v_mfma_f32_16x16x32_bf16 a[60:63], v[48:51], v[16:19], a[60:63]
    buffer_load_dwordx4 v82, s[12:15], s42 offen lds
    s_waitcnt lgkmcnt(4)
    v_mfma_f32_16x16x32_bf16 a[64:67], v[52:55], v[4:7], a[64:67]
    ds_read_b64_tr_b16 v[44:45], v78 offset:64
    ds_read_b64_tr_b16 v[46:47], v78 offset:1856
    v_mfma_f32_16x16x32_bf16 a[68:71], v[52:55], v[8:11], a[68:71]
    v_mfma_f32_16x16x32_bf16 a[72:75], v[52:55], v[12:15], a[72:75]
    s_add_u32 m0, s39, 0x4400
    s_add_u32 s42, s36, 0x8000
    v_mfma_f32_16x16x32_bf16 a[76:79], v[52:55], v[16:19], a[76:79]
    buffer_load_dwordx4 v82, s[12:15], s42 offen lds
    v_mfma_f32_16x16x32_bf16 a[80:83], v[56:59], v[4:7], a[80:83]
    ds_read_b64_tr_b16 v[48:49], v78 offset:96
    ds_read_b64_tr_b16 v[50:51], v78 offset:1888
    v_mfma_f32_16x16x32_bf16 a[84:87], v[56:59], v[8:11], a[84:87]
    v_mfma_f32_16x16x32_bf16 a[88:91], v[56:59], v[12:15], a[88:91]
    s_add_u32 m0, s39, 0x4800
    s_add_u32 s42, s36, 0x10000
    v_mfma_f32_16x16x32_bf16 a[92:95], v[56:59], v[16:19], a[92:95]
    buffer_load_dwordx4 v83, s[12:15], s42 offen lds
    v_mfma_f32_16x16x32_bf16 a[96:99], v[60:63], v[4:7], a[96:99]
    ds_read_b64_tr_b16 v[52:53], v78 offset:128
    ds_read_b64_tr_b16 v[54:55], v78 offset:1920
    v_mfma_f32_16x16x32_bf16 a[100:103], v[60:63], v[8:11], a[100:103]
    v_mfma_f32_16x16x32_bf16 a[104:107], v[60:63], v[12:15], a[104:107]
    s_add_u32 m0, s39, 0x4c00
    s_add_u32 s42, s36, 0x18000
    v_mfma_f32_16x16x32_bf16 a[108:111], v[60:63], v[16:19], a[108:111]
    buffer_load_dwordx4 v83, s[12:15], s42 offen lds
    v_mfma_f32_16x16x32_bf16 a[112:115], v[64:67], v[4:7], a[112:115]
    ds_read_b64_tr_b16 v[56:57], v78 offset:160
    ds_read_b64_tr_b16 v[58:59], v78 offset:1952
    v_mfma_f32_16x16x32_bf16 a[116:119], v[64:67], v[8:11], a[116:119]
    v_mfma_f32_16x16x32_bf16 a[120:123], v[64:67], v[12:15], a[120:123]
    s_add_u32 m0, s40, 0x7000
    s_nop 0
    v_mfma_f32_16x16x32_bf16 a[124:127], v[64:67], v[16:19], a[124:127]
    buffer_load_dwordx4 v84, s[16:19], s37 offen lds
    s_waitcnt lgkmcnt(4)
    v_mfma_f32_16x16x32_bf16 a[128:131], v[36:39], v[4:7], a[128:131]
    ds_read_b64_tr_b16 v[60:61], v78 offset:192
    ds_read_b64_tr_b16 v[62:63], v78 offset:1984
    v_mfma_f32_16x16x32_bf16 a[132:135], v[36:39], v[8:11], a[132:135]
    v_mfma_f32_16x16x32_bf16 a[136:139], v[36:39], v[12:15], a[136:139]
    s_add_u32 m0, s40, 0x7400
    s_nop 0
    v_mfma_f32_16x16x32_bf16 a[140:143], v[36:39], v[16:19], a[140:143]
    buffer_load_dwordx4 v85, s[16:19], s37 offen lds
    v_mfma_f32_16x16x32_bf16 a[144:147], v[40:43], v[4:7], a[144:147]
    ds_read_b64_tr_b16 v[64:65], v78 offset:14336
    ds_read_b64_tr_b16 v[66:67], v78 offset:16128
    v_mfma_f32_16x16x32_bf16 a[148:151], v[40:43], v[8:11], a[148:151]
    v_mfma_f32_16x16x32_bf16 a[152:155], v[40:43], v[12:15], a[152:155]
    s_add_u32 m0, s40, 0x7800
    s_nop 0
    v_mfma_f32_16x16x32_bf16 a[156:159], v[40:43], v[16:19], a[156:159]
    buffer_load_dwordx4 v86, s[16:19], s37 offen lds
    v_mfma_f32_16x16x32_bf16 a[160:163], v[44:47], v[4:7], a[160:163]
    ds_read_b64_tr_b16 v[36:37], v78 offset:14368
    ds_read_b64_tr_b16 v[38:39], v78 offset:16160
    ds_read_b128 v[20:23], v69 offset:0
    v_mfma_f32_16x16x32_bf16 a[164:167], v[44:47], v[8:11], a[164:167]
    v_mfma_f32_16x16x32_bf16 a[168:171], v[44:47], v[12:15], a[168:171]
    s_add_u32 m0, s40, 0x7c00
    s_nop 0
    v_mfma_f32_16x16x32_bf16 a[172:175], v[44:47], v[16:19], a[172:175]
    buffer_load_dwordx4 v87, s[16:19], s37 offen lds
    v_mfma_f32_16x16x32_bf16 a[176:179], v[48:51], v[4:7], a[176:179]
    ds_read_b64_tr_b16 v[40:41], v78 offset:14400
    ds_read_b64_tr_b16 v[42:43], v78 offset:16192
    ds_read_b128 v[24:27], v69 offset:2048
    v_mfma_f32_16x16x32_bf16 a[180:183], v[48:51], v[8:11], a[180:183]
    v_mfma_f32_16x16x32_bf16 a[184:187], v[48:51], v[12:15], a[184:187]
    s_add_u32 m0, s40, 0x8000
    s_nop 0
    v_mfma_f32_16x16x32_bf16 a[188:191], v[48:51], v[16:19], a[188:191]
    buffer_load_dwordx4 v88, s[16:19], s37 offen lds
    s_waitcnt lgkmcnt(6)
    v_mfma_f32_16x16x32_bf16 a[192:195], v[52:55], v[4:7], a[192:195]
    ds_read_b64_tr_b16 v[44:45], v78 offset:14432
    ds_read_b64_tr_b16 v[46:47], v78 offset:16224
    ds_read_b128 v[28:31], v69 offset:4096
    v_mfma_f32_16x16x32_bf16 a[196:199], v[52:55], v[8:11], a[196:199]
    v_mfma_f32_16x16x32_bf16 a[200:203], v[52:55], v[12:15], a[200:203]
    s_add_u32 m0, s40, 0x8400
    s_nop 0
    v_mfma_f32_16x16x32_bf16 a[204:207], v[52:55], v[16:19], a[204:207]
    buffer_load_dwordx4 v89, s[16:19], s37 offen lds
    v_mfma_f32_16x16x32_bf16 a[208:211], v[56:59], v[4:7], a[208:211]
    ds_read_b64_tr_b16 v[48:49], v78 offset:14464
    ds_read_b64_tr_b16 v[50:51], v78 offset:16256
    ds_read_b128 v[32:35], v69 offset:6144
    v_mfma_f32_16x16x32_bf16 a[212:215], v[56:59], v[8:11], a[212:215]
    v_mfma_f32_16x16x32_bf16 a[216:219], v[56:59], v[12:15], a[216:219]
    s_add_u32 m0, s40, 0x8800
    s_nop 0
    v_mfma_f32_16x16x32_bf16 a[220:223], v[56:59], v[16:19], a[220:223]
    buffer_load_dwordx4 v90, s[16:19], s37 offen lds
    v_mfma_f32_16x16x32_bf16 a[224:227], v[60:63], v[4:7], a[224:227]
    ds_read_b64_tr_b16 v[52:53], v78 offset:14496
    ds_read_b64_tr_b16 v[54:55], v78 offset:16288
    v_mfma_f32_16x16x32_bf16 a[228:231], v[60:63], v[8:11], a[228:231]
    v_mfma_f32_16x16x32_bf16 a[232:235], v[60:63], v[12:15], a[232:235]
    s_add_u32 s35, s35, 128
    s_add_u32 s36, s36, 0x80000
    v_mfma_f32_16x16x32_bf16 a[236:239], v[60:63], v[16:19], a[236:239]
    s_add_u32 s37, s37, 0x70000
    v_mfma_f32_16x16x32_bf16 a[240:243], v[64:67], v[4:7], a[240:243]
    ds_read_b64_tr_b16 v[56:57], v78 offset:14528
    ds_read_b64_tr_b16 v[58:59], v78 offset:16320
    v_mfma_f32_16x16x32_bf16 a[244:247], v[64:67], v[8:11], a[244:247]
    v_mfma_f32_16x16x32_bf16 a[248:251], v[64:67], v[12:15], a[248:251]
    s_add_u32 s52, s52, 1
    s_cmp_eq_u32 s52, 16
    v_mfma_f32_16x16x32_bf16 a[252:255], v[64:67], v[16:19], a[252:255]
    s_cselect_b32 s52, 0, s52
    s_cselect_b32 s42, 0x800, 0
    s_sub_u32 s35, s35, s42
    s_waitcnt lgkmcnt(5)
    v_mfma_f32_16x16x32_bf16 v[160:163], v[36:39], v[4:7], v[160:163]
    ds_read_b64_tr_b16 v[60:61], v70 offset:8192
    ds_read_b64_tr_b16 v[62:63], v70 offset:9216
    v_mfma_f32_16x16x32_bf16 v[164:167], v[36:39], v[8:11], v[164:167]
    v_mfma_f32_16x16x32_bf16 v[168:171], v[36:39], v[12:15], v[168:171]
    s_cmp_eq_u32 s52, 0
    s_cselect_b32 s42, 0x800000, 0
    v_mfma_f32_16x16x32_bf16 v[172:175], v[36:39], v[16:19], v[172:175]
    s_cselect_b32 s43, 0x700000, 0
    s_sub_u32 s36, s36, s42
    s_sub_u32 s37, s37, s43
    v_mfma_f32_16x16x32_bf16 v[176:179], v[40:43], v[4:7], v[176:179]
    ds_read_b64_tr_b16 v[64:65], v71 offset:8192
    ds_read_b64_tr_b16 v[66:67], v71 offset:9216
    v_mfma_f32_16x16x32_bf16 v[180:183], v[40:43], v[8:11], v[180:183]
    v_mfma_f32_16x16x32_bf16 v[184:187], v[40:43], v[12:15], v[184:187]
    v_mfma_f32_16x16x32_bf16 v[188:191], v[40:43], v[16:19], v[188:191]
    v_mfma_f32_16x16x32_bf16 v[192:195], v[44:47], v[4:7], v[192:195]
    ds_read_b64_tr_b16 v[36:37], v72 offset:8192
    ds_read_b64_tr_b16 v[38:39], v72 offset:9216
    v_mfma_f32_16x16x32_bf16 v[196:199], v[44:47], v[8:11], v[196:199]
    v_mfma_f32_16x16x32_bf16 v[200:203], v[44:47], v[12:15], v[200:203]
    v_mfma_f32_16x16x32_bf16 v[204:207], v[44:47], v[16:19], v[204:207]
    v_mfma_f32_16x16x32_bf16 v[208:211], v[48:51], v[4:7], v[208:211]
    ds_read_b64_tr_b16 v[40:41], v73 offset:8192
    ds_read_b64_tr_b16 v[42:43], v73 offset:9216
    v_mfma_f32_16x16x32_bf16 v[212:215], v[48:51], v[8:11], v[212:215]
    v_mfma_f32_16x16x32_bf16 v[216:219], v[48:51], v[12:15], v[216:219]
    v_mfma_f32_16x16x32_bf16 v[220:223], v[48:51], v[16:19], v[220:223]
    s_waitcnt lgkmcnt(4)
    v_mfma_f32_16x16x32_bf16 v[224:227], v[52:55], v[4:7], v[224:227]
    ds_read_b64_tr_b16 v[44:45], v74 offset:8192
    ds_read_b64_tr_b16 v[46:47], v74 offset:9216
    v_mfma_f32_16x16x32_bf16 v[228:231], v[52:55], v[8:11], v[228:231]
    v_mfma_f32_16x16x32_bf16 v[232:235], v[52:55], v[12:15], v[232:235]
    v_mfma_f32_16x16x32_bf16 v[236:239], v[52:55], v[16:19], v[236:239]
    buffer_load_dword v101, v100, s[56:59], s51 offen
    buffer_load_dword v101, v100, s[60:63], s51 offen
    v_mfma_f32_16x16x32_bf16 v[240:243], v[56:59], v[4:7], v[240:243]
    ds_read_b64_tr_b16 v[48:49], v75 offset:8192
    ds_read_b64_tr_b16 v[50:51], v75 offset:9216
    v_mfma_f32_16x16x32_bf16 v[244:247], v[56:59], v[8:11], v[244:247]
    v_mfma_f32_16x16x32_bf16 v[248:251], v[56:59], v[12:15], v[248:251]
    v_mfma_f32_16x16x32_bf16 v[252:255], v[56:59], v[16:19], v[252:255]
    v_mfma_f32_16x16x32_bf16 a[0:3], v[60:63], v[20:23], a[0:3]
    ds_read_b64_tr_b16 v[52:53], v76 offset:8192
    ds_read_b64_tr_b16 v[54:55], v76 offset:9216
    v_mfma_f32_16x16x32_bf16 a[4:7], v[60:63], v[24:27], a[4:7]
    v_mfma_f32_16x16x32_bf16 a[8:11], v[60:63], v[28:31], a[8:11]
    v_mfma_f32_16x16x32_bf16 a[12:15], v[60:63], v[32:35], a[12:15]
    v_mfma_f32_16x16x32_bf16 a[16:19], v[64:67], v[20:23], a[16:19]
    ds_read_b64_tr_b16 v[56:57], v77 offset:8192
    ds_read_b64_tr_b16 v[58:59], v77 offset:9216
    v_mfma_f32_16x16x32_bf16 a[20:23], v[64:67], v[24:27], a[20:23]
    v_mfma_f32_16x16x32_bf16 a[24:27], v[64:67], v[28:31], a[24:27]
    v_mfma_f32_16x16x32_bf16 a[28:31], v[64:67], v[32:35], a[28:31]
    s_waitcnt lgkmcnt(4)
    v_mfma_f32_16x16x32_bf16 a[32:35], v[36:39], v[20:23], a[32:35]
    ds_read_b64_tr_b16 v[60:61], v78 offset:7168
    ds_read_b64_tr_b16 v[62:63], v78 offset:8960
    v_mfma_f32_16x16x32_bf16 a[36:39], v[36:39], v[24:27], a[36:39]
    v_mfma_f32_16x16x32_bf16 a[40:43], v[36:39], v[28:31], a[40:43]
    v_mfma_f32_16x16x32_bf16 a[44:47], v[36:39], v[32:35], a[44:47]
    v_mfma_f32_16x16x32_bf16 a[48:51], v[40:43], v[20:23], a[48:51]
    ds_read_b64_tr_b16 v[64:65], v78 offset:7200
    ds_read_b64_tr_b16 v[66:67], v78 offset:8992
    v_mfma_f32_16x16x32_bf16 a[52:55], v[40:43], v[24:27], a[52:55]
    v_mfma_f32_16x16x32_bf16 a[56:59], v[40:43], v[28:31], a[56:59]
    v_mfma_f32_16x16x32_bf16 a[60:63], v[40:43], v[32:35], a[60:63]
    v_mfma_f32_16x16x32_bf16 a[64:67], v[44:47], v[20:23], a[64:67]
    ds_read_b64_tr_b16 v[36:37], v78 offset:7232
    ds_read_b64_tr_b16 v[38:39], v78 offset:9024
    v_mfma_f32_16x16x32_bf16 a[68:71], v[44:47], v[24:27], a[68:71]
    v_mfma_f32_16x16x32_bf16 a[72:75], v[44:47], v[28:31], a[72:75]
    v_mfma_f32_16x16x32_bf16 a[76:79], v[44:47], v[32:35], a[76:79]
    v_mfma_f32_16x16x32_bf16 a[80:83], v[48:51], v[20:23], a[80:83]
    ds_read_b64_tr_b16 v[40:41], v78 offset:7264
    ds_read_b64_tr_b16 v[42:43], v78 offset:9056
    v_mfma_f32_16x16x32_bf16 a[84:87], v[48:51], v[24:27], a[84:87]
    v_mfma_f32_16x16x32_bf16 a[88:91], v[48:51], v[28:31], a[88:91]
    v_mfma_f32_16x16x32_bf16 a[92:95], v[48:51], v[32:35], a[92:95]
    s_waitcnt lgkmcnt(4)
    v_mfma_f32_16x16x32_bf16 a[96:99], v[52:55], v[20:23], a[96:99]
    ds_read_b64_tr_b16 v[44:45], v78 offset:7296
    ds_read_b64_tr_b16 v[46:47], v78 offset:9088
    v_mfma_f32_16x16x32_bf16 a[100:103], v[52:55], v[24:27], a[100:103]
    v_mfma_f32_16x16x32_bf16 a[104:107], v[52:55], v[28:31], a[104:107]
    v_mfma_f32_16x16x32_bf16 a[108:111], v[52:55], v[32:35], a[108:111]
    v_mfma_f32_16x16x32_bf16 a[112:115], v[56:59], v[20:23], a[112:115]
    ds_read_b64_tr_b16 v[48:49], v78 offset:7328
    ds_read_b64_tr_b16 v[50:51], v78 offset:9120
    v_mfma_f32_16x16x32_bf16 a[116:119], v[56:59], v[24:27], a[116:119]
    v_mfma_f32_16x16x32_bf16 a[120:123], v[56:59], v[28:31], a[120:123]
    v_mfma_f32_16x16x32_bf16 a[124:127], v[56:59], v[32:35], a[124:127]
    v_mfma_f32_16x16x32_bf16 a[128:131], v[60:63], v[20:23], a[128:131]
    ds_read_b64_tr_b16 v[52:53], v78 offset:7360
    ds_read_b64_tr_b16 v[54:55], v78 offset:9152
    v_mfma_f32_16x16x32_bf16 a[132:135], v[60:63], v[24:27], a[132:135]
    v_mfma_f32_16x16x32_bf16 a[136:139], v[60:63], v[28:31], a[136:139]
    v_mfma_f32_16x16x32_bf16 a[140:143], v[60:63], v[32:35], a[140:143]
    v_mfma_f32_16x16x32_bf16 a[144:147], v[64:67], v[20:23], a[144:147]
    ds_read_b64_tr_b16 v[56:57], v78 offset:21504
    ds_read_b64_tr_b16 v[58:59], v78 offset:23296
    v_mfma_f32_16x16x32_bf16 a[148:151], v[64:67], v[24:27], a[148:151]
    v_mfma_f32_16x16x32_bf16 a[152:155], v[64:67], v[28:31], a[152:155]
    v_mfma_f32_16x16x32_bf16 a[156:159], v[64:67], v[32:35], a[156:159]
    s_waitcnt lgkmcnt(4)
    v_mfma_f32_16x16x32_bf16 a[160:163], v[36:39], v[20:23], a[160:163]
    ds_read_b64_tr_b16 v[60:61], v78 offset:21536
    ds_read_b64_tr_b16 v[62:63], v78 offset:23328
    v_mfma_f32_16x16x32_bf16 a[164:167], v[36:39], v[24:27], a[164:167]
    v_mfma_f32_16x16x32_bf16 a[168:171], v[36:39], v[28:31], a[168:171]
    v_mfma_f32_16x16x32_bf16 a[172:175], v[36:39], v[32:35], a[172:175]
    v_mfma_f32_16x16x32_bf16 a[176:179], v[40:43], v[20:23], a[176:179]
    ds_read_b64_tr_b16 v[64:65], v78 offset:21568
    ds_read_b64_tr_b16 v[66:67], v78 offset:23360
    v_mfma_f32_16x16x32_bf16 a[180:183], v[40:43], v[24:27], a[180:183]
    v_mfma_f32_16x16x32_bf16 a[184:187], v[40:43], v[28:31], a[184:187]
    v_mfma_f32_16x16x32_bf16 a[188:191], v[40:43], v[32:35], a[188:191]
    v_mfma_f32_16x16x32_bf16 a[192:195], v[44:47], v[20:23], a[192:195]
    ds_read_b64_tr_b16 v[36:37], v78 offset:21600
    ds_read_b64_tr_b16 v[38:39], v78 offset:23392
    v_mfma_f32_16x16x32_bf16 a[196:199], v[44:47], v[24:27], a[196:199]
    v_mfma_f32_16x16x32_bf16 a[200:203], v[44:47], v[28:31], a[200:203]
    v_mfma_f32_16x16x32_bf16 a[204:207], v[44:47], v[32:35], a[204:207]
    v_mfma_f32_16x16x32_bf16 a[208:211], v[48:51], v[20:23], a[208:211]
    ds_read_b64_tr_b16 v[40:41], v78 offset:21632
    ds_read_b64_tr_b16 v[42:43], v78 offset:23424
    v_mfma_f32_16x16x32_bf16 a[212:215], v[48:51], v[24:27], a[212:215]
    v_mfma_f32_16x16x32_bf16 a[216:219], v[48:51], v[28:31], a[216:219]
    v_mfma_f32_16x16x32_bf16 a[220:223], v[48:51], v[32:35], a[220:223]
    s_waitcnt lgkmcnt(4)
    v_mfma_f32_16x16x32_bf16 a[224:227], v[52:55], v[20:23], a[224:227]
    ds_read_b64_tr_b16 v[44:45], v78 offset:21664
    ds_read_b64_tr_b16 v[46:47], v78 offset:23456
    v_mfma_f32_16x16x32_bf16 a[228:231], v[52:55], v[24:27], a[228:231]
    v_mfma_f32_16x16x32_bf16 a[232:235], v[52:55], v[28:31], a[232:235]
    v_mfma_f32_16x16x32_bf16 a[236:239], v[52:55], v[32:35], a[236:239]
    v_mfma_f32_16x16x32_bf16 a[240:243], v[56:59], v[20:23], a[240:243]
    ds_read_b64_tr_b16 v[48:49], v78 offset:21696
    ds_read_b64_tr_b16 v[50:51], v78 offset:23488
    v_mfma_f32_16x16x32_bf16 a[244:247], v[56:59], v[24:27], a[244:247]
    v_mfma_f32_16x16x32_bf16 a[248:251], v[56:59], v[28:31], a[248:251]
    v_mfma_f32_16x16x32_bf16 a[252:255], v[56:59], v[32:35], a[252:255]
    v_mfma_f32_16x16x32_bf16 v[160:163], v[60:63], v[20:23], v[160:163]
    s_waitcnt vmcnt(2) lgkmcnt(0)
    s_barrier
    ds_read_b64_tr_b16 v[52:53], v70 offset:16384
    ds_read_b64_tr_b16 v[54:55], v70 offset:17408
    v_mfma_f32_16x16x32_bf16 v[164:167], v[60:63], v[24:27], v[164:167]
    ds_read_b128 v[4:7], v68 offset:32768
    v_mfma_f32_16x16x32_bf16 v[168:171], v[60:63], v[28:31], v[168:171]
    v_mfma_f32_16x16x32_bf16 v[172:175], v[60:63], v[32:35], v[172:175]
    v_mfma_f32_16x16x32_bf16 v[176:179], v[64:67], v[20:23], v[176:179]
    ds_read_b64_tr_b16 v[56:57], v71 offset:16384
    ds_read_b64_tr_b16 v[58:59], v71 offset:17408
    ds_read_b128 v[8:11], v68 offset:34816
    v_mfma_f32_16x16x32_bf16 v[180:183], v[64:67], v[24:27], v[180:183]
    v_mfma_f32_16x16x32_bf16 v[184:187], v[64:67], v[28:31], v[184:187]
    s_add_u32 m0, s38, 0x0
    s_add_u32 s42, s35, 0x0
    v_mfma_f32_16x16x32_bf16 v[188:191], v[64:67], v[32:35], v[188:191]
    buffer_load_dwordx4 v80, s[8:11], s42 offen lds
    v_mfma_f32_16x16x32_bf16 v[192:195], v[36:39], v[20:23], v[192:195]
    ds_read_b64_tr_b16 v[60:61], v72 offset:16384
    ds_read_b64_tr_b16 v[62:63], v72 offset:17408
    ds_read_b128 v[12:15], v68 offset:36864
    v_mfma_f32_16x16x32_bf16 v[196:199], v[36:39], v[24:27], v[196:199]
    v_mfma_f32_16x16x32_bf16 v[200:203], v[36:39], v[28:31], v[200:203]
    s_add_u32 m0, s38, 0x400
    s_add_u32 s42, s35, 0x4000
    v_mfma_f32_16x16x32_bf16 v[204:207], v[36:39], v[32:35], v[204:207]
    buffer_load_dwordx4 v81, s[8:11], s42 offen lds
    v_mfma_f32_16x16x32_bf16 v[208:211], v[40:43], v[20:23], v[208:211]
    ds_read_b64_tr_b16 v[64:65], v73 offset:16384
    ds_read_b64_tr_b16 v[66:67], v73 offset:17408
    ds_read_b128 v[16:19], v68 offset:38912
    v_mfma_f32_16x16x32_bf16 v[212:215], v[40:43], v[24:27], v[212:215]
    v_mfma_f32_16x16x32_bf16 v[216:219], v[40:43], v[28:31], v[216:219]
    s_add_u32 m0, s38, 0x800
    s_add_u32 s42, s35, 0x8000
    v_mfma_f32_16x16x32_bf16 v[220:223], v[40:43], v[32:35], v[220:223]
    buffer_load_dwordx4 v80, s[8:11], s42 offen lds
    v_mfma_f32_16x16x32_bf16 v[224:227], v[44:47], v[20:23], v[224:227]
    ds_read_b64_tr_b16 v[36:37], v74 offset:16384
    ds_read_b64_tr_b16 v[38:39], v74 offset:17408
    v_mfma_f32_16x16x32_bf16 v[228:231], v[44:47], v[24:27], v[228:231]
    v_mfma_f32_16x16x32_bf16 v[232:235], v[44:47], v[28:31], v[232:235]
    s_add_u32 m0, s38, 0xc00
    s_add_u32 s42, s35, 0xc000
    v_mfma_f32_16x16x32_bf16 v[236:239], v[44:47], v[32:35], v[236:239]
    buffer_load_dwordx4 v81, s[8:11], s42 offen lds
    v_mfma_f32_16x16x32_bf16 v[240:243], v[48:51], v[20:23], v[240:243]
    ds_read_b64_tr_b16 v[40:41], v75 offset:16384
    ds_read_b64_tr_b16 v[42:43], v75 offset:17408
    v_mfma_f32_16x16x32_bf16 v[244:247], v[48:51], v[24:27], v[244:247]
    v_mfma_f32_16x16x32_bf16 v[248:251], v[48:51], v[28:31], v[248:251]
    s_add_u32 m0, s38, 0x1000
    s_add_u32 s42, s35, 0x10000
    v_mfma_f32_16x16x32_bf16 v[252:255], v[48:51], v[32:35], v[252:255]
    buffer_load_dwordx4 v80, s[8:11], s42 offen lds
    s_waitcnt lgkmcnt(5)
    s_waitcnt lgkmcnt(4)
    v_mfma_f32_16x16x32_bf16 a[0:3], v[52:55], v[4:7], a[0:3]
    ds_read_b64_tr_b16 v[44:45], v76 offset:16384
    ds_read_b64_tr_b16 v[46:47], v76 offset:17408
    v_mfma_f32_16x16x32_bf16 a[4:7], v[52:55], v[8:11], a[4:7]
    v_mfma_f32_16x16x32_bf16 a[8:11], v[52:55], v[12:15], a[8:11]
    s_add_u32 m0, s38, 0x1400
    s_add_u32 s42, s35, 0x14000
    v_mfma_f32_16x16x32_bf16 a[12:15], v[52:55], v[16:19], a[12:15]
    buffer_load_dwordx4 v81, s[8:11], s42 offen lds
    v_mfma_f32_16x16x32_bf16 a[16:19], v[56:59], v[4:7], a[16:19]
    ds_read_b64_tr_b16 v[48:49], v77 offset:16384
    ds_read_b64_tr_b16 v[50:51], v77 offset:17408
    v_mfma_f32_16x16x32_bf16 a[20:23], v[56:59], v[8:11], a[20:23]
    v_mfma_f32_16x16x32_bf16 a[24:27], v[56:59], v[12:15], a[24:27]
    s_add_u32 m0, s38, 0x1800
    s_add_u32 s42, s35, 0x18000
    v_mfma_f32_16x16x32_bf16 a[28:31], v[56:59], v[16:19], a[28:31]
    buffer_load_dwordx4 v80, s[8:11], s42 offen lds
    v_mfma_f32_16x16x32_bf16 a[32:35], v[60:63], v[4:7], a[32:35]
    ds_read_b64_tr_b16 v[52:53], v78 offset:28672
    ds_read_b64_tr_b16 v[54:55], v78 offset:30464
    v_mfma_f32_16x16x32_bf16 a[36:39], v[60:63], v[8:11], a[36:39]
    v_mfma_f32_16x16x32_bf16 a[40:43], v[60:63], v[12:15], a[40:43]
    s_add_u32 m0, s38, 0x1c00
    s_add_u32 s42, s35, 0x1c000
    v_mfma_f32_16x16x32_bf16 a[44:47], v[60:63], v[16:19], a[44:47]
    buffer_load_dwordx4 v81, s[8:11], s42 offen lds
    v_mfma_f32_16x16x32_bf16 a[48:51], v[64:67], v[4:7], a[48:51]
    ds_read_b64_tr_b16 v[56:57], v78 offset:28704
    ds_read_b64_tr_b16 v[58:59], v78 offset:30496
    v_mfma_f32_16x16x32_bf16 a[52:55], v[64:67], v[8:11], a[52:55]
    v_mfma_f32_16x16x32_bf16 a[56:59], v[64:67], v[12:15], a[56:59]
    s_add_u32 m0, s39, 0x0
    s_add_u32 s42, s36, 0x0
    v_mfma_f32_16x16x32_bf16 a[60:63], v[64:67], v[16:19], a[60:63]
    buffer_load_dwordx4 v82, s[12:15], s42 offen lds
    s_waitcnt lgkmcnt(4)
    v_mfma_f32_16x16x32_bf16 a[64:67], v[36:39], v[4:7], a[64:67]
    ds_read_b64_tr_b16 v[60:61], v78 offset:28736
    ds_read_b64_tr_b16 v[62:63], v78 offset:30528
    v_mfma_f32_16x16x32_bf16 a[68:71], v[36:39], v[8:11], a[68:71]
    v_mfma_f32_16x16x32_bf16 a[72:75], v[36:39], v[12:15], a[72:75]
    s_add_u32 m0, s39, 0x400
    s_add_u32 s42, s36, 0x8000
    v_mfma_f32_16x16x32_bf16 a[76:79], v[36:39], v[16:19], a[76:79]
    buffer_load_dwordx4 v82, s[12:15], s42 offen lds
    v_mfma_f32_16x16x32_bf16 a[80:83], v[40:43], v[4:7], a[80:83]
    ds_read_b64_tr_b16 v[64:65], v78 offset:28768
    ds_read_b64_tr_b16 v[66:67], v78 offset:30560
    v_mfma_f32_16x16x32_bf16 a[84:87], v[40:43], v[8:11], a[84:87]
    v_mfma_f32_16x16x32_bf16 a[88:91], v[40:43], v[12:15], a[88:91]
    s_add_u32 m0, s39, 0x800
    s_add_u32 s42, s36, 0x10000
    v_mfma_f32_16x16x32_bf16 a[92:95], v[40:43], v[16:19], a[92:95]
    buffer_load_dwordx4 v83, s[12:15], s42 offen lds
    v_mfma_f32_16x16x32_bf16 a[96:99], v[44:47], v[4:7], a[96:99]
    ds_read_b64_tr_b16 v[36:37], v78 offset:28800
    ds_read_b64_tr_b16 v[38:39], v78 offset:30592
    v_mfma_f32_16x16x32_bf16 a[100:103], v[44:47], v[8:11], a[100:103]
    v_mfma_f32_16x16x32_bf16 a[104:107], v[44:47], v[12:15], a[104:107]
    s_add_u32 m0, s39, 0xc00
    s_add_u32 s42, s36, 0x18000
    v_mfma_f32_16x16x32_bf16 a[108:111], v[44:47], v[16:19], a[108:111]
    buffer_load_dwordx4 v83, s[12:15], s42 offen lds
    v_mfma_f32_16x16x32_bf16 a[112:115], v[48:51], v[4:7], a[112:115]
    ds_read_b64_tr_b16 v[40:41], v78 offset:28832
    ds_read_b64_tr_b16 v[42:43], v78 offset:30624
    v_mfma_f32_16x16x32_bf16 a[116:119], v[48:51], v[8:11], a[116:119]
    v_mfma_f32_16x16x32_bf16 a[120:123], v[48:51], v[12:15], a[120:123]
    s_add_u32 m0, s40, 0x0
    s_nop 0
    v_mfma_f32_16x16x32_bf16 a[124:127], v[48:51], v[16:19], a[124:127]
    buffer_load_dwordx4 v84, s[16:19], s37 offen lds
    s_waitcnt lgkmcnt(4)
    v_mfma_f32_16x16x32_bf16 a[128:131], v[52:55], v[4:7], a[128:131]
    ds_read_b64_tr_b16 v[44:45], v78 offset:28864
    ds_read_b64_tr_b16 v[46:47], v78 offset:30656
    v_mfma_f32_16x16x32_bf16 a[132:135], v[52:55], v[8:11], a[132:135]
    v_mfma_f32_16x16x32_bf16 a[136:139], v[52:55], v[12:15], a[136:139]
    s_add_u32 m0, s40, 0x400
    s_nop 0
    v_mfma_f32_16x16x32_bf16 a[140:143], v[52:55], v[16:19], a[140:143]
    buffer_load_dwordx4 v85, s[16:19], s37 offen lds
    v_mfma_f32_16x16x32_bf16 a[144:147], v[56:59], v[4:7], a[144:147]
    ds_read_b64_tr_b16 v[48:49], v78 offset:43008
    ds_read_b64_tr_b16 v[50:51], v78 offset:44800
    v_mfma_f32_16x16x32_bf16 a[148:151], v[56:59], v[8:11], a[148:151]
    v_mfma_f32_16x16x32_bf16 a[152:155], v[56:59], v[12:15], a[152:155]
    s_add_u32 m0, s40, 0x800
    s_nop 0
    v_mfma_f32_16x16x32_bf16 a[156:159], v[56:59], v[16:19], a[156:159]
    buffer_load_dwordx4 v86, s[16:19], s37 offen lds
    v_mfma_f32_16x16x32_bf16 a[160:163], v[60:63], v[4:7], a[160:163]
    ds_read_b64_tr_b16 v[52:53], v78 offset:43040
    ds_read_b64_tr_b16 v[54:55], v78 offset:44832
    ds_read_b128 v[20:23], v69 offset:32768
    v_mfma_f32_16x16x32_bf16 a[164:167], v[60:63], v[8:11], a[164:167]
    v_mfma_f32_16x16x32_bf16 a[168:171], v[60:63], v[12:15], a[168:171]
    s_add_u32 m0, s40, 0xc00
    s_nop 0
    v_mfma_f32_16x16x32_bf16 a[172:175], v[60:63], v[16:19], a[172:175]
    buffer_load_dwordx4 v87, s[16:19], s37 offen lds
    v_mfma_f32_16x16x32_bf16 a[176:179], v[64:67], v[4:7], a[176:179]
    ds_read_b64_tr_b16 v[56:57], v78 offset:43072
    ds_read_b64_tr_b16 v[58:59], v78 offset:44864
    ds_read_b128 v[24:27], v69 offset:34816
    v_mfma_f32_16x16x32_bf16 a[180:183], v[64:67], v[8:11], a[180:183]
    v_mfma_f32_16x16x32_bf16 a[184:187], v[64:67], v[12:15], a[184:187]
    s_add_u32 m0, s40, 0x1000
    s_nop 0
    v_mfma_f32_16x16x32_bf16 a[188:191], v[64:67], v[16:19], a[188:191]
    buffer_load_dwordx4 v88, s[16:19], s37 offen lds
    s_waitcnt lgkmcnt(6)
    v_mfma_f32_16x16x32_bf16 a[192:195], v[36:39], v[4:7], a[192:195]
    ds_read_b64_tr_b16 v[60:61], v78 offset:43104
    ds_read_b64_tr_b16 v[62:63], v78 offset:44896
    ds_read_b128 v[28:31], v69 offset:36864
    v_mfma_f32_16x16x32_bf16 a[196:199], v[36:39], v[8:11], a[196:199]
    v_mfma_f32_16x16x32_bf16 a[200:203], v[36:39], v[12:15], a[200:203]
    s_add_u32 m0, s40, 0x1400
    s_nop 0
    v_mfma_f32_16x16x32_bf16 a[204:207], v[36:39], v[16:19], a[204:207]
    buffer_load_dwordx4 v89, s[16:19], s37 offen lds
    v_mfma_f32_16x16x32_bf16 a[208:211], v[40:43], v[4:7], a[208:211]
    ds_read_b64_tr_b16 v[64:65], v78 offset:43136
    ds_read_b64_tr_b16 v[66:67], v78 offset:44928
    ds_read_b128 v[32:35], v69 offset:38912
    v_mfma_f32_16x16x32_bf16 a[212:215], v[40:43], v[8:11], a[212:215]
    v_mfma_f32_16x16x32_bf16 a[216:219], v[40:43], v[12:15], a[216:219]
    s_add_u32 m0, s40, 0x1800
    s_nop 0
    v_mfma_f32_16x16x32_bf16 a[220:223], v[40:43], v[16:19], a[220:223]
    buffer_load_dwordx4 v90, s[16:19], s37 offen lds
    v_mfma_f32_16x16x32_bf16 a[224:227], v[44:47], v[4:7], a[224:227]
    ds_read_b64_tr_b16 v[36:37], v78 offset:43168
    ds_read_b64_tr_b16 v[38:39], v78 offset:44960
    v_mfma_f32_16x16x32_bf16 a[228:231], v[44:47], v[8:11], a[228:231]
    v_mfma_f32_16x16x32_bf16 a[232:235], v[44:47], v[12:15], a[232:235]
    s_add_u32 s35, s35, 128
    s_add_u32 s36, s36, 0x80000
    v_mfma_f32_16x16x32_bf16 a[236:239], v[44:47], v[16:19], a[236:239]
    s_add_u32 s37, s37, 0x70000
    v_mfma_f32_16x16x32_bf16 a[240:243], v[48:51], v[4:7], a[240:243]
    ds_read_b64_tr_b16 v[40:41], v78 offset:43200
    ds_read_b64_tr_b16 v[42:43], v78 offset:44992
    v_mfma_f32_16x16x32_bf16 a[244:247], v[48:51], v[8:11], a[244:247]
    v_mfma_f32_16x16x32_bf16 a[248:251], v[48:51], v[12:15], a[248:251]
    s_add_u32 s52, s52, 1
    s_cmp_eq_u32 s52, 16
    v_mfma_f32_16x16x32_bf16 a[252:255], v[48:51], v[16:19], a[252:255]
    s_cselect_b32 s52, 0, s52
    s_cselect_b32 s42, 0x800, 0
    s_sub_u32 s35, s35, s42
    s_waitcnt lgkmcnt(5)
    v_mfma_f32_16x16x32_bf16 v[160:163], v[52:55], v[4:7], v[160:163]
    ds_read_b64_tr_b16 v[44:45], v70 offset:24576
    ds_read_b64_tr_b16 v[46:47], v70 offset:25600
    v_mfma_f32_16x16x32_bf16 v[164:167], v[52:55], v[8:11], v[164:167]
    v_mfma_f32_16x16x32_bf16 v[168:171], v[52:55], v[12:15], v[168:171]
    s_cmp_eq_u32 s52, 0
    s_cselect_b32 s42, 0x800000, 0
    v_mfma_f32_16x16x32_bf16 v[172:175], v[52:55], v[16:19], v[172:175]
    s_cselect_b32 s43, 0x700000, 0
    s_sub_u32 s36, s36, s42
    s_sub_u32 s37, s37, s43
    v_mfma_f32_16x16x32_bf16 v[176:179], v[56:59], v[4:7], v[176:179]
    ds_read_b64_tr_b16 v[48:49], v71 offset:24576
    ds_read_b64_tr_b16 v[50:51], v71 offset:25600
    v_mfma_f32_16x16x32_bf16 v[180:183], v[56:59], v[8:11], v[180:183]
    v_mfma_f32_16x16x32_bf16 v[184:187], v[56:59], v[12:15], v[184:187]
    v_mfma_f32_16x16x32_bf16 v[188:191], v[56:59], v[16:19], v[188:191]
    v_mfma_f32_16x16x32_bf16 v[192:195], v[60:63], v[4:7], v[192:195]
    ds_read_b64_tr_b16 v[52:53], v72 offset:24576
    ds_read_b64_tr_b16 v[54:55], v72 offset:25600
    v_mfma_f32_16x16x32_bf16 v[196:199], v[60:63], v[8:11], v[196:199]
    v_mfma_f32_16x16x32_bf16 v[200:203], v[60:63], v[12:15], v[200:203]
    v_mfma_f32_16x16x32_bf16 v[204:207], v[60:63], v[16:19], v[204:207]
    v_mfma_f32_16x16x32_bf16 v[208:211], v[64:67], v[4:7], v[208:211]
    ds_read_b64_tr_b16 v[56:57], v73 offset:24576
    ds_read_b64_tr_b16 v[58:59], v73 offset:25600
    v_mfma_f32_16x16x32_bf16 v[212:215], v[64:67], v[8:11], v[212:215]
    v_mfma_f32_16x16x32_bf16 v[216:219], v[64:67], v[12:15], v[216:219]
    v_mfma_f32_16x16x32_bf16 v[220:223], v[64:67], v[16:19], v[220:223]
    s_waitcnt lgkmcnt(4)
    v_mfma_f32_16x16x32_bf16 v[224:227], v[36:39], v[4:7], v[224:227]
    ds_read_b64_tr_b16 v[60:61], v74 offset:24576
    ds_read_b64_tr_b16 v[62:63], v74 offset:25600
    v_mfma_f32_16x16x32_bf16 v[228:231], v[36:39], v[8:11], v[228:231]
    v_mfma_f32_16x16x32_bf16 v[232:235], v[36:39], v[12:15], v[232:235]
    v_mfma_f32_16x16x32_bf16 v[236:239], v[36:39], v[16:19], v[236:239]
    v_mfma_f32_16x16x32_bf16 v[240:243], v[40:43], v[4:7], v[240:243]
    ds_read_b64_tr_b16 v[64:65], v75 offset:24576
    ds_read_b64_tr_b16 v[66:67], v75 offset:25600
    v_mfma_f32_16x16x32_bf16 v[244:247], v[40:43], v[8:11], v[244:247]
    v_mfma_f32_16x16x32_bf16 v[248:251], v[40:43], v[12:15], v[248:251]
    v_mfma_f32_16x16x32_bf16 v[252:255], v[40:43], v[16:19], v[252:255]
    v_mfma_f32_16x16x32_bf16 a[0:3], v[44:47], v[20:23], a[0:3]
    ds_read_b64_tr_b16 v[36:37], v76 offset:24576
    ds_read_b64_tr_b16 v[38:39], v76 offset:25600
    v_mfma_f32_16x16x32_bf16 a[4:7], v[44:47], v[24:27], a[4:7]
    v_mfma_f32_16x16x32_bf16 a[8:11], v[44:47], v[28:31], a[8:11]
    v_mfma_f32_16x16x32_bf16 a[12:15], v[44:47], v[32:35], a[12:15]
    v_mfma_f32_16x16x32_bf16 a[16:19], v[48:51], v[20:23], a[16:19]
    ds_read_b64_tr_b16 v[40:41], v77 offset:24576
    ds_read_b64_tr_b16 v[42:43], v77 offset:25600
    v_mfma_f32_16x16x32_bf16 a[20:23], v[48:51], v[24:27], a[20:23]
    v_mfma_f32_16x16x32_bf16 a[24:27], v[48:51], v[28:31], a[24:27]
    v_mfma_f32_16x16x32_bf16 a[28:31], v[48:51], v[32:35], a[28:31]
    s_waitcnt lgkmcnt(4)
    v_mfma_f32_16x16x32_bf16 a[32:35], v[52:55], v[20:23], a[32:35]
    ds_read_b64_tr_b16 v[44:45], v78 offset:35840
    ds_read_b64_tr_b16 v[46:47], v78 offset:37632
    v_mfma_f32_16x16x32_bf16 a[36:39], v[52:55], v[24:27], a[36:39]
    v_mfma_f32_16x16x32_bf16 a[40:43], v[52:55], v[28:31], a[40:43]
    v_mfma_f32_16x16x32_bf16 a[44:47], v[52:55], v[32:35], a[44:47]
    v_mfma_f32_16x16x32_bf16 a[48:51], v[56:59], v[20:23], a[48:51]
    ds_read_b64_tr_b16 v[48:49], v78 offset:35872
    ds_read_b64_tr_b16 v[50:51], v78 offset:37664
    v_mfma_f32_16x16x32_bf16 a[52:55], v[56:59], v[24:27], a[52:55]
    v_mfma_f32_16x16x32_bf16 a[56:59], v[56:59], v[28:31], a[56:59]
    v_mfma_f32_16x16x32_bf16 a[60:63], v[56:59], v[32:35], a[60:63]
    v_mfma_f32_16x16x32_bf16 a[64:67], v[60:63], v[20:23], a[64:67]
    ds_read_b64_tr_b16 v[52:53], v78 offset:35904
    ds_read_b64_tr_b16 v[54:55], v78 offset:37696
    v_mfma_f32_16x16x32_bf16 a[68:71], v[60:63], v[24:27], a[68:71]
    v_mfma_f32_16x16x32_bf16 a[72:75], v[60:63], v[28:31], a[72:75]
    v_mfma_f32_16x16x32_bf16 a[76:79], v[60:63], v[32:35], a[76:79]
    v_mfma_f32_16x16x32_bf16 a[80:83], v[64:67], v[20:23], a[80:83]
    ds_read_b64_tr_b16 v[56:57], v78 offset:35936
    ds_read_b64_tr_b16 v[58:59], v78 offset:37728
    v_mfma_f32_16x16x32_bf16 a[84:87], v[64:67], v[24:27], a[84:87]
    v_mfma_f32_16x16x32_bf16 a[88:91], v[64:67], v[28:31], a[88:91]
    v_mfma_f32_16x16x32_bf16 a[92:95], v[64:67], v[32:35], a[92:95]
    s_waitcnt lgkmcnt(4)
    v_mfma_f32_16x16x32_bf16 a[96:99], v[36:39], v[20:23], a[96:99]
    ds_read_b64_tr_b16 v[60:61], v78 offset:35968
    ds_read_b64_tr_b16 v[62:63], v78 offset:37760
    v_mfma_f32_16x16x32_bf16 a[100:103], v[36:39], v[24:27], a[100:103]
    v_mfma_f32_16x16x32_bf16 a[104:107], v[36:39], v[28:31], a[104:107]
    v_mfma_f32_16x16x32_bf16 a[108:111], v[36:39], v[32:35], a[108:111]
    v_mfma_f32_16x16x32_bf16 a[112:115], v[40:43], v[20:23], a[112:115]
    ds_read_b64_tr_b16 v[64:65], v78 offset:36000
    ds_read_b64_tr_b16 v[66:67], v78 offset:37792
    v_mfma_f32_16x16x32_bf16 a[116:119], v[40:43], v[24:27], a[116:119]
    v_mfma_f32_16x16x32_bf16 a[120:123], v[40:43], v[28:31], a[120:123]
    v_mfma_f32_16x16x32_bf16 a[124:127], v[40:43], v[32:35], a[124:127]
    v_mfma_f32_16x16x32_bf16 a[128:131], v[44:47], v[20:23], a[128:131]
    ds_read_b64_tr_b16 v[36:37], v78 offset:36032
    ds_read_b64_tr_b16 v[38:39], v78 offset:37824
    v_mfma_f32_16x16x32_bf16 a[132:135], v[44:47], v[24:27], a[132:135]
    v_mfma_f32_16x16x32_bf16 a[136:139], v[44:47], v[28:31], a[136:139]
    v_mfma_f32_16x16x32_bf16 a[140:143], v[44:47], v[32:35], a[140:143]
    v_mfma_f32_16x16x32_bf16 a[144:147], v[48:51], v[20:23], a[144:147]
    ds_read_b64_tr_b16 v[40:41], v78 offset:50176
    ds_read_b64_tr_b16 v[42:43], v78 offset:51968
    v_mfma_f32_16x16x32_bf16 a[148:151], v[48:51], v[24:27], a[148:151]
    v_mfma_f32_16x16x32_bf16 a[152:155], v[48:51], v[28:31], a[152:155]
    v_mfma_f32_16x16x32_bf16 a[156:159], v[48:51], v[32:35], a[156:159]
    s_waitcnt lgkmcnt(4)
    v_mfma_f32_16x16x32_bf16 a[160:163], v[52:55], v[20:23], a[160:163]
    ds_read_b64_tr_b16 v[44:45], v78 offset:50208
    ds_read_b64_tr_b16 v[46:47], v78 offset:52000
    v_mfma_f32_16x16x32_bf16 a[164:167], v[52:55], v[24:27], a[164:167]
    v_mfma_f32_16x16x32_bf16 a[168:171], v[52:55], v[28:31], a[168:171]
    v_mfma_f32_16x16x32_bf16 a[172:175], v[52:55], v[32:35], a[172:175]
    v_mfma_f32_16x16x32_bf16 a[176:179], v[56:59], v[20:23], a[176:179]
    ds_read_b64_tr_b16 v[48:49], v78 offset:50240
    ds_read_b64_tr_b16 v[50:51], v78 offset:52032
    v_mfma_f32_16x16x32_bf16 a[180:183], v[56:59], v[24:27], a[180:183]
    v_mfma_f32_16x16x32_bf16 a[184:187], v[56:59], v[28:31], a[184:187]
    v_mfma_f32_16x16x32_bf16 a[188:191], v[56:59], v[32:35], a[188:191]
    v_mfma_f32_16x16x32_bf16 a[192:195], v[60:63], v[20:23], a[192:195]
    ds_read_b64_tr_b16 v[52:53], v78 offset:50272
    ds_read_b64_tr_b16 v[54:55], v78 offset:52064
    v_mfma_f32_16x16x32_bf16 a[196:199], v[60:63], v[24:27], a[196:199]
    v_mfma_f32_16x16x32_bf16 a[200:203], v[60:63], v[28:31], a[200:203]
    v_mfma_f32_16x16x32_bf16 a[204:207], v[60:63], v[32:35], a[204:207]
    v_mfma_f32_16x16x32_bf16 a[208:211], v[64:67], v[20:23], a[208:211]
    ds_read_b64_tr_b16 v[56:57], v78 offset:50304
    ds_read_b64_tr_b16 v[58:59], v78 offset:52096
    v_mfma_f32_16x16x32_bf16 a[212:215], v[64:67], v[24:27], a[212:215]
    v_mfma_f32_16x16x32_bf16 a[216:219], v[64:67], v[28:31], a[216:219]
    v_mfma_f32_16x16x32_bf16 a[220:223], v[64:67], v[32:35], a[220:223]
    s_waitcnt lgkmcnt(4)
    v_mfma_f32_16x16x32_bf16 a[224:227], v[36:39], v[20:23], a[224:227]
    ds_read_b64_tr_b16 v[60:61], v78 offset:50336
    ds_read_b64_tr_b16 v[62:63], v78 offset:52128
    v_mfma_f32_16x16x32_bf16 a[228:231], v[36:39], v[24:27], a[228:231]
    v_mfma_f32_16x16x32_bf16 a[232:235], v[36:39], v[28:31], a[232:235]
    v_mfma_f32_16x16x32_bf16 a[236:239], v[36:39], v[32:35], a[236:239]
    v_mfma_f32_16x16x32_bf16 a[240:243], v[40:43], v[20:23], a[240:243]
    ds_read_b64_tr_b16 v[64:65], v78 offset:50368
    ds_read_b64_tr_b16 v[66:67], v78 offset:52160
    v_mfma_f32_16x16x32_bf16 a[244:247], v[40:43], v[24:27], a[244:247]
    v_mfma_f32_16x16x32_bf16 a[248:251], v[40:43], v[28:31], a[248:251]
    v_mfma_f32_16x16x32_bf16 a[252:255], v[40:43], v[32:35], a[252:255]
    v_mfma_f32_16x16x32_bf16 v[160:163], v[44:47], v[20:23], v[160:163]
    s_waitcnt vmcnt(0) lgkmcnt(0)
    s_barrier
    ds_read_b64_tr_b16 v[36:37], v70 offset:0
    ds_read_b64_tr_b16 v[38:39], v70 offset:1024
    v_mfma_f32_16x16x32_bf16 v[164:167], v[44:47], v[24:27], v[164:167]
    ds_read_b128 v[4:7], v68 offset:0
    v_mfma_f32_16x16x32_bf16 v[168:171], v[44:47], v[28:31], v[168:171]
    v_mfma_f32_16x16x32_bf16 v[172:175], v[44:47], v[32:35], v[172:175]
    v_mfma_f32_16x16x32_bf16 v[176:179], v[48:51], v[20:23], v[176:179]
    ds_read_b64_tr_b16 v[40:41], v71 offset:0
    ds_read_b64_tr_b16 v[42:43], v71 offset:1024
    ds_read_b128 v[8:11], v68 offset:2048
    v_mfma_f32_16x16x32_bf16 v[180:183], v[48:51], v[24:27], v[180:183]
    v_mfma_f32_16x16x32_bf16 v[184:187], v[48:51], v[28:31], v[184:187]
    s_add_u32 m0, s38, 0x8000
    s_add_u32 s42, s35, 0x0
    v_mfma_f32_16x16x32_bf16 v[188:191], v[48:51], v[32:35], v[188:191]
    buffer_load_dwordx4 v80, s[8:11], s42 offen lds
    v_mfma_f32_16x16x32_bf16 v[192:195], v[52:55], v[20:23], v[192:195]
    ds_read_b64_tr_b16 v[44:45], v72 offset:0
    ds_read_b64_tr_b16 v[46:47], v72 offset:1024
    ds_read_b128 v[12:15], v68 offset:4096
    v_mfma_f32_16x16x32_bf16 v[196:199], v[52:55], v[24:27], v[196:199]
    v_mfma_f32_16x16x32_bf16 v[200:203], v[52:55], v[28:31], v[200:203]
    s_add_u32 m0, s38, 0x8400
    s_add_u32 s42, s35, 0x4000
    v_mfma_f32_16x16x32_bf16 v[204:207], v[52:55], v[32:35], v[204:207]
    buffer_load_dwordx4 v81, s[8:11], s42 offen lds
    v_mfma_f32_16x16x32_bf16 v[208:211], v[56:59], v[20:23], v[208:211]
    ds_read_b64_tr_b16 v[48:49], v73 offset:0
    ds_read_b64_tr_b16 v[50:51], v73 offset:1024
    ds_read_b128 v[16:19], v68 offset:6144
    v_mfma_f32_16x16x32_bf16 v[212:215], v[56:59], v[24:27], v[212:215]
    v_mfma_f32_16x16x32_bf16 v[216:219], v[56:59], v[28:31], v[216:219]
    s_add_u32 m0, s38, 0x8800
    s_add_u32 s42, s35, 0x8000
    v_mfma_f32_16x16x32_bf16 v[220:223], v[56:59], v[32:35], v[220:223]
    buffer_load_dwordx4 v80, s[8:11], s42 offen lds
    v_mfma_f32_16x16x32_bf16 v[224:227], v[60:63], v[20:23], v[224:227]
    ds_read_b64_tr_b16 v[52:53], v74 offset:0
    ds_read_b64_tr_b16 v[54:55], v74 offset:1024
    v_mfma_f32_16x16x32_bf16 v[228:231], v[60:63], v[24:27], v[228:231]
    v_mfma_f32_16x16x32_bf16 v[232:235], v[60:63], v[28:31], v[232:235]
    s_add_u32 m0, s38, 0x8c00
    s_add_u32 s42, s35, 0xc000
    v_mfma_f32_16x16x32_bf16 v[236:239], v[60:63], v[32:35], v[236:239]
    buffer_load_dwordx4 v81, s[8:11], s42 offen lds
    v_mfma_f32_16x16x32_bf16 v[240:243], v[64:67], v[20:23], v[240:243]
    ds_read_b64_tr_b16 v[56:57], v75 offset:0
    ds_read_b64_tr_b16 v[58:59], v75 offset:1024
    v_mfma_f32_16x16x32_bf16 v[244:247], v[64:67], v[24:27], v[244:247]
    v_mfma_f32_16x16x32_bf16 v[248:251], v[64:67], v[28:31], v[248:251]
    s_add_u32 m0, s38, 0x9000
    s_add_u32 s42, s35, 0x10000
    v_mfma_f32_16x16x32_bf16 v[252:255], v[64:67], v[32:35], v[252:255]
    buffer_load_dwordx4 v80, s[8:11], s42 offen lds
    s_add_u32 s41, s41, 1
    s_cmp_eq_u32 s41, 6
    s_cselect_b32 s51, 0, 0x80000
    s_cmp_lt_u32 s41, 8
    s_cbranch_scc1 g1_loop
    s_waitcnt vmcnt(0) lgkmcnt(0)
    s_barrier
    s_add_u32 s43, s78, 0x0
    s_add_u32 m0, s78, 0x0
    s_nop 0
    buffer_load_dwordx4 v116, s[56:59], s43 offen offset:0 lds
    buffer_load_dwordx4 v117, s[56:59], s43 offen offset:1024 lds
    buffer_load_dwordx4 v118, s[56:59], s43 offen offset:2048 lds
    buffer_load_dwordx4 v119, s[56:59], s43 offen offset:3072 lds
    s_add_u32 s43, s78, 0x4000
    s_add_u32 m0, s78, 0x4000
    s_nop 0
    buffer_load_dwordx4 v116, s[56:59], s43 offen offset:0 lds
    buffer_load_dwordx4 v117, s[56:59], s43 offen offset:1024 lds
    buffer_load_dwordx4 v118, s[56:59], s43 offen offset:2048 lds
    buffer_load_dwordx4 v119, s[56:59], s43 offen offset:3072 lds
    s_add_u32 s43, s78, 0x0
    s_add_u32 m0, s78, 0x10000
    s_nop 0
    buffer_load_dwordx4 v120, s[60:63], s43 offen offset:0 lds
    buffer_load_dwordx4 v121, s[60:63], s43 offen offset:1024 lds
    buffer_load_dwordx4 v120, s[60:63], s43 offen offset:2048 lds
    buffer_load_dwordx4 v121, s[60:63], s43 offen offset:3072 lds
    s_nop 7
    s_nop 7
    v_and_b32 v95, 1, v92
    v_lshrrev_b32 v96, 1, v92
    v_lshlrev_b32 v95, 5, v95
    v_lshl_add_u32 v95, v96, 4, v95
    v_lshl_add_u32 v64, v3, 13, v95
    v_mul_u32_u24 v96, s45, v3
    v_add_u32 v65, v96, v95
    v_lshl_add_u32 v66, v92, 3, v96
    s_lshl_b32 s47, s46, 13
    s_lshl_b32 s42, s34, 8
    s_add_u32 s47, s47, s42
    s_mul_i32 s48, s46, 7168
    s_mul_i32 s42, s34, 224
    s_add_u32 s48, s48, s42
    s_mov_b32 s49, 0x3e0293ee
    v_accvgpr_read_b32 v4, a128
    v_accvgpr_read_b32 v5, a129
    v_accvgpr_read_b32 v6, a130
    v_accvgpr_read_b32 v7, a131
    v_accvgpr_read_b32 v52, a240
    v_accvgpr_read_b32 v53, a241
    v_accvgpr_read_b32 v54, a242
    v_accvgpr_read_b32 v55, a243
    v_max_f32 v4, 0, v4
    v_max_f32 v5, 0, v5
    v_max_f32 v6, 0, v6
    v_max_f32 v7, 0, v7
    v_mul_f32 v4, v4, v52
    v_mul_f32 v5, v5, v53
    v_mul_f32 v6, v6, v54
    v_mul_f32 v7, v7, v55
    v_accvgpr_read_b32 v8, a144
    v_accvgpr_read_b32 v9, a145
    v_accvgpr_read_b32 v10, a146
    v_accvgpr_read_b32 v11, a147
    v_mov_b32 v56, v160
    v_mov_b32 v57, v161
    v_mov_b32 v58, v162
    v_mov_b32 v59, v163
    v_max_f32 v8, 0, v8
    v_max_f32 v9, 0, v9
    v_max_f32 v10, 0, v10
    v_max_f32 v11, 0, v11
    v_mul_f32 v8, v8, v56
    v_mul_f32 v9, v9, v57
    v_mul_f32 v10, v10, v58
    v_mul_f32 v11, v11, v59
    v_cvt_pk_bf16_f32 v12, v4, v5
    v_cvt_pk_bf16_f32 v13, v6, v7
    v_cvt_pk_bf16_f32 v14, v8, v9
    v_cvt_pk_bf16_f32 v15, v10, v11
    s_nop 1
    v_permlane16_swap_b32 v12, v14
    v_permlane16_swap_b32 v13, v15
    buffer_store_dwordx4 v[12:15], v65, s[24:27], s48 offen offset:0
    s_add_u32 s43, s78, 0x8000
    s_add_u32 m0, s78, 0x8000
    s_nop 0
    buffer_load_dwordx4 v116, s[56:59], s43 offen offset:0 lds
    buffer_load_dwordx4 v117, s[56:59], s43 offen offset:1024 lds
    v_accvgpr_read_b32 v16, a160
    v_accvgpr_read_b32 v17, a161
    v_accvgpr_read_b32 v18, a162
    v_accvgpr_read_b32 v19, a163
    v_mov_b32 v52, v176
    v_mov_b32 v53, v177
    v_mov_b32 v54, v178
    v_mov_b32 v55, v179
    v_max_f32 v16, 0, v16
    v_max_f32 v17, 0, v17
    v_max_f32 v18, 0, v18
    v_max_f32 v19, 0, v19
    v_mul_f32 v16, v16, v52
    v_mul_f32 v17, v17, v53
    v_mul_f32 v18, v18, v54
    v_mul_f32 v19, v19, v55
    v_accvgpr_read_b32 v20, a176
    v_accvgpr_read_b32 v21, a177
    v_accvgpr_read_b32 v22, a178
    v_accvgpr_read_b32 v23, a179
    v_mov_b32 v56, v192
    v_mov_b32 v57, v193
    v_mov_b32 v58, v194
    v_mov_b32 v59, v195
    v_max_f32 v20, 0, v20
    v_max_f32 v21, 0, v21
    v_max_f32 v22, 0, v22
    v_max_f32 v23, 0, v23
    v_mul_f32 v20, v20, v56
    v_mul_f32 v21, v21, v57
    v_mul_f32 v22, v22, v58
    v_mul_f32 v23, v23, v59
    v_cvt_pk_bf16_f32 v24, v16, v17
    v_cvt_pk_bf16_f32 v25, v18, v19
    v_cvt_pk_bf16_f32 v26, v20, v21
    v_cvt_pk_bf16_f32 v27, v22, v23
    s_nop 1
    v_permlane16_swap_b32 v24, v26
    v_permlane16_swap_b32 v25, v27
    buffer_store_dwordx4 v[24:27], v65, s[24:27], s48 offen offset:64
    buffer_load_dwordx4 v118, s[56:59], s43 offen offset:2048 lds
    buffer_load_dwordx4 v119, s[56:59], s43 offen offset:3072 lds
    v_accvgpr_read_b32 v28, a192
    v_accvgpr_read_b32 v29, a193
    v_accvgpr_read_b32 v30, a194
    v_accvgpr_read_b32 v31, a195
    v_mov_b32 v52, v208
    v_mov_b32 v53, v209
    v_mov_b32 v54, v210
    v_mov_b32 v55, v211
    v_max_f32 v28, 0, v28
    v_max_f32 v29, 0, v29
    v_max_f32 v30, 0, v30
    v_max_f32 v31, 0, v31
    v_mul_f32 v28, v28, v52
    v_mul_f32 v29, v29, v53
    v_mul_f32 v30, v30, v54
    v_mul_f32 v31, v31, v55
    v_accvgpr_read_b32 v32, a208
    v_accvgpr_read_b32 v33, a209
    v_accvgpr_read_b32 v34, a210
    v_accvgpr_read_b32 v35, a211
    v_mov_b32 v56, v224
    v_mov_b32 v57, v225
    v_mov_b32 v58, v226
    v_mov_b32 v59, v227
    v_max_f32 v32, 0, v32
    v_max_f32 v33, 0, v33
    v_max_f32 v34, 0, v34
    v_max_f32 v35, 0, v35
    v_mul_f32 v32, v32, v56
    v_mul_f32 v33, v33, v57
    v_mul_f32 v34, v34, v58
    v_mul_f32 v35, v35, v59
    v_cvt_pk_bf16_f32 v36, v28, v29
    v_cvt_pk_bf16_f32 v37, v30, v31
    v_cvt_pk_bf16_f32 v38, v32, v33
    v_cvt_pk_bf16_f32 v39, v34, v35
    s_nop 1
    v_permlane16_swap_b32 v36, v38
    v_permlane16_swap_b32 v37, v39
    buffer_store_dwordx4 v[36:39], v65, s[24:27], s48 offen offset:128
    s_add_u32 s43, s78, 0x4000
    s_add_u32 m0, s78, 0x14000
    s_nop 0
    buffer_load_dwordx4 v120, s[60:63], s43 offen offset:0 lds
    buffer_load_dwordx4 v121, s[60:63], s43 offen offset:1024 lds
    v_accvgpr_read_b32 v40, a224
    v_accvgpr_read_b32 v41, a225
    v_accvgpr_read_b32 v42, a226
    v_accvgpr_read_b32 v43, a227
    v_mov_b32 v52, v240
    v_mov_b32 v53, v241
    v_mov_b32 v54, v242
    v_mov_b32 v55, v243
    v_max_f32 v40, 0, v40
    v_max_f32 v41, 0, v41
    v_max_f32 v42, 0, v42
    v_max_f32 v43, 0, v43
    v_mul_f32 v40, v40, v52
    v_mul_f32 v41, v41, v53
    v_mul_f32 v42, v42, v54
    v_mul_f32 v43, v43, v55
    v_cvt_pk_bf16_f32 v48, v40, v41
    v_cvt_pk_bf16_f32 v49, v42, v43
    buffer_store_dwordx2 v[48:49], v66, s[24:27], s48 offen offset:192
    buffer_load_dwordx4 v120, s[60:63], s43 offen offset:2048 lds
    buffer_load_dwordx4 v121, s[60:63], s43 offen offset:3072 lds
    s_add_u32 s47, s47, 0x20000
    s_add_u32 s48, s48, 0x1c000
    v_accvgpr_read_b32 v4, a132
    v_accvgpr_read_b32 v5, a133
    v_accvgpr_read_b32 v6, a134
    v_accvgpr_read_b32 v7, a135
    v_accvgpr_read_b32 v52, a244
    v_accvgpr_read_b32 v53, a245
    v_accvgpr_read_b32 v54, a246
    v_accvgpr_read_b32 v55, a247
    v_max_f32 v4, 0, v4
    v_max_f32 v5, 0, v5
    v_max_f32 v6, 0, v6
    v_max_f32 v7, 0, v7
    v_mul_f32 v4, v4, v52
    v_mul_f32 v5, v5, v53
    v_mul_f32 v6, v6, v54
    v_mul_f32 v7, v7, v55
    v_accvgpr_read_b32 v8, a148
    v_accvgpr_read_b32 v9, a149
    v_accvgpr_read_b32 v10, a150
    v_accvgpr_read_b32 v11, a151
    v_mov_b32 v56, v164
    v_mov_b32 v57, v165
    v_mov_b32 v58, v166
    v_mov_b32 v59, v167
    v_max_f32 v8, 0, v8
    v_max_f32 v9, 0, v9
    v_max_f32 v10, 0, v10
    v_max_f32 v11, 0, v11
    v_mul_f32 v8, v8, v56
    v_mul_f32 v9, v9, v57
    v_mul_f32 v10, v10, v58
    v_mul_f32 v11, v11, v59
    v_cvt_pk_bf16_f32 v12, v4, v5
    v_cvt_pk_bf16_f32 v13, v6, v7
    v_cvt_pk_bf16_f32 v14, v8, v9
    v_cvt_pk_bf16_f32 v15, v10, v11
    s_nop 1
    v_permlane16_swap_b32 v12, v14
    v_permlane16_swap_b32 v13, v15
    buffer_store_dwordx4 v[12:15], v65, s[24:27], s48 offen offset:0
    s_add_u32 s43, s78, 0xc000
    s_add_u32 m0, s78, 0xc000
    s_nop 0
    buffer_load_dwordx4 v116, s[56:59], s43 offen offset:0 lds
    buffer_load_dwordx4 v117, s[56:59], s43 offen offset:1024 lds
    v_accvgpr_read_b32 v16, a164
    v_accvgpr_read_b32 v17, a165
    v_accvgpr_read_b32 v18, a166
    v_accvgpr_read_b32 v19, a167
    v_mov_b32 v52, v180
    v_mov_b32 v53, v181
    v_mov_b32 v54, v182
    v_mov_b32 v55, v183
    v_max_f32 v16, 0, v16
    v_max_f32 v17, 0, v17
    v_max_f32 v18, 0, v18
    v_max_f32 v19, 0, v19
    v_mul_f32 v16, v16, v52
    v_mul_f32 v17, v17, v53
    v_mul_f32 v18, v18, v54
    v_mul_f32 v19, v19, v55
    v_accvgpr_read_b32 v20, a180
    v_accvgpr_read_b32 v21, a181
    v_accvgpr_read_b32 v22, a182
    v_accvgpr_read_b32 v23, a183
    v_mov_b32 v56, v196
    v_mov_b32 v57, v197
    v_mov_b32 v58, v198
    v_mov_b32 v59, v199
    v_max_f32 v20, 0, v20
    v_max_f32 v21, 0, v21
    v_max_f32 v22, 0, v22
    v_max_f32 v23, 0, v23
    v_mul_f32 v20, v20, v56
    v_mul_f32 v21, v21, v57
    v_mul_f32 v22, v22, v58
    v_mul_f32 v23, v23, v59
    v_cvt_pk_bf16_f32 v24, v16, v17
    v_cvt_pk_bf16_f32 v25, v18, v19
    v_cvt_pk_bf16_f32 v26, v20, v21
    v_cvt_pk_bf16_f32 v27, v22, v23
    s_nop 1
    v_permlane16_swap_b32 v24, v26
    v_permlane16_swap_b32 v25, v27
    buffer_store_dwordx4 v[24:27], v65, s[24:27], s48 offen offset:64
    buffer_load_dwordx4 v118, s[56:59], s43 offen offset:2048 lds
    buffer_load_dwordx4 v119, s[56:59], s43 offen offset:3072 lds
    v_accvgpr_read_b32 v28, a196
    v_accvgpr_read_b32 v29, a197
    v_accvgpr_read_b32 v30, a198
    v_accvgpr_read_b32 v31, a199
    v_mov_b32 v52, v212
    v_mov_b32 v53, v213
    v_mov_b32 v54, v214
    v_mov_b32 v55, v215
    v_max_f32 v28, 0, v28
    v_max_f32 v29, 0, v29
    v_max_f32 v30, 0, v30
    v_max_f32 v31, 0, v31
    v_mul_f32 v28, v28, v52
    v_mul_f32 v29, v29, v53
    v_mul_f32 v30, v30, v54
    v_mul_f32 v31, v31, v55
    v_accvgpr_read_b32 v32, a212
    v_accvgpr_read_b32 v33, a213
    v_accvgpr_read_b32 v34, a214
    v_accvgpr_read_b32 v35, a215
    v_mov_b32 v56, v228
    v_mov_b32 v57, v229
    v_mov_b32 v58, v230
    v_mov_b32 v59, v231
    v_max_f32 v32, 0, v32
    v_max_f32 v33, 0, v33
    v_max_f32 v34, 0, v34
    v_max_f32 v35, 0, v35
    v_mul_f32 v32, v32, v56
    v_mul_f32 v33, v33, v57
    v_mul_f32 v34, v34, v58
    v_mul_f32 v35, v35, v59
    v_cvt_pk_bf16_f32 v36, v28, v29
    v_cvt_pk_bf16_f32 v37, v30, v31
    v_cvt_pk_bf16_f32 v38, v32, v33
    v_cvt_pk_bf16_f32 v39, v34, v35
    s_nop 1
    v_permlane16_swap_b32 v36, v38
    v_permlane16_swap_b32 v37, v39
    buffer_store_dwordx4 v[36:39], v65, s[24:27], s48 offen offset:128
    s_add_u32 s43, s78, 0x8000
    s_add_u32 m0, s78, 0x18000
    s_nop 0
    buffer_load_dwordx4 v120, s[60:63], s43 offen offset:0 lds
    buffer_load_dwordx4 v121, s[60:63], s43 offen offset:1024 lds
    v_accvgpr_read_b32 v40, a228
    v_accvgpr_read_b32 v41, a229
    v_accvgpr_read_b32 v42, a230
    v_accvgpr_read_b32 v43, a231
    v_mov_b32 v52, v244
    v_mov_b32 v53, v245
    v_mov_b32 v54, v246
    v_mov_b32 v55, v247
    v_max_f32 v40, 0, v40
    v_max_f32 v41, 0, v41
    v_max_f32 v42, 0, v42
    v_max_f32 v43, 0, v43
    v_mul_f32 v40, v40, v52
    v_mul_f32 v41, v41, v53
    v_mul_f32 v42, v42, v54
    v_mul_f32 v43, v43, v55
    v_cvt_pk_bf16_f32 v48, v40, v41
    v_cvt_pk_bf16_f32 v49, v42, v43
    buffer_store_dwordx2 v[48:49], v66, s[24:27], s48 offen offset:192
    buffer_load_dwordx4 v120, s[60:63], s43 offen offset:2048 lds
    buffer_load_dwordx4 v121, s[60:63], s43 offen offset:3072 lds
    s_add_u32 s47, s47, 0x20000
    s_add_u32 s48, s48, 0x1c000
    v_accvgpr_read_b32 v4, a136
    v_accvgpr_read_b32 v5, a137
    v_accvgpr_read_b32 v6, a138
    v_accvgpr_read_b32 v7, a139
    v_accvgpr_read_b32 v52, a248
    v_accvgpr_read_b32 v53, a249
    v_accvgpr_read_b32 v54, a250
    v_accvgpr_read_b32 v55, a251
    v_max_f32 v4, 0, v4
    v_max_f32 v5, 0, v5
    v_max_f32 v6, 0, v6
    v_max_f32 v7, 0, v7
    v_mul_f32 v4, v4, v52
    v_mul_f32 v5, v5, v53
    v_mul_f32 v6, v6, v54
    v_mul_f32 v7, v7, v55
    v_accvgpr_read_b32 v8, a152
    v_accvgpr_read_b32 v9, a153
    v_accvgpr_read_b32 v10, a154
    v_accvgpr_read_b32 v11, a155
    v_mov_b32 v56, v168
    v_mov_b32 v57, v169
    v_mov_b32 v58, v170
    v_mov_b32 v59, v171
    v_max_f32 v8, 0, v8
    v_max_f32 v9, 0, v9
    v_max_f32 v10, 0, v10
    v_max_f32 v11, 0, v11
    v_mul_f32 v8, v8, v56
    v_mul_f32 v9, v9, v57
    v_mul_f32 v10, v10, v58
    v_mul_f32 v11, v11, v59
    v_cvt_pk_bf16_f32 v12, v4, v5
    v_cvt_pk_bf16_f32 v13, v6, v7
    v_cvt_pk_bf16_f32 v14, v8, v9
    v_cvt_pk_bf16_f32 v15, v10, v11
    s_nop 1
    v_permlane16_swap_b32 v12, v14
    v_permlane16_swap_b32 v13, v15
    buffer_store_dwordx4 v[12:15], v65, s[24:27], s48 offen offset:0
    v_accvgpr_read_b32 v16, a168
    v_accvgpr_read_b32 v17, a169
    v_accvgpr_read_b32 v18, a170
    v_accvgpr_read_b32 v19, a171
    v_mov_b32 v52, v184
    v_mov_b32 v53, v185
    v_mov_b32 v54, v186
    v_mov_b32 v55, v187
    v_max_f32 v16, 0, v16
    v_max_f32 v17, 0, v17
    v_max_f32 v18, 0, v18
    v_max_f32 v19, 0, v19
    v_mul_f32 v16, v16, v52
    v_mul_f32 v17, v17, v53
    v_mul_f32 v18, v18, v54
    v_mul_f32 v19, v19, v55
    v_accvgpr_read_b32 v20, a184
    v_accvgpr_read_b32 v21, a185
    v_accvgpr_read_b32 v22, a186
    v_accvgpr_read_b32 v23, a187
    v_mov_b32 v56, v200
    v_mov_b32 v57, v201
    v_mov_b32 v58, v202
    v_mov_b32 v59, v203
    v_max_f32 v20, 0, v20
    v_max_f32 v21, 0, v21
    v_max_f32 v22, 0, v22
    v_max_f32 v23, 0, v23
    v_mul_f32 v20, v20, v56
    v_mul_f32 v21, v21, v57
    v_mul_f32 v22, v22, v58
    v_mul_f32 v23, v23, v59
    v_cvt_pk_bf16_f32 v24, v16, v17
    v_cvt_pk_bf16_f32 v25, v18, v19
    v_cvt_pk_bf16_f32 v26, v20, v21
    v_cvt_pk_bf16_f32 v27, v22, v23
    s_nop 1
    v_permlane16_swap_b32 v24, v26
    v_permlane16_swap_b32 v25, v27
    buffer_store_dwordx4 v[24:27], v65, s[24:27], s48 offen offset:64
    v_accvgpr_read_b32 v28, a200
    v_accvgpr_read_b32 v29, a201
    v_accvgpr_read_b32 v30, a202
    v_accvgpr_read_b32 v31, a203
    v_mov_b32 v52, v216
    v_mov_b32 v53, v217
    v_mov_b32 v54, v218
    v_mov_b32 v55, v219
    v_max_f32 v28, 0, v28
    v_max_f32 v29, 0, v29
    v_max_f32 v30, 0, v30
    v_max_f32 v31, 0, v31
    v_mul_f32 v28, v28, v52
    v_mul_f32 v29, v29, v53
    v_mul_f32 v30, v30, v54
    v_mul_f32 v31, v31, v55
    v_accvgpr_read_b32 v32, a216
    v_accvgpr_read_b32 v33, a217
    v_accvgpr_read_b32 v34, a218
    v_accvgpr_read_b32 v35, a219
    v_mov_b32 v56, v232
    v_mov_b32 v57, v233
    v_mov_b32 v58, v234
    v_mov_b32 v59, v235
    v_max_f32 v32, 0, v32
    v_max_f32 v33, 0, v33
    v_max_f32 v34, 0, v34
    v_max_f32 v35, 0, v35
    v_mul_f32 v32, v32, v56
    v_mul_f32 v33, v33, v57
    v_mul_f32 v34, v34, v58
    v_mul_f32 v35, v35, v59
    v_cvt_pk_bf16_f32 v36, v28, v29
    v_cvt_pk_bf16_f32 v37, v30, v31
    v_cvt_pk_bf16_f32 v38, v32, v33
    v_cvt_pk_bf16_f32 v39, v34, v35
    s_nop 1
    v_permlane16_swap_b32 v36, v38
    v_permlane16_swap_b32 v37, v39
    buffer_store_dwordx4 v[36:39], v65, s[24:27], s48 offen offset:128
    v_accvgpr_read_b32 v40, a232
    v_accvgpr_read_b32 v41, a233
    v_accvgpr_read_b32 v42, a234
    v_accvgpr_read_b32 v43, a235
    v_mov_b32 v52, v248
    v_mov_b32 v53, v249
    v_mov_b32 v54, v250
    v_mov_b32 v55, v251
    v_max_f32 v40, 0, v40
    v_max_f32 v41, 0, v41
    v_max_f32 v42, 0, v42
    v_max_f32 v43, 0, v43
    v_mul_f32 v40, v40, v52
    v_mul_f32 v41, v41, v53
    v_mul_f32 v42, v42, v54
    v_mul_f32 v43, v43, v55
    v_cvt_pk_bf16_f32 v48, v40, v41
    v_cvt_pk_bf16_f32 v49, v42, v43
    buffer_store_dwordx2 v[48:49], v66, s[24:27], s48 offen offset:192
    s_add_u32 s47, s47, 0x20000
    s_add_u32 s48, s48, 0x1c000
    v_accvgpr_read_b32 v4, a140
    v_accvgpr_read_b32 v5, a141
    v_accvgpr_read_b32 v6, a142
    v_accvgpr_read_b32 v7, a143
    v_accvgpr_read_b32 v52, a252
    v_accvgpr_read_b32 v53, a253
    v_accvgpr_read_b32 v54, a254
    v_accvgpr_read_b32 v55, a255
    v_max_f32 v4, 0, v4
    v_max_f32 v5, 0, v5
    v_max_f32 v6, 0, v6
    v_max_f32 v7, 0, v7
    v_mul_f32 v4, v4, v52
    v_mul_f32 v5, v5, v53
    v_mul_f32 v6, v6, v54
    v_mul_f32 v7, v7, v55
    v_accvgpr_read_b32 v8, a156
    v_accvgpr_read_b32 v9, a157
    v_accvgpr_read_b32 v10, a158
    v_accvgpr_read_b32 v11, a159
    v_mov_b32 v56, v172
    v_mov_b32 v57, v173
    v_mov_b32 v58, v174
    v_mov_b32 v59, v175
    v_max_f32 v8, 0, v8
    v_max_f32 v9, 0, v9
    v_max_f32 v10, 0, v10
    v_max_f32 v11, 0, v11
    v_mul_f32 v8, v8, v56
    v_mul_f32 v9, v9, v57
    v_mul_f32 v10, v10, v58
    v_mul_f32 v11, v11, v59
    v_cvt_pk_bf16_f32 v12, v4, v5
    v_cvt_pk_bf16_f32 v13, v6, v7
    v_cvt_pk_bf16_f32 v14, v8, v9
    v_cvt_pk_bf16_f32 v15, v10, v11
    s_nop 1
    v_permlane16_swap_b32 v12, v14
    v_permlane16_swap_b32 v13, v15
    buffer_store_dwordx4 v[12:15], v65, s[24:27], s48 offen offset:0
    v_accvgpr_read_b32 v16, a172
    v_accvgpr_read_b32 v17, a173
    v_accvgpr_read_b32 v18, a174
    v_accvgpr_read_b32 v19, a175
    v_mov_b32 v52, v188
    v_mov_b32 v53, v189
    v_mov_b32 v54, v190
    v_mov_b32 v55, v191
    v_max_f32 v16, 0, v16
    v_max_f32 v17, 0, v17
    v_max_f32 v18, 0, v18
    v_max_f32 v19, 0, v19
    v_mul_f32 v16, v16, v52
    v_mul_f32 v17, v17, v53
    v_mul_f32 v18, v18, v54
    v_mul_f32 v19, v19, v55
    v_accvgpr_read_b32 v20, a188
    v_accvgpr_read_b32 v21, a189
    v_accvgpr_read_b32 v22, a190
    v_accvgpr_read_b32 v23, a191
    v_mov_b32 v56, v204
    v_mov_b32 v57, v205
    v_mov_b32 v58, v206
    v_mov_b32 v59, v207
    v_max_f32 v20, 0, v20
    v_max_f32 v21, 0, v21
    v_max_f32 v22, 0, v22
    v_max_f32 v23, 0, v23
    v_mul_f32 v20, v20, v56
    v_mul_f32 v21, v21, v57
    v_mul_f32 v22, v22, v58
    v_mul_f32 v23, v23, v59
    v_cvt_pk_bf16_f32 v24, v16, v17
    v_cvt_pk_bf16_f32 v25, v18, v19
    v_cvt_pk_bf16_f32 v26, v20, v21
    v_cvt_pk_bf16_f32 v27, v22, v23
    s_nop 1
    v_permlane16_swap_b32 v24, v26
    v_permlane16_swap_b32 v25, v27
    buffer_store_dwordx4 v[24:27], v65, s[24:27], s48 offen offset:64
    v_accvgpr_read_b32 v28, a204
    v_accvgpr_read_b32 v29, a205
    v_accvgpr_read_b32 v30, a206
    v_accvgpr_read_b32 v31, a207
    v_mov_b32 v52, v220
    v_mov_b32 v53, v221
    v_mov_b32 v54, v222
    v_mov_b32 v55, v223
    v_max_f32 v28, 0, v28
    v_max_f32 v29, 0, v29
    v_max_f32 v30, 0, v30
    v_max_f32 v31, 0, v31
    v_mul_f32 v28, v28, v52
    v_mul_f32 v29, v29, v53
    v_mul_f32 v30, v30, v54
    v_mul_f32 v31, v31, v55
    v_accvgpr_read_b32 v32, a220
    v_accvgpr_read_b32 v33, a221
    v_accvgpr_read_b32 v34, a222
    v_accvgpr_read_b32 v35, a223
    v_mov_b32 v56, v236
    v_mov_b32 v57, v237
    v_mov_b32 v58, v238
    v_mov_b32 v59, v239
    v_max_f32 v32, 0, v32
    v_max_f32 v33, 0, v33
    v_max_f32 v34, 0, v34
    v_max_f32 v35, 0, v35
    v_mul_f32 v32, v32, v56
    v_mul_f32 v33, v33, v57
    v_mul_f32 v34, v34, v58
    v_mul_f32 v35, v35, v59
    v_cvt_pk_bf16_f32 v36, v28, v29
    v_cvt_pk_bf16_f32 v37, v30, v31
    v_cvt_pk_bf16_f32 v38, v32, v33
    v_cvt_pk_bf16_f32 v39, v34, v35
    s_nop 1
    v_permlane16_swap_b32 v36, v38
    v_permlane16_swap_b32 v37, v39
    buffer_store_dwordx4 v[36:39], v65, s[24:27], s48 offen offset:128
    v_accvgpr_read_b32 v40, a236
    v_accvgpr_read_b32 v41, a237
    v_accvgpr_read_b32 v42, a238
    v_accvgpr_read_b32 v43, a239
    v_mov_b32 v52, v252
    v_mov_b32 v53, v253
    v_mov_b32 v54, v254
    v_mov_b32 v55, v255
    v_max_f32 v40, 0, v40
    v_max_f32 v41, 0, v41
    v_max_f32 v42, 0, v42
    v_max_f32 v43, 0, v43
    v_mul_f32 v40, v40, v52
    v_mul_f32 v41, v41, v53
    v_mul_f32 v42, v42, v54
    v_mul_f32 v43, v43, v55
    v_cvt_pk_bf16_f32 v48, v40, v41
    v_cvt_pk_bf16_f32 v49, v42, v43
    buffer_store_dwordx2 v[48:49], v66, s[24:27], s48 offen offset:192
    v_accvgpr_read_b32 v4, a0
    v_accvgpr_read_b32 v5, a1
    v_accvgpr_read_b32 v6, a2
    v_accvgpr_read_b32 v7, a3
    v_accvgpr_read_b32 v8, a16
    v_accvgpr_read_b32 v9, a17
    v_accvgpr_read_b32 v10, a18
    v_accvgpr_read_b32 v11, a19
    v_mul_f32 v4, s49, v4
    v_mul_f32 v5, s49, v5
    v_mul_f32 v6, s49, v6
    v_mul_f32 v7, s49, v7
    v_mul_f32 v8, s49, v8
    v_mul_f32 v9, s49, v9
    v_mul_f32 v10, s49, v10
    v_mul_f32 v11, s49, v11
    v_cvt_pk_bf16_f32 v12, v4, v5
    v_cvt_pk_bf16_f32 v13, v6, v7
    v_cvt_pk_bf16_f32 v14, v8, v9
    v_cvt_pk_bf16_f32 v15, v10, v11
    s_nop 1
    v_permlane16_swap_b32 v12, v14
    v_permlane16_swap_b32 v13, v15
    s_nop 1
    v_accvgpr_write_b32 a128, v12
    v_accvgpr_write_b32 a129, v13
    v_accvgpr_write_b32 a130, v14
    v_accvgpr_write_b32 a131, v15
    v_accvgpr_read_b32 v16, a32
    v_accvgpr_read_b32 v17, a33
    v_accvgpr_read_b32 v18, a34
    v_accvgpr_read_b32 v19, a35
    v_accvgpr_read_b32 v20, a48
    v_accvgpr_read_b32 v21, a49
    v_accvgpr_read_b32 v22, a50
    v_accvgpr_read_b32 v23, a51
    v_mul_f32 v16, s49, v16
    v_mul_f32 v17, s49, v17
    v_mul_f32 v18, s49, v18
    v_mul_f32 v19, s49, v19
    v_mul_f32 v20, s49, v20
    v_mul_f32 v21, s49, v21
    v_mul_f32 v22, s49, v22
    v_mul_f32 v23, s49, v23
    v_cvt_pk_bf16_f32 v24, v16, v17
    v_cvt_pk_bf16_f32 v25, v18, v19
    v_cvt_pk_bf16_f32 v26, v20, v21
    v_cvt_pk_bf16_f32 v27, v22, v23
    s_nop 1
    v_permlane16_swap_b32 v24, v26
    v_permlane16_swap_b32 v25, v27
    s_nop 1
    v_accvgpr_write_b32 a132, v24
    v_accvgpr_write_b32 a133, v25
    v_accvgpr_write_b32 a134, v26
    v_accvgpr_write_b32 a135, v27
    v_accvgpr_read_b32 v28, a64
    v_accvgpr_read_b32 v29, a65
    v_accvgpr_read_b32 v30, a66
    v_accvgpr_read_b32 v31, a67
    v_accvgpr_read_b32 v32, a80
    v_accvgpr_read_b32 v33, a81
    v_accvgpr_read_b32 v34, a82
    v_accvgpr_read_b32 v35, a83
    v_mul_f32 v28, s49, v28
    v_mul_f32 v29, s49, v29
    v_mul_f32 v30, s49, v30
    v_mul_f32 v31, s49, v31
    v_mul_f32 v32, s49, v32
    v_mul_f32 v33, s49, v33
    v_mul_f32 v34, s49, v34
    v_mul_f32 v35, s49, v35
    v_cvt_pk_bf16_f32 v36, v28, v29
    v_cvt_pk_bf16_f32 v37, v30, v31
    v_cvt_pk_bf16_f32 v38, v32, v33
    v_cvt_pk_bf16_f32 v39, v34, v35
    s_nop 1
    v_permlane16_swap_b32 v36, v38
    v_permlane16_swap_b32 v37, v39
    s_nop 1
    v_accvgpr_write_b32 a136, v36
    v_accvgpr_write_b32 a137, v37
    v_accvgpr_write_b32 a138, v38
    v_accvgpr_write_b32 a139, v39
    v_accvgpr_read_b32 v40, a96
    v_accvgpr_read_b32 v41, a97
    v_accvgpr_read_b32 v42, a98
    v_accvgpr_read_b32 v43, a99
    v_accvgpr_read_b32 v44, a112
    v_accvgpr_read_b32 v45, a113
    v_accvgpr_read_b32 v46, a114
    v_accvgpr_read_b32 v47, a115
    v_mul_f32 v40, s49, v40
    v_mul_f32 v41, s49, v41
    v_mul_f32 v42, s49, v42
    v_mul_f32 v43, s49, v43
    v_mul_f32 v44, s49, v44
    v_mul_f32 v45, s49, v45
    v_mul_f32 v46, s49, v46
    v_mul_f32 v47, s49, v47
    v_cvt_pk_bf16_f32 v48, v40, v41
    v_cvt_pk_bf16_f32 v49, v42, v43
    v_cvt_pk_bf16_f32 v50, v44, v45
    v_cvt_pk_bf16_f32 v51, v46, v47
    s_nop 1
    v_permlane16_swap_b32 v48, v50
    v_permlane16_swap_b32 v49, v51
    s_nop 1
    v_accvgpr_write_b32 a140, v48
    v_accvgpr_write_b32 a141, v49
    v_accvgpr_write_b32 a142, v50
    v_accvgpr_write_b32 a143, v51
    v_accvgpr_read_b32 v4, a4
    v_accvgpr_read_b32 v5, a5
    v_accvgpr_read_b32 v6, a6
    v_accvgpr_read_b32 v7, a7
    v_accvgpr_read_b32 v8, a20
    v_accvgpr_read_b32 v9, a21
    v_accvgpr_read_b32 v10, a22
    v_accvgpr_read_b32 v11, a23
    v_mul_f32 v4, s49, v4
    v_mul_f32 v5, s49, v5
    v_mul_f32 v6, s49, v6
    v_mul_f32 v7, s49, v7
    v_mul_f32 v8, s49, v8
    v_mul_f32 v9, s49, v9
    v_mul_f32 v10, s49, v10
    v_mul_f32 v11, s49, v11
    v_cvt_pk_bf16_f32 v12, v4, v5
    v_cvt_pk_bf16_f32 v13, v6, v7
    v_cvt_pk_bf16_f32 v14, v8, v9
    v_cvt_pk_bf16_f32 v15, v10, v11
    s_nop 1
    v_permlane16_swap_b32 v12, v14
    v_permlane16_swap_b32 v13, v15
    s_nop 1
    v_accvgpr_write_b32 a144, v12
    v_accvgpr_write_b32 a145, v13
    v_accvgpr_write_b32 a146, v14
    v_accvgpr_write_b32 a147, v15
    v_accvgpr_read_b32 v16, a36
    v_accvgpr_read_b32 v17, a37
    v_accvgpr_read_b32 v18, a38
    v_accvgpr_read_b32 v19, a39
    v_accvgpr_read_b32 v20, a52
    v_accvgpr_read_b32 v21, a53
    v_accvgpr_read_b32 v22, a54
    v_accvgpr_read_b32 v23, a55
    v_mul_f32 v16, s49, v16
    v_mul_f32 v17, s49, v17
    v_mul_f32 v18, s49, v18
    v_mul_f32 v19, s49, v19
    v_mul_f32 v20, s49, v20
    v_mul_f32 v21, s49, v21
    v_mul_f32 v22, s49, v22
    v_mul_f32 v23, s49, v23
    v_cvt_pk_bf16_f32 v24, v16, v17
    v_cvt_pk_bf16_f32 v25, v18, v19
    v_cvt_pk_bf16_f32 v26, v20, v21
    v_cvt_pk_bf16_f32 v27, v22, v23
    s_nop 1
    v_permlane16_swap_b32 v24, v26
    v_permlane16_swap_b32 v25, v27
    s_nop 1
    v_accvgpr_write_b32 a148, v24
    v_accvgpr_write_b32 a149, v25
    v_accvgpr_write_b32 a150, v26
    v_accvgpr_write_b32 a151, v27
    v_accvgpr_read_b32 v28, a68
    v_accvgpr_read_b32 v29, a69
    v_accvgpr_read_b32 v30, a70
    v_accvgpr_read_b32 v31, a71
    v_accvgpr_read_b32 v32, a84
    v_accvgpr_read_b32 v33, a85
    v_accvgpr_read_b32 v34, a86
    v_accvgpr_read_b32 v35, a87
    v_mul_f32 v28, s49, v28
    v_mul_f32 v29, s49, v29
    v_mul_f32 v30, s49, v30
    v_mul_f32 v31, s49, v31
    v_mul_f32 v32, s49, v32
    v_mul_f32 v33, s49, v33
    v_mul_f32 v34, s49, v34
    v_mul_f32 v35, s49, v35
    v_cvt_pk_bf16_f32 v36, v28, v29
    v_cvt_pk_bf16_f32 v37, v30, v31
    v_cvt_pk_bf16_f32 v38, v32, v33
    v_cvt_pk_bf16_f32 v39, v34, v35
    s_nop 1
    v_permlane16_swap_b32 v36, v38
    v_permlane16_swap_b32 v37, v39
    s_nop 1
    v_accvgpr_write_b32 a152, v36
    v_accvgpr_write_b32 a153, v37
    v_accvgpr_write_b32 a154, v38
    v_accvgpr_write_b32 a155, v39
    v_accvgpr_read_b32 v40, a100
    v_accvgpr_read_b32 v41, a101
    v_accvgpr_read_b32 v42, a102
    v_accvgpr_read_b32 v43, a103
    v_accvgpr_read_b32 v44, a116
    v_accvgpr_read_b32 v45, a117
    v_accvgpr_read_b32 v46, a118
    v_accvgpr_read_b32 v47, a119
    v_mul_f32 v40, s49, v40
    v_mul_f32 v41, s49, v41
    v_mul_f32 v42, s49, v42
    v_mul_f32 v43, s49, v43
    v_mul_f32 v44, s49, v44
    v_mul_f32 v45, s49, v45
    v_mul_f32 v46, s49, v46
    v_mul_f32 v47, s49, v47
    v_cvt_pk_bf16_f32 v48, v40, v41
    v_cvt_pk_bf16_f32 v49, v42, v43
    v_cvt_pk_bf16_f32 v50, v44, v45
    v_cvt_pk_bf16_f32 v51, v46, v47
    s_nop 1
    v_permlane16_swap_b32 v48, v50
    v_permlane16_swap_b32 v49, v51
    s_nop 1
    v_accvgpr_write_b32 a156, v48
    v_accvgpr_write_b32 a157, v49
    v_accvgpr_write_b32 a158, v50
    v_accvgpr_write_b32 a159, v51
    v_accvgpr_read_b32 v4, a8
    v_accvgpr_read_b32 v5, a9
    v_accvgpr_read_b32 v6, a10
    v_accvgpr_read_b32 v7, a11
    v_accvgpr_read_b32 v8, a24
    v_accvgpr_read_b32 v9, a25
    v_accvgpr_read_b32 v10, a26
    v_accvgpr_read_b32 v11, a27
    v_mul_f32 v4, s49, v4
    v_mul_f32 v5, s49, v5
    v_mul_f32 v6, s49, v6
    v_mul_f32 v7, s49, v7
    v_mul_f32 v8, s49, v8
    v_mul_f32 v9, s49, v9
    v_mul_f32 v10, s49, v10
    v_mul_f32 v11, s49, v11
    v_cvt_pk_bf16_f32 v12, v4, v5
    v_cvt_pk_bf16_f32 v13, v6, v7
    v_cvt_pk_bf16_f32 v14, v8, v9
    v_cvt_pk_bf16_f32 v15, v10, v11
    s_nop 1
    v_permlane16_swap_b32 v12, v14
    v_permlane16_swap_b32 v13, v15
    s_nop 1
    v_accvgpr_write_b32 a160, v12
    v_accvgpr_write_b32 a161, v13
    v_accvgpr_write_b32 a162, v14
    v_accvgpr_write_b32 a163, v15
    v_accvgpr_read_b32 v16, a40
    v_accvgpr_read_b32 v17, a41
    v_accvgpr_read_b32 v18, a42
    v_accvgpr_read_b32 v19, a43
    v_accvgpr_read_b32 v20, a56
    v_accvgpr_read_b32 v21, a57
    v_accvgpr_read_b32 v22, a58
    v_accvgpr_read_b32 v23, a59
    v_mul_f32 v16, s49, v16
    v_mul_f32 v17, s49, v17
    v_mul_f32 v18, s49, v18
    v_mul_f32 v19, s49, v19
    v_mul_f32 v20, s49, v20
    v_mul_f32 v21, s49, v21
    v_mul_f32 v22, s49, v22
    v_mul_f32 v23, s49, v23
    v_cvt_pk_bf16_f32 v24, v16, v17
    v_cvt_pk_bf16_f32 v25, v18, v19
    v_cvt_pk_bf16_f32 v26, v20, v21
    v_cvt_pk_bf16_f32 v27, v22, v23
    s_nop 1
    v_permlane16_swap_b32 v24, v26
    v_permlane16_swap_b32 v25, v27
    s_nop 1
    v_accvgpr_write_b32 a164, v24
    v_accvgpr_write_b32 a165, v25
    v_accvgpr_write_b32 a166, v26
    v_accvgpr_write_b32 a167, v27
    v_accvgpr_read_b32 v28, a72
    v_accvgpr_read_b32 v29, a73
    v_accvgpr_read_b32 v30, a74
    v_accvgpr_read_b32 v31, a75
    v_accvgpr_read_b32 v32, a88
    v_accvgpr_read_b32 v33, a89
    v_accvgpr_read_b32 v34, a90
    v_accvgpr_read_b32 v35, a91
    v_mul_f32 v28, s49, v28
    v_mul_f32 v29, s49, v29
    v_mul_f32 v30, s49, v30
    v_mul_f32 v31, s49, v31
    v_mul_f32 v32, s49, v32
    v_mul_f32 v33, s49, v33
    v_mul_f32 v34, s49, v34
    v_mul_f32 v35, s49, v35
    v_cvt_pk_bf16_f32 v36, v28, v29
    v_cvt_pk_bf16_f32 v37, v30, v31
    v_cvt_pk_bf16_f32 v38, v32, v33
    v_cvt_pk_bf16_f32 v39, v34, v35
    s_nop 1
    v_permlane16_swap_b32 v36, v38
    v_permlane16_swap_b32 v37, v39
    s_nop 1
    v_accvgpr_write_b32 a168, v36
    v_accvgpr_write_b32 a169, v37
    v_accvgpr_write_b32 a170, v38
    v_accvgpr_write_b32 a171, v39
    v_accvgpr_read_b32 v40, a104
    v_accvgpr_read_b32 v41, a105
    v_accvgpr_read_b32 v42, a106
    v_accvgpr_read_b32 v43, a107
    v_accvgpr_read_b32 v44, a120
    v_accvgpr_read_b32 v45, a121
    v_accvgpr_read_b32 v46, a122
    v_accvgpr_read_b32 v47, a123
    v_mul_f32 v40, s49, v40
    v_mul_f32 v41, s49, v41
    v_mul_f32 v42, s49, v42
    v_mul_f32 v43, s49, v43
    v_mul_f32 v44, s49, v44
    v_mul_f32 v45, s49, v45
    v_mul_f32 v46, s49, v46
    v_mul_f32 v47, s49, v47
    v_cvt_pk_bf16_f32 v48, v40, v41
    v_cvt_pk_bf16_f32 v49, v42, v43
    v_cvt_pk_bf16_f32 v50, v44, v45
    v_cvt_pk_bf16_f32 v51, v46, v47
    s_nop 1
    v_permlane16_swap_b32 v48, v50
    v_permlane16_swap_b32 v49, v51
    s_nop 1
    v_accvgpr_write_b32 a172, v48
    v_accvgpr_write_b32 a173, v49
    v_accvgpr_write_b32 a174, v50
    v_accvgpr_write_b32 a175, v51
    v_accvgpr_read_b32 v4, a12
    v_accvgpr_read_b32 v5, a13
    v_accvgpr_read_b32 v6, a14
    v_accvgpr_read_b32 v7, a15
    v_accvgpr_read_b32 v8, a28
    v_accvgpr_read_b32 v9, a29
    v_accvgpr_read_b32 v10, a30
    v_accvgpr_read_b32 v11, a31
    v_mul_f32 v4, s49, v4
    v_mul_f32 v5, s49, v5
    v_mul_f32 v6, s49, v6
    v_mul_f32 v7, s49, v7
    v_mul_f32 v8, s49, v8
    v_mul_f32 v9, s49, v9
    v_mul_f32 v10, s49, v10
    v_mul_f32 v11, s49, v11
    v_cvt_pk_bf16_f32 v12, v4, v5
    v_cvt_pk_bf16_f32 v13, v6, v7
    v_cvt_pk_bf16_f32 v14, v8, v9
    v_cvt_pk_bf16_f32 v15, v10, v11
    s_nop 1
    v_permlane16_swap_b32 v12, v14
    v_permlane16_swap_b32 v13, v15
    s_nop 1
    v_accvgpr_write_b32 a176, v12
    v_accvgpr_write_b32 a177, v13
    v_accvgpr_write_b32 a178, v14
    v_accvgpr_write_b32 a179, v15
    v_accvgpr_read_b32 v16, a44
    v_accvgpr_read_b32 v17, a45
    v_accvgpr_read_b32 v18, a46
    v_accvgpr_read_b32 v19, a47
    v_accvgpr_read_b32 v20, a60
    v_accvgpr_read_b32 v21, a61
    v_accvgpr_read_b32 v22, a62
    v_accvgpr_read_b32 v23, a63
    v_mul_f32 v16, s49, v16
    v_mul_f32 v17, s49, v17
    v_mul_f32 v18, s49, v18
    v_mul_f32 v19, s49, v19
    v_mul_f32 v20, s49, v20
    v_mul_f32 v21, s49, v21
    v_mul_f32 v22, s49, v22
    v_mul_f32 v23, s49, v23
    v_cvt_pk_bf16_f32 v24, v16, v17
    v_cvt_pk_bf16_f32 v25, v18, v19
    v_cvt_pk_bf16_f32 v26, v20, v21
    v_cvt_pk_bf16_f32 v27, v22, v23
    s_nop 1
    v_permlane16_swap_b32 v24, v26
    v_permlane16_swap_b32 v25, v27
    s_nop 1
    v_accvgpr_write_b32 a180, v24
    v_accvgpr_write_b32 a181, v25
    v_accvgpr_write_b32 a182, v26
    v_accvgpr_write_b32 a183, v27
    v_accvgpr_read_b32 v28, a76
    v_accvgpr_read_b32 v29, a77
    v_accvgpr_read_b32 v30, a78
    v_accvgpr_read_b32 v31, a79
    v_accvgpr_read_b32 v32, a92
    v_accvgpr_read_b32 v33, a93
    v_accvgpr_read_b32 v34, a94
    v_accvgpr_read_b32 v35, a95
    v_mul_f32 v28, s49, v28
    v_mul_f32 v29, s49, v29
    v_mul_f32 v30, s49, v30
    v_mul_f32 v31, s49, v31
    v_mul_f32 v32, s49, v32
    v_mul_f32 v33, s49, v33
    v_mul_f32 v34, s49, v34
    v_mul_f32 v35, s49, v35
    v_cvt_pk_bf16_f32 v36, v28, v29
    v_cvt_pk_bf16_f32 v37, v30, v31
    v_cvt_pk_bf16_f32 v38, v32, v33
    v_cvt_pk_bf16_f32 v39, v34, v35
    s_nop 1
    v_permlane16_swap_b32 v36, v38
    v_permlane16_swap_b32 v37, v39
    s_nop 1
    v_accvgpr_write_b32 a184, v36
    v_accvgpr_write_b32 a185, v37
    v_accvgpr_write_b32 a186, v38
    v_accvgpr_write_b32 a187, v39
    v_accvgpr_read_b32 v40, a108
    v_accvgpr_read_b32 v41, a109
    v_accvgpr_read_b32 v42, a110
    v_accvgpr_read_b32 v43, a111
    v_accvgpr_read_b32 v44, a124
    v_accvgpr_read_b32 v45, a125
    v_accvgpr_read_b32 v46, a126
    v_accvgpr_read_b32 v47, a127
    v_mul_f32 v40, s49, v40
    v_mul_f32 v41, s49, v41
    v_mul_f32 v42, s49, v42
    v_mul_f32 v43, s49, v43
    v_mul_f32 v44, s49, v44
    v_mul_f32 v45, s49, v45
    v_mul_f32 v46, s49, v46
    v_mul_f32 v47, s49, v47
    v_cvt_pk_bf16_f32 v48, v40, v41
    v_cvt_pk_bf16_f32 v49, v42, v43
    v_cvt_pk_bf16_f32 v50, v44, v45
    v_cvt_pk_bf16_f32 v51, v46, v47
    s_nop 1
    v_permlane16_swap_b32 v48, v50
    v_permlane16_swap_b32 v49, v51
    s_nop 1
    v_accvgpr_write_b32 a188, v48
    v_accvgpr_write_b32 a189, v49
    v_accvgpr_write_b32 a190, v50
    v_accvgpr_write_b32 a191, v51
    v_mov_b32 v40, 0
    v_mov_b32 v60, 0x3f803f80
    v_mov_b32 v41, 0
    v_mov_b32 v61, 0x3f803f80
    v_mov_b32 v42, 0
    v_mov_b32 v62, 0x3f803f80
    v_mov_b32 v43, 0
    v_mov_b32 v63, 0x3f803f80
    v_mov_b32 v80, 0
    v_mov_b32 v81, 0
    v_mov_b32 v82, 0
    v_mov_b32 v83, 0
    v_mov_b32 v84, 0
    v_mov_b32 v85, 0
    v_mov_b32 v86, 0
    v_mov_b32 v87, 0
    v_mov_b32 v88, 0
    v_mov_b32 v89, 0
    v_mov_b32 v90, 0
    v_mov_b32 v91, 0
    v_mov_b32 v92, 0
    v_mov_b32 v93, 0
    v_mov_b32 v94, 0
    v_mov_b32 v95, 0
    s_nop 1
    v_mfma_f32_32x32x16_bf16 a[0:15], v[40:43], v[40:43], 0
    v_mfma_f32_32x32x16_bf16 a[16:31], v[40:43], v[40:43], 0
    v_mfma_f32_32x32x16_bf16 a[32:47], v[40:43], v[40:43], 0
    v_mfma_f32_32x32x16_bf16 a[48:63], v[40:43], v[40:43], 0
    v_mfma_f32_32x32x16_bf16 a[64:79], v[40:43], v[40:43], 0
    v_mfma_f32_32x32x16_bf16 a[80:95], v[40:43], v[40:43], 0
    v_mfma_f32_32x32x16_bf16 a[96:111], v[40:43], v[40:43], 0
    v_mfma_f32_32x32x16_bf16 a[112:127], v[40:43], v[40:43], 0
    s_waitcnt vmcnt(40)
    s_barrier
    ds_read_b128 a[192:195], v104 offset:0
    ds_read_b128 a[196:199], v105 offset:0
    ds_read_b128 a[200:203], v106 offset:0
    ds_read_b128 a[204:207], v107 offset:0
    s_waitcnt lgkmcnt(3)
    v_mfma_f32_16x16x32_bf16 v[128:131], a[192:195], a[128:131], 0
    v_mfma_f32_16x16x32_bf16 v[132:135], a[192:195], a[144:147], 0
    v_mfma_f32_16x16x32_bf16 v[136:139], a[192:195], a[160:163], 0
    v_mfma_f32_16x16x32_bf16 v[140:143], a[192:195], a[176:179], 0
    ds_read_b128 a[208:211], v104 offset:4096
    s_waitcnt lgkmcnt(3)
    v_mfma_f32_16x16x32_bf16 v[128:131], a[196:199], a[132:135], v[128:131]
    v_mfma_f32_16x16x32_bf16 v[132:135], a[196:199], a[148:151], v[132:135]
    v_mfma_f32_16x16x32_bf16 v[136:139], a[196:199], a[164:167], v[136:139]
    v_mfma_f32_16x16x32_bf16 v[140:143], a[196:199], a[180:183], v[140:143]
    ds_read_b128 a[212:215], v105 offset:4096
    s_waitcnt lgkmcnt(3)
    v_mfma_f32_16x16x32_bf16 v[128:131], a[200:203], a[136:139], v[128:131]
    v_mfma_f32_16x16x32_bf16 v[132:135], a[200:203], a[152:155], v[132:135]
    v_mfma_f32_16x16x32_bf16 v[136:139], a[200:203], a[168:171], v[136:139]
    v_mfma_f32_16x16x32_bf16 v[140:143], a[200:203], a[184:187], v[140:143]
    ds_read_b128 a[216:219], v106 offset:4096
    s_waitcnt lgkmcnt(3)
    v_mfma_f32_16x16x32_bf16 v[128:131], a[204:207], a[140:143], v[128:131]
    v_mfma_f32_16x16x32_bf16 v[132:135], a[204:207], a[156:159], v[132:135]
    v_mfma_f32_16x16x32_bf16 v[136:139], a[204:207], a[172:175], v[136:139]
    v_mfma_f32_16x16x32_bf16 v[140:143], a[204:207], a[188:191], v[140:143]
    ds_read_b128 a[220:223], v107 offset:4096
    s_waitcnt lgkmcnt(3)
    v_mfma_f32_16x16x32_bf16 v[144:147], a[208:211], a[128:131], 0
    v_mfma_f32_16x16x32_bf16 v[148:151], a[208:211], a[144:147], 0
    v_mfma_f32_16x16x32_bf16 v[152:155], a[208:211], a[160:163], 0
    v_mfma_f32_16x16x32_bf16 v[156:159], a[208:211], a[176:179], 0
    ds_read_b128 a[224:227], v104 offset:8192
    s_waitcnt lgkmcnt(3)
    v_mfma_f32_16x16x32_bf16 v[144:147], a[212:215], a[132:135], v[144:147]
    v_mfma_f32_16x16x32_bf16 v[148:151], a[212:215], a[148:151], v[148:151]
    v_mfma_f32_16x16x32_bf16 v[152:155], a[212:215], a[164:167], v[152:155]
    v_mfma_f32_16x16x32_bf16 v[156:159], a[212:215], a[180:183], v[156:159]
    ds_read_b128 a[228:231], v105 offset:8192
    s_waitcnt lgkmcnt(3)
    v_mfma_f32_16x16x32_bf16 v[144:147], a[216:219], a[136:139], v[144:147]
    v_mfma_f32_16x16x32_bf16 v[148:151], a[216:219], a[152:155], v[148:151]
    v_mfma_f32_16x16x32_bf16 v[152:155], a[216:219], a[168:171], v[152:155]
    v_mfma_f32_16x16x32_bf16 v[156:159], a[216:219], a[184:187], v[156:159]
    ds_read_b128 a[232:235], v106 offset:8192
    s_waitcnt lgkmcnt(3)
    v_mfma_f32_16x16x32_bf16 v[144:147], a[220:223], a[140:143], v[144:147]
    v_mfma_f32_16x16x32_bf16 v[148:151], a[220:223], a[156:159], v[148:151]
    v_mfma_f32_16x16x32_bf16 v[152:155], a[220:223], a[172:175], v[152:155]
    v_mfma_f32_16x16x32_bf16 v[156:159], a[220:223], a[188:191], v[156:159]
    ds_read_b128 a[236:239], v107 offset:8192
    s_waitcnt lgkmcnt(3)
    v_mfma_f32_16x16x32_bf16 v[160:163], a[224:227], a[128:131], 0
    v_mfma_f32_16x16x32_bf16 v[164:167], a[224:227], a[144:147], 0
    v_mfma_f32_16x16x32_bf16 v[168:171], a[224:227], a[160:163], 0
    v_mfma_f32_16x16x32_bf16 v[172:175], a[224:227], a[176:179], 0
    ds_read_b128 a[240:243], v104 offset:12288
    s_waitcnt lgkmcnt(3)
    v_mfma_f32_16x16x32_bf16 v[160:163], a[228:231], a[132:135], v[160:163]
    v_mfma_f32_16x16x32_bf16 v[164:167], a[228:231], a[148:151], v[164:167]
    v_mfma_f32_16x16x32_bf16 v[168:171], a[228:231], a[164:167], v[168:171]
    v_mfma_f32_16x16x32_bf16 v[172:175], a[228:231], a[180:183], v[172:175]
    ds_read_b128 a[244:247], v105 offset:12288
    s_waitcnt lgkmcnt(3)
    v_mfma_f32_16x16x32_bf16 v[160:163], a[232:235], a[136:139], v[160:163]
    v_mfma_f32_16x16x32_bf16 v[164:167], a[232:235], a[152:155], v[164:167]
    v_mfma_f32_16x16x32_bf16 v[168:171], a[232:235], a[168:171], v[168:171]
    v_mfma_f32_16x16x32_bf16 v[172:175], a[232:235], a[184:187], v[172:175]
    ds_read_b128 a[248:251], v106 offset:12288
    s_waitcnt lgkmcnt(3)
    v_mfma_f32_16x16x32_bf16 v[160:163], a[236:239], a[140:143], v[160:163]
    v_mfma_f32_16x16x32_bf16 v[164:167], a[236:239], a[156:159], v[164:167]
    v_mfma_f32_16x16x32_bf16 v[168:171], a[236:239], a[172:175], v[168:171]
    v_mfma_f32_16x16x32_bf16 v[172:175], a[236:239], a[188:191], v[172:175]
    ds_read_b128 a[252:255], v107 offset:12288
    s_waitcnt lgkmcnt(3)
    v_mfma_f32_16x16x32_bf16 v[176:179], a[240:243], a[128:131], 0
    v_mfma_f32_16x16x32_bf16 v[180:183], a[240:243], a[144:147], 0
    v_mfma_f32_16x16x32_bf16 v[184:187], a[240:243], a[160:163], 0
    v_mfma_f32_16x16x32_bf16 v[188:191], a[240:243], a[176:179], 0
    s_waitcnt lgkmcnt(2)
    v_mfma_f32_16x16x32_bf16 v[176:179], a[244:247], a[132:135], v[176:179]
    v_mfma_f32_16x16x32_bf16 v[180:183], a[244:247], a[148:151], v[180:183]
    v_mfma_f32_16x16x32_bf16 v[184:187], a[244:247], a[164:167], v[184:187]
    v_mfma_f32_16x16x32_bf16 v[188:191], a[244:247], a[180:183], v[188:191]
    s_waitcnt lgkmcnt(1)
    v_mfma_f32_16x16x32_bf16 v[176:179], a[248:251], a[136:139], v[176:179]
    v_mfma_f32_16x16x32_bf16 v[180:183], a[248:251], a[152:155], v[180:183]
    v_mfma_f32_16x16x32_bf16 v[184:187], a[248:251], a[168:171], v[184:187]
    v_mfma_f32_16x16x32_bf16 v[188:191], a[248:251], a[184:187], v[188:191]
    s_waitcnt lgkmcnt(0)
    v_mfma_f32_16x16x32_bf16 v[176:179], a[252:255], a[140:143], v[176:179]
    v_mfma_f32_16x16x32_bf16 v[180:183], a[252:255], a[156:159], v[180:183]
    v_mfma_f32_16x16x32_bf16 v[184:187], a[252:255], a[172:175], v[184:187]
    v_mfma_f32_16x16x32_bf16 v[188:191], a[252:255], a[188:191], v[188:191]
    s_nop 7
    s_nop 7
    v_max3_f32 v124, v128, v129, v130
    v_max3_f32 v124, v124, v131, v144
    v_max3_f32 v124, v124, v145, v146
    v_max3_f32 v124, v124, v147, v160
    v_max3_f32 v124, v124, v161, v162
    v_max3_f32 v124, v124, v163, v176
    v_max3_f32 v124, v124, v177, v178
    v_max3_f32 v124, v124, v179, v179
    v_mov_b32 v36, v124
    v_mov_b32 v37, v124
    s_nop 1
    v_permlane16_swap_b32 v36, v37
    s_nop 1
    v_max_f32 v36, v36, v37
    v_mov_b32 v37, v36
    s_nop 1
    v_permlane32_swap_b32 v36, v37
    s_nop 1
    v_max_f32 v38, v36, v37
    v_sub_f32 v128, v128, v38
    v_sub_f32 v129, v129, v38
    v_sub_f32 v130, v130, v38
    v_sub_f32 v131, v131, v38
    v_sub_f32 v144, v144, v38
    v_sub_f32 v145, v145, v38
    v_sub_f32 v146, v146, v38
    v_sub_f32 v147, v147, v38
    v_sub_f32 v160, v160, v38
    v_sub_f32 v161, v161, v38
    v_sub_f32 v162, v162, v38
    v_sub_f32 v163, v163, v38
    v_sub_f32 v176, v176, v38
    v_sub_f32 v177, v177, v38
    v_sub_f32 v178, v178, v38
    v_sub_f32 v179, v179, v38
    v_sub_f32 v64, 0, v38
    v_sub_f32 v65, 0, v38
    v_sub_f32 v66, 0, v38
    v_sub_f32 v67, 0, v38
    v_max3_f32 v124, v132, v133, v134
    v_max3_f32 v124, v124, v135, v148
    v_max3_f32 v124, v124, v149, v150
    v_max3_f32 v124, v124, v151, v164
    v_max3_f32 v124, v124, v165, v166
    v_max3_f32 v124, v124, v167, v180
    v_max3_f32 v124, v124, v181, v182
    v_max3_f32 v124, v124, v183, v183
    v_mov_b32 v36, v124
    v_mov_b32 v37, v124
    s_nop 1
    v_permlane16_swap_b32 v36, v37
    s_nop 1
    v_max_f32 v36, v36, v37
    v_mov_b32 v37, v36
    s_nop 1
    v_permlane32_swap_b32 v36, v37
    s_nop 1
    v_max_f32 v38, v36, v37
    v_sub_f32 v132, v132, v38
    v_sub_f32 v133, v133, v38
    v_sub_f32 v134, v134, v38
    v_sub_f32 v135, v135, v38
    v_sub_f32 v148, v148, v38
    v_sub_f32 v149, v149, v38
    v_sub_f32 v150, v150, v38
    v_sub_f32 v151, v151, v38
    v_sub_f32 v164, v164, v38
    v_sub_f32 v165, v165, v38
    v_sub_f32 v166, v166, v38
    v_sub_f32 v167, v167, v38
    v_sub_f32 v180, v180, v38
    v_sub_f32 v181, v181, v38
    v_sub_f32 v182, v182, v38
    v_sub_f32 v183, v183, v38
    v_sub_f32 v68, 0, v38
    v_sub_f32 v69, 0, v38
    v_sub_f32 v70, 0, v38
    v_sub_f32 v71, 0, v38
    v_max3_f32 v124, v136, v137, v138
    v_max3_f32 v124, v124, v139, v152
    v_max3_f32 v124, v124, v153, v154
    v_max3_f32 v124, v124, v155, v168
    v_max3_f32 v124, v124, v169, v170
    v_max3_f32 v124, v124, v171, v184
    v_max3_f32 v124, v124, v185, v186
    v_max3_f32 v124, v124, v187, v187
    v_mov_b32 v36, v124
    v_mov_b32 v37, v124
    s_nop 1
    v_permlane16_swap_b32 v36, v37
    s_nop 1
    v_max_f32 v36, v36, v37
    v_mov_b32 v37, v36
    s_nop 1
    v_permlane32_swap_b32 v36, v37
    s_nop 1
    v_max_f32 v38, v36, v37
    v_sub_f32 v136, v136, v38
    v_sub_f32 v137, v137, v38
    v_sub_f32 v138, v138, v38
    v_sub_f32 v139, v139, v38
    v_sub_f32 v152, v152, v38
    v_sub_f32 v153, v153, v38
    v_sub_f32 v154, v154, v38
    v_sub_f32 v155, v155, v38
    v_sub_f32 v168, v168, v38
    v_sub_f32 v169, v169, v38
    v_sub_f32 v170, v170, v38
    v_sub_f32 v171, v171, v38
    v_sub_f32 v184, v184, v38
    v_sub_f32 v185, v185, v38
    v_sub_f32 v186, v186, v38
    v_sub_f32 v187, v187, v38
    v_sub_f32 v72, 0, v38
    v_sub_f32 v73, 0, v38
    v_sub_f32 v74, 0, v38
    v_sub_f32 v75, 0, v38
    v_max3_f32 v124, v140, v141, v142
    v_max3_f32 v124, v124, v143, v156
    v_max3_f32 v124, v124, v157, v158
    v_max3_f32 v124, v124, v159, v172
    v_max3_f32 v124, v124, v173, v174
    v_max3_f32 v124, v124, v175, v188
    v_max3_f32 v124, v124, v189, v190
    v_max3_f32 v124, v124, v191, v191
    v_mov_b32 v36, v124
    v_mov_b32 v37, v124
    s_nop 1
    v_permlane16_swap_b32 v36, v37
    s_nop 1
    v_max_f32 v36, v36, v37
    v_mov_b32 v37, v36
    s_nop 1
    v_permlane32_swap_b32 v36, v37
    s_nop 1
    v_max_f32 v38, v36, v37
    v_sub_f32 v140, v140, v38
    v_sub_f32 v141, v141, v38
    v_sub_f32 v142, v142, v38
    v_sub_f32 v143, v143, v38
    v_sub_f32 v156, v156, v38
    v_sub_f32 v157, v157, v38
    v_sub_f32 v158, v158, v38
    v_sub_f32 v159, v159, v38
    v_sub_f32 v172, v172, v38
    v_sub_f32 v173, v173, v38
    v_sub_f32 v174, v174, v38
    v_sub_f32 v175, v175, v38
    v_sub_f32 v188, v188, v38
    v_sub_f32 v189, v189, v38
    v_sub_f32 v190, v190, v38
    v_sub_f32 v191, v191, v38
    v_sub_f32 v76, 0, v38
    v_sub_f32 v77, 0, v38
    v_sub_f32 v78, 0, v38
    v_sub_f32 v79, 0, v38
    s_waitcnt vmcnt(20)
    s_barrier
    ds_read_b128 a[192:195], v104 offset:16384
    ds_read_b128 a[196:199], v105 offset:16384
    ds_read_b128 a[200:203], v106 offset:16384
    ds_read_b128 a[204:207], v107 offset:16384
    ds_read_b128 a[208:211], v104 offset:20480
    ds_read_b128 a[212:215], v105 offset:20480
    ds_read_b128 a[216:219], v106 offset:20480
    s_mov_b32 s41, 0
    s_mov_b32 s80, 0
at_loop:
    s_waitcnt lgkmcnt(3)
    v_mfma_f32_16x16x32_bf16 v[192:195], a[192:195], a[128:131], v[64:67]
    s_waitcnt vmcnt(8)
    s_barrier
    v_mfma_f32_16x16x32_bf16 v[196:199], a[192:195], a[144:147], v[68:71]
    ds_read_b128 a[220:223], v107 offset:20480
    v_mfma_f32_16x16x32_bf16 v[200:203], a[192:195], a[160:163], v[72:75]
    v_exp_f32 v128, v128
    v_mfma_f32_16x16x32_bf16 v[204:207], a[192:195], a[176:179], v[76:79]
    v_exp_f32 v129, v129
    v_mfma_f32_16x16x32_bf16 v[192:195], a[196:199], a[132:135], v[192:195]
    v_exp_f32 v130, v130
    v_mfma_f32_16x16x32_bf16 v[196:199], a[196:199], a[148:151], v[196:199]
    ds_read_b128 a[224:227], v104 offset:24576
    v_exp_f32 v131, v131
    v_mfma_f32_16x16x32_bf16 v[200:203], a[196:199], a[164:167], v[200:203]
    v_exp_f32 v144, v144
    v_mfma_f32_16x16x32_bf16 v[204:207], a[196:199], a[180:183], v[204:207]
    v_exp_f32 v145, v145
    v_mfma_f32_16x16x32_bf16 v[192:195], a[200:203], a[136:139], v[192:195]
    v_exp_f32 v146, v146
    v_mfma_f32_16x16x32_bf16 v[196:199], a[200:203], a[152:155], v[196:199]
    ds_read_b128 a[228:231], v105 offset:24576
    v_exp_f32 v147, v147
    v_mfma_f32_16x16x32_bf16 v[200:203], a[200:203], a[168:171], v[200:203]
    v_exp_f32 v132, v132
    v_mfma_f32_16x16x32_bf16 v[204:207], a[200:203], a[184:187], v[204:207]
    v_exp_f32 v133, v133
    v_mfma_f32_16x16x32_bf16 v[192:195], a[204:207], a[140:143], v[192:195]
    v_cvt_pk_bf16_f32 v4, v128, v129
    v_exp_f32 v134, v134
    v_mfma_f32_16x16x32_bf16 v[196:199], a[204:207], a[156:159], v[196:199]
    ds_read_b128 a[232:235], v106 offset:24576
    v_mfma_f32_16x16x32_bf16 v[200:203], a[204:207], a[172:175], v[200:203]
    v_exp_f32 v135, v135
    v_cvt_pk_bf16_f32 v5, v130, v131
    v_mfma_f32_16x16x32_bf16 v[204:207], a[204:207], a[188:191], v[204:207]
    v_exp_f32 v148, v148
    s_waitcnt lgkmcnt(3)
    v_mfma_f32_16x16x32_bf16 v[208:211], a[208:211], a[128:131], v[64:67]
    v_mfma_f32_16x16x32_bf16 v[212:215], a[208:211], a[144:147], v[68:71]
    ds_read_b128 a[236:239], v107 offset:24576
    v_exp_f32 v149, v149
    v_mfma_f32_16x16x32_bf16 v[216:219], a[208:211], a[160:163], v[72:75]
    v_cvt_pk_bf16_f32 v6, v144, v145
    v_exp_f32 v150, v150
    v_mfma_f32_16x16x32_bf16 v[220:223], a[208:211], a[176:179], v[76:79]
    v_exp_f32 v151, v151
    v_mfma_f32_16x16x32_bf16 v[208:211], a[212:215], a[132:135], v[208:211]
    v_cvt_pk_bf16_f32 v7, v146, v147
    v_mfma_f32_16x16x32_bf16 v[212:215], a[212:215], a[148:151], v[212:215]
    ds_read_b128 a[240:243], v104 offset:28672
    v_exp_f32 v136, v136
    v_mfma_f32_16x16x32_bf16 v[216:219], a[212:215], a[164:167], v[216:219]
    v_exp_f32 v137, v137
    v_mfma_f32_16x16x32_bf16 v[220:223], a[212:215], a[180:183], v[220:223]
    v_cvt_pk_bf16_f32 v8, v132, v133
    v_exp_f32 v138, v138
    v_mfma_f32_16x16x32_bf16 v[208:211], a[216:219], a[136:139], v[208:211]
    v_exp_f32 v139, v139
    v_mfma_f32_16x16x32_bf16 v[212:215], a[216:219], a[152:155], v[212:215]
    ds_read_b128 a[244:247], v105 offset:28672
    v_cvt_pk_bf16_f32 v9, v134, v135
    v_mfma_f32_16x16x32_bf16 v[216:219], a[216:219], a[168:171], v[216:219]
    v_exp_f32 v152, v152
    v_mfma_f32_16x16x32_bf16 v[220:223], a[216:219], a[184:187], v[220:223]
    v_exp_f32 v153, v153
    v_mfma_f32_16x16x32_bf16 v[208:211], a[220:223], a[140:143], v[208:211]
    v_cvt_pk_bf16_f32 v10, v148, v149
    v_exp_f32 v154, v154
    v_mfma_f32_16x16x32_bf16 v[212:215], a[220:223], a[156:159], v[212:215]
    ds_read_b128 a[248:251], v106 offset:28672
    v_mfma_f32_16x16x32_bf16 v[216:219], a[220:223], a[172:175], v[216:219]
    v_exp_f32 v155, v155
    v_cvt_pk_bf16_f32 v11, v150, v151
    v_mfma_f32_16x16x32_bf16 v[220:223], a[220:223], a[188:191], v[220:223]
    v_exp_f32 v140, v140
    s_waitcnt lgkmcnt(3)
    v_mfma_f32_16x16x32_bf16 v[224:227], a[224:227], a[128:131], v[64:67]
    v_exp_f32 v141, v141
    v_mfma_f32_16x16x32_bf16 v[228:231], a[224:227], a[144:147], v[68:71]
    ds_read_b128 a[252:255], v107 offset:28672
    v_cvt_pk_bf16_f32 v12, v136, v137
    v_mfma_f32_16x16x32_bf16 v[232:235], a[224:227], a[160:163], v[72:75]
    v_exp_f32 v142, v142
    v_mfma_f32_16x16x32_bf16 v[236:239], a[224:227], a[176:179], v[76:79]
    v_exp_f32 v143, v143
    v_mfma_f32_16x16x32_bf16 v[224:227], a[228:231], a[132:135], v[224:227]
    v_cvt_pk_bf16_f32 v13, v138, v139
    v_mfma_f32_16x16x32_bf16 v[228:231], a[228:231], a[148:151], v[228:231]
    ds_read_b64_tr_b16 a[192:193], v108 offset:0
    ds_read_b64_tr_b16 a[194:195], v108 offset:4096
    v_exp_f32 v156, v156
    v_mfma_f32_16x16x32_bf16 v[232:235], a[228:231], a[164:167], v[232:235]
    v_exp_f32 v157, v157
    v_mfma_f32_16x16x32_bf16 v[236:239], a[228:231], a[180:183], v[236:239]
    v_cvt_pk_bf16_f32 v14, v152, v153
    v_mfma_f32_16x16x32_bf16 v[224:227], a[232:235], a[136:139], v[224:227]
    v_exp_f32 v158, v158
    v_mfma_f32_16x16x32_bf16 v[228:231], a[232:235], a[152:155], v[228:231]
    ds_read_b64_tr_b16 a[196:197], v109 offset:0
    ds_read_b64_tr_b16 a[198:199], v109 offset:4096
    v_mfma_f32_16x16x32_bf16 v[232:235], a[232:235], a[168:171], v[232:235]
    v_exp_f32 v159, v159
    v_cvt_pk_bf16_f32 v15, v154, v155
    v_mfma_f32_16x16x32_bf16 v[236:239], a[232:235], a[184:187], v[236:239]
    v_exp_f32 v160, v160
    v_mfma_f32_16x16x32_bf16 v[224:227], a[236:239], a[140:143], v[224:227]
    v_exp_f32 v161, v161
    v_cvt_pk_bf16_f32 v16, v140, v141
    v_mfma_f32_16x16x32_bf16 v[228:231], a[236:239], a[156:159], v[228:231]
    ds_read_b64_tr_b16 a[200:201], v110 offset:0
    ds_read_b64_tr_b16 a[202:203], v110 offset:4096
    v_mfma_f32_16x16x32_bf16 v[232:235], a[236:239], a[172:175], v[232:235]
    v_exp_f32 v162, v162
    v_mfma_f32_16x16x32_bf16 v[236:239], a[236:239], a[188:191], v[236:239]
    v_exp_f32 v163, v163
    s_waitcnt lgkmcnt(6)
    v_mfma_f32_16x16x32_bf16 v[240:243], a[240:243], a[128:131], v[64:67]
    v_cvt_pk_bf16_f32 v17, v142, v143
    v_mfma_f32_16x16x32_bf16 v[244:247], a[240:243], a[144:147], v[68:71]
    ds_read_b64_tr_b16 a[204:205], v111 offset:0
    ds_read_b64_tr_b16 a[206:207], v111 offset:4096
    v_mfma_f32_16x16x32_bf16 v[248:251], a[240:243], a[160:163], v[72:75]
    v_exp_f32 v176, v176
    v_mfma_f32_16x16x32_bf16 v[252:255], a[240:243], a[176:179], v[76:79]
    v_exp_f32 v177, v177
    v_cvt_pk_bf16_f32 v18, v156, v157
    v_mfma_f32_16x16x32_bf16 v[240:243], a[244:247], a[132:135], v[240:243]
    v_exp_f32 v178, v178
    v_mfma_f32_16x16x32_bf16 v[244:247], a[244:247], a[148:151], v[244:247]
    ds_read_b64_tr_b16 a[208:209], v112 offset:0
    ds_read_b64_tr_b16 a[210:211], v112 offset:4096
    v_mfma_f32_16x16x32_bf16 v[248:251], a[244:247], a[164:167], v[248:251]
    v_exp_f32 v179, v179
    v_cvt_pk_bf16_f32 v19, v158, v159
    v_mfma_f32_16x16x32_bf16 v[252:255], a[244:247], a[180:183], v[252:255]
    v_exp_f32 v164, v164
    v_mfma_f32_16x16x32_bf16 v[240:243], a[248:251], a[136:139], v[240:243]
    v_exp_f32 v165, v165
    v_mfma_f32_16x16x32_bf16 v[244:247], a[248:251], a[152:155], v[244:247]
    ds_read_b64_tr_b16 a[212:213], v113 offset:0
    ds_read_b64_tr_b16 a[214:215], v113 offset:4096
    v_mfma_f32_16x16x32_bf16 v[248:251], a[248:251], a[168:171], v[248:251]
    v_cvt_pk_bf16_f32 v20, v160, v161
    v_exp_f32 v166, v166
    v_mfma_f32_16x16x32_bf16 v[252:255], a[248:251], a[184:187], v[252:255]
    v_exp_f32 v167, v167
    v_mfma_f32_16x16x32_bf16 v[240:243], a[252:255], a[140:143], v[240:243]
    v_cvt_pk_bf16_f32 v21, v162, v163
    v_mfma_f32_16x16x32_bf16 v[244:247], a[252:255], a[156:159], v[244:247]
    ds_read_b64_tr_b16 a[216:217], v114 offset:0
    ds_read_b64_tr_b16 a[218:219], v114 offset:4096
    v_mfma_f32_16x16x32_bf16 v[248:251], a[252:255], a[172:175], v[248:251]
    v_exp_f32 v180, v180
    v_exp_f32 v181, v181
    v_mfma_f32_16x16x32_bf16 v[252:255], a[252:255], a[188:191], v[252:255]
    v_cvt_pk_bf16_f32 v22, v176, v177
    v_mfma_f32_16x16x32_bf16 v[80:83], v[60:63], v[4:7], v[80:83]
    v_exp_f32 v182, v182
    v_mfma_f32_16x16x32_bf16 v[84:87], v[60:63], v[8:11], v[84:87]
    v_exp_f32 v183, v183
    v_cvt_pk_bf16_f32 v23, v178, v179
    v_mfma_f32_16x16x32_bf16 v[88:91], v[60:63], v[12:15], v[88:91]
    v_exp_f32 v168, v168
    v_mfma_f32_16x16x32_bf16 v[92:95], v[60:63], v[16:19], v[92:95]
    v_exp_f32 v169, v169
    s_waitcnt lgkmcnt(6)
    v_mfma_f32_16x16x32_bf16 a[0:3], a[192:195], v[4:7], a[0:3]
    v_cvt_pk_bf16_f32 v24, v164, v165
    v_mfma_f32_16x16x32_bf16 a[4:7], a[192:195], v[8:11], a[4:7]
    ds_read_b64_tr_b16 a[220:221], v115 offset:0
    ds_read_b64_tr_b16 a[222:223], v115 offset:4096
    v_mfma_f32_16x16x32_bf16 a[8:11], a[192:195], v[12:15], a[8:11]
    v_exp_f32 v170, v170
    v_mfma_f32_16x16x32_bf16 a[12:15], a[192:195], v[16:19], a[12:15]
    v_exp_f32 v171, v171
    v_cvt_pk_bf16_f32 v25, v166, v167
    v_mfma_f32_16x16x32_bf16 a[16:19], a[196:199], v[4:7], a[16:19]
    v_exp_f32 v184, v184
    v_mfma_f32_16x16x32_bf16 a[20:23], a[196:199], v[8:11], a[20:23]
    ds_read_b64_tr_b16 a[224:225], v108 offset:8192
    ds_read_b64_tr_b16 a[226:227], v108 offset:12288
    v_mfma_f32_16x16x32_bf16 a[24:27], a[196:199], v[12:15], a[24:27]
    v_exp_f32 v185, v185
    v_cvt_pk_bf16_f32 v26, v180, v181
    v_mfma_f32_16x16x32_bf16 a[28:31], a[196:199], v[16:19], a[28:31]
    v_exp_f32 v186, v186
    v_mfma_f32_16x16x32_bf16 a[32:35], a[200:203], v[4:7], a[32:35]
    v_exp_f32 v187, v187
    v_mfma_f32_16x16x32_bf16 a[36:39], a[200:203], v[8:11], a[36:39]
    ds_read_b64_tr_b16 a[228:229], v109 offset:8192
    ds_read_b64_tr_b16 a[230:231], v109 offset:12288
    v_mfma_f32_16x16x32_bf16 a[40:43], a[200:203], v[12:15], a[40:43]
    v_cvt_pk_bf16_f32 v27, v182, v183
    v_exp_f32 v172, v172
    v_mfma_f32_16x16x32_bf16 a[44:47], a[200:203], v[16:19], a[44:47]
    v_exp_f32 v173, v173
    v_mfma_f32_16x16x32_bf16 a[48:51], a[204:207], v[4:7], a[48:51]
    v_cvt_pk_bf16_f32 v28, v168, v169
    v_mfma_f32_16x16x32_bf16 a[52:55], a[204:207], v[8:11], a[52:55]
    ds_read_b64_tr_b16 a[232:233], v110 offset:8192
    ds_read_b64_tr_b16 a[234:235], v110 offset:12288
    v_mfma_f32_16x16x32_bf16 a[56:59], a[204:207], v[12:15], a[56:59]
    v_exp_f32 v174, v174
    v_exp_f32 v175, v175
    v_mfma_f32_16x16x32_bf16 a[60:63], a[204:207], v[16:19], a[60:63]
    v_cvt_pk_bf16_f32 v29, v170, v171
    s_waitcnt lgkmcnt(6)
    v_mfma_f32_16x16x32_bf16 a[64:67], a[208:211], v[4:7], a[64:67]
    v_exp_f32 v188, v188
    v_mfma_f32_16x16x32_bf16 a[68:71], a[208:211], v[8:11], a[68:71]
    ds_read_b64_tr_b16 a[236:237], v111 offset:8192
    ds_read_b64_tr_b16 a[238:239], v111 offset:12288
    v_mfma_f32_16x16x32_bf16 a[72:75], a[208:211], v[12:15], a[72:75]
    v_exp_f32 v189, v189
    v_mfma_f32_16x16x32_bf16 a[76:79], a[208:211], v[16:19], a[76:79]
    v_cvt_pk_bf16_f32 v30, v184, v185
    v_exp_f32 v190, v190
    v_mfma_f32_16x16x32_bf16 a[80:83], a[212:215], v[4:7], a[80:83]
    v_exp_f32 v191, v191
    v_mfma_f32_16x16x32_bf16 a[84:87], a[212:215], v[8:11], a[84:87]
    ds_read_b64_tr_b16 a[240:241], v112 offset:8192
    ds_read_b64_tr_b16 a[242:243], v112 offset:12288
    v_mfma_f32_16x16x32_bf16 a[88:91], a[212:215], v[12:15], a[88:91]
    v_cvt_pk_bf16_f32 v31, v186, v187
    v_cvt_pk_bf16_f32 v32, v172, v173
    v_mfma_f32_16x16x32_bf16 a[92:95], a[212:215], v[16:19], a[92:95]
    v_cvt_pk_bf16_f32 v33, v174, v175
    v_cvt_pk_bf16_f32 v34, v188, v189
    v_mfma_f32_16x16x32_bf16 a[96:99], a[216:219], v[4:7], a[96:99]
    v_cvt_pk_bf16_f32 v35, v190, v191
    v_max3_f32 v124, v192, v193, v194
    v_mfma_f32_16x16x32_bf16 a[100:103], a[216:219], v[8:11], a[100:103]
    ds_read_b64_tr_b16 a[244:245], v113 offset:8192
    ds_read_b64_tr_b16 a[246:247], v113 offset:12288
    v_mfma_f32_16x16x32_bf16 a[104:107], a[216:219], v[12:15], a[104:107]
    v_max3_f32 v125, v196, v197, v198
    v_max3_f32 v124, v124, v195, v200
    v_mfma_f32_16x16x32_bf16 a[108:111], a[216:219], v[16:19], a[108:111]
    v_max3_f32 v125, v125, v199, v204
    v_max3_f32 v124, v124, v201, v202
    v_mfma_f32_16x16x32_bf16 a[112:115], a[220:223], v[4:7], a[112:115]
    v_max3_f32 v125, v125, v205, v206
    v_max3_f32 v124, v124, v203, v208
    v_mfma_f32_16x16x32_bf16 a[116:119], a[220:223], v[8:11], a[116:119]
    ds_read_b64_tr_b16 a[248:249], v114 offset:8192
    ds_read_b64_tr_b16 a[250:251], v114 offset:12288
    v_mfma_f32_16x16x32_bf16 a[120:123], a[220:223], v[12:15], a[120:123]
    v_max3_f32 v125, v125, v207, v212
    v_max3_f32 v124, v124, v209, v210
    v_mfma_f32_16x16x32_bf16 a[124:127], a[220:223], v[16:19], a[124:127]
    v_max3_f32 v125, v125, v213, v214
    v_max3_f32 v124, v124, v211, v216
    v_mfma_f32_16x16x32_bf16 v[80:83], v[60:63], v[20:23], v[80:83]
    v_max3_f32 v125, v125, v215, v220
    v_max3_f32 v124, v124, v217, v218
    v_mfma_f32_16x16x32_bf16 v[84:87], v[60:63], v[24:27], v[84:87]
    v_max3_f32 v125, v125, v221, v222
    v_max3_f32 v124, v124, v219, v224
    v_mfma_f32_16x16x32_bf16 v[88:91], v[60:63], v[28:31], v[88:91]
    v_max3_f32 v125, v125, v223, v228
    v_max3_f32 v124, v124, v225, v226
    v_mfma_f32_16x16x32_bf16 v[92:95], v[60:63], v[32:35], v[92:95]
    v_max3_f32 v125, v125, v229, v230
    v_max3_f32 v124, v124, v227, v232
    s_waitcnt lgkmcnt(6)
    v_mfma_f32_16x16x32_bf16 a[0:3], a[224:227], v[20:23], a[0:3]
    v_max3_f32 v125, v125, v231, v236
    v_mfma_f32_16x16x32_bf16 a[4:7], a[224:227], v[24:27], a[4:7]
    ds_read_b64_tr_b16 a[252:253], v115 offset:8192
    ds_read_b64_tr_b16 a[254:255], v115 offset:12288
    v_mfma_f32_16x16x32_bf16 a[8:11], a[224:227], v[28:31], a[8:11]
    v_max3_f32 v124, v124, v233, v234
    v_max3_f32 v125, v125, v237, v238
    v_mfma_f32_16x16x32_bf16 a[12:15], a[224:227], v[32:35], a[12:15]
    s_add_u32 m0, s78, 0x0
    s_nop 0
    buffer_load_dwordx4 v116, s[56:59], s76 offen offset:0 lds
    v_mfma_f32_16x16x32_bf16 a[16:19], a[228:231], v[20:23], a[16:19]
    v_max3_f32 v124, v124, v235, v240
    v_mfma_f32_16x16x32_bf16 a[20:23], a[228:231], v[24:27], a[20:23]
    ds_read_b128 a[192:195], v104 offset:32768
    v_max3_f32 v125, v125, v239, v244
    v_mfma_f32_16x16x32_bf16 a[24:27], a[228:231], v[28:31], a[24:27]
    v_max3_f32 v124, v124, v241, v242
    v_max3_f32 v125, v125, v245, v246
    v_mfma_f32_16x16x32_bf16 a[28:31], a[228:231], v[32:35], a[28:31]
    buffer_load_dwordx4 v117, s[56:59], s76 offen offset:1024 lds
    v_max3_f32 v124, v124, v243, v248
    v_mfma_f32_16x16x32_bf16 a[32:35], a[232:235], v[20:23], a[32:35]
    v_max3_f32 v125, v125, v247, v252
    v_max3_f32 v124, v124, v249, v250
    v_mfma_f32_16x16x32_bf16 a[36:39], a[232:235], v[24:27], a[36:39]
    ds_read_b128 a[196:199], v105 offset:32768
    v_max3_f32 v125, v125, v253, v254
    v_mfma_f32_16x16x32_bf16 a[40:43], a[232:235], v[28:31], a[40:43]
    v_max3_f32 v124, v124, v251, v251
    v_max3_f32 v125, v125, v255, v255
    v_mfma_f32_16x16x32_bf16 a[44:47], a[232:235], v[32:35], a[44:47]
    buffer_load_dwordx4 v118, s[56:59], s76 offen offset:2048 lds
    v_max_f32 v126, v124, v125
    v_mfma_f32_16x16x32_bf16 a[48:51], a[236:239], v[20:23], a[48:51]
    v_cmp_lt_f32 vcc, s79, v126
    v_mfma_f32_16x16x32_bf16 a[52:55], a[236:239], v[24:27], a[52:55]
    ds_read_b128 a[200:203], v106 offset:32768
    v_mfma_f32_16x16x32_bf16 a[56:59], a[236:239], v[28:31], a[56:59]
    v_mfma_f32_16x16x32_bf16 a[60:63], a[236:239], v[32:35], a[60:63]
    buffer_load_dwordx4 v119, s[56:59], s76 offen offset:3072 lds
    s_add_u32 s76, s76, 0x4000
    s_and_b32 s76, s76, 0x7ffff
    s_waitcnt lgkmcnt(3)
    v_mfma_f32_16x16x32_bf16 a[64:67], a[240:243], v[20:23], a[64:67]
    v_mfma_f32_16x16x32_bf16 a[68:71], a[240:243], v[24:27], a[68:71]
    ds_read_b128 a[204:207], v107 offset:32768
    v_mfma_f32_16x16x32_bf16 a[72:75], a[240:243], v[28:31], a[72:75]
    v_mfma_f32_16x16x32_bf16 a[76:79], a[240:243], v[32:35], a[76:79]
    s_add_u32 m0, s78, 0x1c000
    s_nop 0
    buffer_load_dwordx4 v120, s[60:63], s77 offen offset:0 lds
    v_mfma_f32_16x16x32_bf16 a[80:83], a[244:247], v[20:23], a[80:83]
    v_mfma_f32_16x16x32_bf16 a[84:87], a[244:247], v[24:27], a[84:87]
    ds_read_b128 a[208:211], v104 offset:36864
    v_mfma_f32_16x16x32_bf16 a[88:91], a[244:247], v[28:31], a[88:91]
    v_mfma_f32_16x16x32_bf16 a[92:95], a[244:247], v[32:35], a[92:95]
    buffer_load_dwordx4 v121, s[60:63], s77 offen offset:1024 lds
    v_mfma_f32_16x16x32_bf16 a[96:99], a[248:251], v[20:23], a[96:99]
    v_mfma_f32_16x16x32_bf16 a[100:103], a[248:251], v[24:27], a[100:103]
    ds_read_b128 a[212:215], v105 offset:36864
    v_mfma_f32_16x16x32_bf16 a[104:107], a[248:251], v[28:31], a[104:107]
    v_mfma_f32_16x16x32_bf16 a[108:111], a[248:251], v[32:35], a[108:111]
    buffer_load_dwordx4 v120, s[60:63], s77 offen offset:2048 lds
    v_mfma_f32_16x16x32_bf16 a[112:115], a[252:255], v[20:23], a[112:115]
    v_mfma_f32_16x16x32_bf16 a[116:119], a[252:255], v[24:27], a[116:119]
    ds_read_b128 a[216:219], v106 offset:36864
    v_mfma_f32_16x16x32_bf16 a[120:123], a[252:255], v[28:31], a[120:123]
    v_mfma_f32_16x16x32_bf16 a[124:127], a[252:255], v[32:35], a[124:127]
    buffer_load_dwordx4 v121, s[60:63], s77 offen offset:3072 lds
    s_add_u32 s77, s77, 0x4000
    s_and_b32 s77, s77, 0x7ffff
    buffer_load_dword v123, v122, s[68:71], s80 offen
    s_cbranch_vccnz at_rare0
at_back0:
    s_waitcnt lgkmcnt(3)
    v_mfma_f32_16x16x32_bf16 v[128:131], a[192:195], a[128:131], v[64:67]
    s_waitcnt vmcnt(9)
    s_barrier
    v_mfma_f32_16x16x32_bf16 v[132:135], a[192:195], a[144:147], v[68:71]
    ds_read_b128 a[220:223], v107 offset:36864
    v_mfma_f32_16x16x32_bf16 v[136:139], a[192:195], a[160:163], v[72:75]
    v_exp_f32 v192, v192
    v_mfma_f32_16x16x32_bf16 v[140:143], a[192:195], a[176:179], v[76:79]
    v_exp_f32 v193, v193
    v_mfma_f32_16x16x32_bf16 v[128:131], a[196:199], a[132:135], v[128:131]
    v_exp_f32 v194, v194
    v_mfma_f32_16x16x32_bf16 v[132:135], a[196:199], a[148:151], v[132:135]
    ds_read_b128 a[224:227], v104 offset:40960
    v_exp_f32 v195, v195
    v_mfma_f32_16x16x32_bf16 v[136:139], a[196:199], a[164:167], v[136:139]
    v_exp_f32 v208, v208
    v_mfma_f32_16x16x32_bf16 v[140:143], a[196:199], a[180:183], v[140:143]
    v_exp_f32 v209, v209
    v_mfma_f32_16x16x32_bf16 v[128:131], a[200:203], a[136:139], v[128:131]
    v_exp_f32 v210, v210
    v_mfma_f32_16x16x32_bf16 v[132:135], a[200:203], a[152:155], v[132:135]
    ds_read_b128 a[228:231], v105 offset:40960
    v_exp_f32 v211, v211
    v_mfma_f32_16x16x32_bf16 v[136:139], a[200:203], a[168:171], v[136:139]
    v_exp_f32 v196, v196
    v_mfma_f32_16x16x32_bf16 v[140:143], a[200:203], a[184:187], v[140:143]
    v_exp_f32 v197, v197
    v_mfma_f32_16x16x32_bf16 v[128:131], a[204:207], a[140:143], v[128:131]
    v_cvt_pk_bf16_f32 v4, v192, v193
    v_exp_f32 v198, v198
    v_mfma_f32_16x16x32_bf16 v[132:135], a[204:207], a[156:159], v[132:135]
    ds_read_b128 a[232:235], v106 offset:40960
    v_mfma_f32_16x16x32_bf16 v[136:139], a[204:207], a[172:175], v[136:139]
    v_exp_f32 v199, v199
    v_cvt_pk_bf16_f32 v5, v194, v195
    v_mfma_f32_16x16x32_bf16 v[140:143], a[204:207], a[188:191], v[140:143]
    v_exp_f32 v212, v212
    s_waitcnt lgkmcnt(3)
    v_mfma_f32_16x16x32_bf16 v[144:147], a[208:211], a[128:131], v[64:67]
    v_mfma_f32_16x16x32_bf16 v[148:151], a[208:211], a[144:147], v[68:71]
    ds_read_b128 a[236:239], v107 offset:40960
    v_exp_f32 v213, v213
    v_mfma_f32_16x16x32_bf16 v[152:155], a[208:211], a[160:163], v[72:75]
    v_cvt_pk_bf16_f32 v6, v208, v209
    v_exp_f32 v214, v214
    v_mfma_f32_16x16x32_bf16 v[156:159], a[208:211], a[176:179], v[76:79]
    v_exp_f32 v215, v215
    v_mfma_f32_16x16x32_bf16 v[144:147], a[212:215], a[132:135], v[144:147]
    v_cvt_pk_bf16_f32 v7, v210, v211
    v_mfma_f32_16x16x32_bf16 v[148:151], a[212:215], a[148:151], v[148:151]
    ds_read_b128 a[240:243], v104 offset:45056
    v_exp_f32 v200, v200
    v_mfma_f32_16x16x32_bf16 v[152:155], a[212:215], a[164:167], v[152:155]
    v_exp_f32 v201, v201
    v_mfma_f32_16x16x32_bf16 v[156:159], a[212:215], a[180:183], v[156:159]
    v_cvt_pk_bf16_f32 v8, v196, v197
    v_exp_f32 v202, v202
    v_mfma_f32_16x16x32_bf16 v[144:147], a[216:219], a[136:139], v[144:147]
    v_exp_f32 v203, v203
    v_mfma_f32_16x16x32_bf16 v[148:151], a[216:219], a[152:155], v[148:151]
    ds_read_b128 a[244:247], v105 offset:45056
    v_cvt_pk_bf16_f32 v9, v198, v199
    v_mfma_f32_16x16x32_bf16 v[152:155], a[216:219], a[168:171], v[152:155]
    v_exp_f32 v216, v216
    v_mfma_f32_16x16x32_bf16 v[156:159], a[216:219], a[184:187], v[156:159]
    v_exp_f32 v217, v217
    v_mfma_f32_16x16x32_bf16 v[144:147], a[220:223], a[140:143], v[144:147]
    v_cvt_pk_bf16_f32 v10, v212, v213
    v_exp_f32 v218, v218
    v_mfma_f32_16x16x32_bf16 v[148:151], a[220:223], a[156:159], v[148:151]
    ds_read_b128 a[248:251], v106 offset:45056
    v_mfma_f32_16x16x32_bf16 v[152:155], a[220:223], a[172:175], v[152:155]
    v_exp_f32 v219, v219
    v_cvt_pk_bf16_f32 v11, v214, v215
    v_mfma_f32_16x16x32_bf16 v[156:159], a[220:223], a[188:191], v[156:159]
    v_exp_f32 v204, v204
    s_waitcnt lgkmcnt(3)
    v_mfma_f32_16x16x32_bf16 v[160:163], a[224:227], a[128:131], v[64:67]
    v_exp_f32 v205, v205
    v_mfma_f32_16x16x32_bf16 v[164:167], a[224:227], a[144:147], v[68:71]
    ds_read_b128 a[252:255], v107 offset:45056
    v_cvt_pk_bf16_f32 v12, v200, v201
    v_mfma_f32_16x16x32_bf16 v[168:171], a[224:227], a[160:163], v[72:75]
    v_exp_f32 v206, v206
    v_mfma_f32_16x16x32_bf16 v[172:175], a[224:227], a[176:179], v[76:79]
    v_exp_f32 v207, v207
    v_mfma_f32_16x16x32_bf16 v[160:163], a[228:231], a[132:135], v[160:163]
    v_cvt_pk_bf16_f32 v13, v202, v203
    v_mfma_f32_16x16x32_bf16 v[164:167], a[228:231], a[148:151], v[164:167]
    ds_read_b64_tr_b16 a[192:193], v108 offset:16384
    ds_read_b64_tr_b16 a[194:195], v108 offset:20480
    v_exp_f32 v220, v220
    v_mfma_f32_16x16x32_bf16 v[168:171], a[228:231], a[164:167], v[168:171]
    v_exp_f32 v221, v221
    v_mfma_f32_16x16x32_bf16 v[172:175], a[228:231], a[180:183], v[172:175]
    v_cvt_pk_bf16_f32 v14, v216, v217
    v_mfma_f32_16x16x32_bf16 v[160:163], a[232:235], a[136:139], v[160:163]
    v_exp_f32 v222, v222
    v_mfma_f32_16x16x32_bf16 v[164:167], a[232:235], a[152:155], v[164:167]
    ds_read_b64_tr_b16 a[196:197], v109 offset:16384
    ds_read_b64_tr_b16 a[198:199], v109 offset:20480
    v_mfma_f32_16x16x32_bf16 v[168:171], a[232:235], a[168:171], v[168:171]
    v_exp_f32 v223, v223
    v_cvt_pk_bf16_f32 v15, v218, v219
    v_mfma_f32_16x16x32_bf16 v[172:175], a[232:235], a[184:187], v[172:175]
    v_exp_f32 v224, v224
    v_mfma_f32_16x16x32_bf16 v[160:163], a[236:239], a[140:143], v[160:163]
    v_exp_f32 v225, v225
    v_cvt_pk_bf16_f32 v16, v204, v205
    v_mfma_f32_16x16x32_bf16 v[164:167], a[236:239], a[156:159], v[164:167]
    ds_read_b64_tr_b16 a[200:201], v110 offset:16384
    ds_read_b64_tr_b16 a[202:203], v110 offset:20480
    v_mfma_f32_16x16x32_bf16 v[168:171], a[236:239], a[172:175], v[168:171]
    v_exp_f32 v226, v226
    v_mfma_f32_16x16x32_bf16 v[172:175], a[236:239], a[188:191], v[172:175]
    v_exp_f32 v227, v227
    s_waitcnt lgkmcnt(6)
    v_mfma_f32_16x16x32_bf16 v[176:179], a[240:243], a[128:131], v[64:67]
    v_cvt_pk_bf16_f32 v17, v206, v207
    v_mfma_f32_16x16x32_bf16 v[180:183], a[240:243], a[144:147], v[68:71]
    ds_read_b64_tr_b16 a[204:205], v111 offset:16384
    ds_read_b64_tr_b16 a[206:207], v111 offset:20480
    v_mfma_f32_16x16x32_bf16 v[184:187], a[240:243], a[160:163], v[72:75]
    v_exp_f32 v240, v240
    v_mfma_f32_16x16x32_bf16 v[188:191], a[240:243], a[176:179], v[76:79]
    v_exp_f32 v241, v241
    v_cvt_pk_bf16_f32 v18, v220, v221
    v_mfma_f32_16x16x32_bf16 v[176:179], a[244:247], a[132:135], v[176:179]
    v_exp_f32 v242, v242
    v_mfma_f32_16x16x32_bf16 v[180:183], a[244:247], a[148:151], v[180:183]
    ds_read_b64_tr_b16 a[208:209], v112 offset:16384
    ds_read_b64_tr_b16 a[210:211], v112 offset:20480
    v_mfma_f32_16x16x32_bf16 v[184:187], a[244:247], a[164:167], v[184:187]
    v_exp_f32 v243, v243
    v_cvt_pk_bf16_f32 v19, v222, v223
    v_mfma_f32_16x16x32_bf16 v[188:191], a[244:247], a[180:183], v[188:191]
    v_exp_f32 v228, v228
    v_mfma_f32_16x16x32_bf16 v[176:179], a[248:251], a[136:139], v[176:179]
    v_exp_f32 v229, v229
    v_mfma_f32_16x16x32_bf16 v[180:183], a[248:251], a[152:155], v[180:183]
    ds_read_b64_tr_b16 a[212:213], v113 offset:16384
    ds_read_b64_tr_b16 a[214:215], v113 offset:20480
    v_mfma_f32_16x16x32_bf16 v[184:187], a[248:251], a[168:171], v[184:187]
    v_cvt_pk_bf16_f32 v20, v224, v225
    v_exp_f32 v230, v230
    v_mfma_f32_16x16x32_bf16 v[188:191], a[248:251], a[184:187], v[188:191]
    v_exp_f32 v231, v231
    v_mfma_f32_16x16x32_bf16 v[176:179], a[252:255], a[140:143], v[176:179]
    v_cvt_pk_bf16_f32 v21, v226, v227
    v_mfma_f32_16x16x32_bf16 v[180:183], a[252:255], a[156:159], v[180:183]
    ds_read_b64_tr_b16 a[216:217], v114 offset:16384
    ds_read_b64_tr_b16 a[218:219], v114 offset:20480
    v_mfma_f32_16x16x32_bf16 v[184:187], a[252:255], a[172:175], v[184:187]
    v_exp_f32 v244, v244
    v_exp_f32 v245, v245
    v_mfma_f32_16x16x32_bf16 v[188:191], a[252:255], a[188:191], v[188:191]
    v_cvt_pk_bf16_f32 v22, v240, v241
    v_mfma_f32_16x16x32_bf16 v[80:83], v[60:63], v[4:7], v[80:83]
    v_exp_f32 v246, v246
    v_mfma_f32_16x16x32_bf16 v[84:87], v[60:63], v[8:11], v[84:87]
    v_exp_f32 v247, v247
    v_cvt_pk_bf16_f32 v23, v242, v243
    v_mfma_f32_16x16x32_bf16 v[88:91], v[60:63], v[12:15], v[88:91]
    v_exp_f32 v232, v232
    v_mfma_f32_16x16x32_bf16 v[92:95], v[60:63], v[16:19], v[92:95]
    v_exp_f32 v233, v233
    s_waitcnt lgkmcnt(6)
    v_mfma_f32_16x16x32_bf16 a[0:3], a[192:195], v[4:7], a[0:3]
    v_cvt_pk_bf16_f32 v24, v228, v229
    v_mfma_f32_16x16x32_bf16 a[4:7], a[192:195], v[8:11], a[4:7]
    ds_read_b64_tr_b16 a[220:221], v115 offset:16384
    ds_read_b64_tr_b16 a[222:223], v115 offset:20480
    v_mfma_f32_16x16x32_bf16 a[8:11], a[192:195], v[12:15], a[8:11]
    v_exp_f32 v234, v234
    v_mfma_f32_16x16x32_bf16 a[12:15], a[192:195], v[16:19], a[12:15]
    v_exp_f32 v235, v235
    v_cvt_pk_bf16_f32 v25, v230, v231
    v_mfma_f32_16x16x32_bf16 a[16:19], a[196:199], v[4:7], a[16:19]
    v_exp_f32 v248, v248
    v_mfma_f32_16x16x32_bf16 a[20:23], a[196:199], v[8:11], a[20:23]
    ds_read_b64_tr_b16 a[224:225], v108 offset:24576
    ds_read_b64_tr_b16 a[226:227], v108 offset:28672
    v_mfma_f32_16x16x32_bf16 a[24:27], a[196:199], v[12:15], a[24:27]
    v_exp_f32 v249, v249
    v_cvt_pk_bf16_f32 v26, v244, v245
    v_mfma_f32_16x16x32_bf16 a[28:31], a[196:199], v[16:19], a[28:31]
    v_exp_f32 v250, v250
    v_mfma_f32_16x16x32_bf16 a[32:35], a[200:203], v[4:7], a[32:35]
    v_exp_f32 v251, v251
    v_mfma_f32_16x16x32_bf16 a[36:39], a[200:203], v[8:11], a[36:39]
    ds_read_b64_tr_b16 a[228:229], v109 offset:24576
    ds_read_b64_tr_b16 a[230:231], v109 offset:28672
    v_mfma_f32_16x16x32_bf16 a[40:43], a[200:203], v[12:15], a[40:43]
    v_cvt_pk_bf16_f32 v27, v246, v247
    v_exp_f32 v236, v236
    v_mfma_f32_16x16x32_bf16 a[44:47], a[200:203], v[16:19], a[44:47]
    v_exp_f32 v237, v237
    v_mfma_f32_16x16x32_bf16 a[48:51], a[204:207], v[4:7], a[48:51]
    v_cvt_pk_bf16_f32 v28, v232, v233
    v_mfma_f32_16x16x32_bf16 a[52:55], a[204:207], v[8:11], a[52:55]
    ds_read_b64_tr_b16 a[232:233], v110 offset:24576
    ds_read_b64_tr_b16 a[234:235], v110 offset:28672
    v_mfma_f32_16x16x32_bf16 a[56:59], a[204:207], v[12:15], a[56:59]
    v_exp_f32 v238, v238
    v_exp_f32 v239, v239
    v_mfma_f32_16x16x32_bf16 a[60:63], a[204:207], v[16:19], a[60:63]
    v_cvt_pk_bf16_f32 v29, v234, v235
    s_waitcnt lgkmcnt(6)
    v_mfma_f32_16x16x32_bf16 a[64:67], a[208:211], v[4:7], a[64:67]
    v_exp_f32 v252, v252
    v_mfma_f32_16x16x32_bf16 a[68:71], a[208:211], v[8:11], a[68:71]
    ds_read_b64_tr_b16 a[236:237], v111 offset:24576
    ds_read_b64_tr_b16 a[238:239], v111 offset:28672
    v_mfma_f32_16x16x32_bf16 a[72:75], a[208:211], v[12:15], a[72:75]
    v_exp_f32 v253, v253
    v_mfma_f32_16x16x32_bf16 a[76:79], a[208:211], v[16:19], a[76:79]
    v_cvt_pk_bf16_f32 v30, v248, v249
    v_exp_f32 v254, v254
    v_mfma_f32_16x16x32_bf16 a[80:83], a[212:215], v[4:7], a[80:83]
    v_exp_f32 v255, v255
    v_mfma_f32_16x16x32_bf16 a[84:87], a[212:215], v[8:11], a[84:87]
    ds_read_b64_tr_b16 a[240:241], v112 offset:24576
    ds_read_b64_tr_b16 a[242:243], v112 offset:28672
    v_mfma_f32_16x16x32_bf16 a[88:91], a[212:215], v[12:15], a[88:91]
    v_cvt_pk_bf16_f32 v31, v250, v251
    v_cvt_pk_bf16_f32 v32, v236, v237
    v_mfma_f32_16x16x32_bf16 a[92:95], a[212:215], v[16:19], a[92:95]
    v_cvt_pk_bf16_f32 v33, v238, v239
    v_cvt_pk_bf16_f32 v34, v252, v253
    v_mfma_f32_16x16x32_bf16 a[96:99], a[216:219], v[4:7], a[96:99]
    v_cvt_pk_bf16_f32 v35, v254, v255
    v_max3_f32 v124, v128, v129, v130
    v_mfma_f32_16x16x32_bf16 a[100:103], a[216:219], v[8:11], a[100:103]
    ds_read_b64_tr_b16 a[244:245], v113 offset:24576
    ds_read_b64_tr_b16 a[246:247], v113 offset:28672
    v_mfma_f32_16x16x32_bf16 a[104:107], a[216:219], v[12:15], a[104:107]
    v_max3_f32 v125, v132, v133, v134
    v_max3_f32 v124, v124, v131, v136
    v_mfma_f32_16x16x32_bf16 a[108:111], a[216:219], v[16:19], a[108:111]
    v_max3_f32 v125, v125, v135, v140
    v_max3_f32 v124, v124, v137, v138
    v_mfma_f32_16x16x32_bf16 a[112:115], a[220:223], v[4:7], a[112:115]
    v_max3_f32 v125, v125, v141, v142
    v_max3_f32 v124, v124, v139, v144
    v_mfma_f32_16x16x32_bf16 a[116:119], a[220:223], v[8:11], a[116:119]
    ds_read_b64_tr_b16 a[248:249], v114 offset:24576
    ds_read_b64_tr_b16 a[250:251], v114 offset:28672
    v_mfma_f32_16x16x32_bf16 a[120:123], a[220:223], v[12:15], a[120:123]
    v_max3_f32 v125, v125, v143, v148
    v_max3_f32 v124, v124, v145, v146
    v_mfma_f32_16x16x32_bf16 a[124:127], a[220:223], v[16:19], a[124:127]
    v_max3_f32 v125, v125, v149, v150
    v_max3_f32 v124, v124, v147, v152
    v_mfma_f32_16x16x32_bf16 v[80:83], v[60:63], v[20:23], v[80:83]
    v_max3_f32 v125, v125, v151, v156
    v_max3_f32 v124, v124, v153, v154
    v_mfma_f32_16x16x32_bf16 v[84:87], v[60:63], v[24:27], v[84:87]
    v_max3_f32 v125, v125, v157, v158
    v_max3_f32 v124, v124, v155, v160
    v_mfma_f32_16x16x32_bf16 v[88:91], v[60:63], v[28:31], v[88:91]
    v_max3_f32 v125, v125, v159, v164
    v_max3_f32 v124, v124, v161, v162
    v_mfma_f32_16x16x32_bf16 v[92:95], v[60:63], v[32:35], v[92:95]
    v_max3_f32 v125, v125, v165, v166
    v_max3_f32 v124, v124, v163, v168
    s_waitcnt lgkmcnt(6)
    v_mfma_f32_16x16x32_bf16 a[0:3], a[224:227], v[20:23], a[0:3]
    v_max3_f32 v125, v125, v167, v172
    v_mfma_f32_16x16x32_bf16 a[4:7], a[224:227], v[24:27], a[4:7]
    ds_read_b64_tr_b16 a[252:253], v115 offset:24576
    ds_read_b64_tr_b16 a[254:255], v115 offset:28672
    v_mfma_f32_16x16x32_bf16 a[8:11], a[224:227], v[28:31], a[8:11]
    v_max3_f32 v124, v124, v169, v170
    v_max3_f32 v125, v125, v173, v174
    v_mfma_f32_16x16x32_bf16 a[12:15], a[224:227], v[32:35], a[12:15]
    s_add_u32 m0, s78, 0x4000
    s_nop 0
    buffer_load_dwordx4 v116, s[56:59], s76 offen offset:0 lds
    v_mfma_f32_16x16x32_bf16 a[16:19], a[228:231], v[20:23], a[16:19]
    v_max3_f32 v124, v124, v171, v176
    v_mfma_f32_16x16x32_bf16 a[20:23], a[228:231], v[24:27], a[20:23]
    ds_read_b128 a[192:195], v104 offset:49152
    v_max3_f32 v125, v125, v175, v180
    v_mfma_f32_16x16x32_bf16 a[24:27], a[228:231], v[28:31], a[24:27]
    v_max3_f32 v124, v124, v177, v178
    v_max3_f32 v125, v125, v181, v182
    v_mfma_f32_16x16x32_bf16 a[28:31], a[228:231], v[32:35], a[28:31]
    buffer_load_dwordx4 v117, s[56:59], s76 offen offset:1024 lds
    v_max3_f32 v124, v124, v179, v184
    v_mfma_f32_16x16x32_bf16 a[32:35], a[232:235], v[20:23], a[32:35]
    v_max3_f32 v125, v125, v183, v188
    v_max3_f32 v124, v124, v185, v186
    v_mfma_f32_16x16x32_bf16 a[36:39], a[232:235], v[24:27], a[36:39]
    ds_read_b128 a[196:199], v105 offset:49152
    v_max3_f32 v125, v125, v189, v190
    v_mfma_f32_16x16x32_bf16 a[40:43], a[232:235], v[28:31], a[40:43]
    v_max3_f32 v124, v124, v187, v187
    v_max3_f32 v125, v125, v191, v191
    v_mfma_f32_16x16x32_bf16 a[44:47], a[232:235], v[32:35], a[44:47]
    buffer_load_dwordx4 v118, s[56:59], s76 offen offset:2048 lds
    v_max_f32 v126, v124, v125
    v_mfma_f32_16x16x32_bf16 a[48:51], a[236:239], v[20:23], a[48:51]
    v_cmp_lt_f32 vcc, s79, v126
    v_mfma_f32_16x16x32_bf16 a[52:55], a[236:239], v[24:27], a[52:55]
    ds_read_b128 a[200:203], v106 offset:49152
    v_mfma_f32_16x16x32_bf16 a[56:59], a[236:239], v[28:31], a[56:59]
    v_mfma_f32_16x16x32_bf16 a[60:63], a[236:239], v[32:35], a[60:63]
    buffer_load_dwordx4 v119, s[56:59], s76 offen offset:3072 lds
    s_add_u32 s76, s76, 0x4000
    s_and_b32 s76, s76, 0x7ffff
    s_waitcnt lgkmcnt(3)
    v_mfma_f32_16x16x32_bf16 a[64:67], a[240:243], v[20:23], a[64:67]
    v_mfma_f32_16x16x32_bf16 a[68:71], a[240:243], v[24:27], a[68:71]
    ds_read_b128 a[204:207], v107 offset:49152
    v_mfma_f32_16x16x32_bf16 a[72:75], a[240:243], v[28:31], a[72:75]
    v_mfma_f32_16x16x32_bf16 a[76:79], a[240:243], v[32:35], a[76:79]
    s_add_u32 m0, s78, 0x10000
    s_nop 0
    buffer_load_dwordx4 v120, s[60:63], s77 offen offset:0 lds
    v_mfma_f32_16x16x32_bf16 a[80:83], a[244:247], v[20:23], a[80:83]
    v_mfma_f32_16x16x32_bf16 a[84:87], a[244:247], v[24:27], a[84:87]
    ds_read_b128 a[208:211], v104 offset:53248
    v_mfma_f32_16x16x32_bf16 a[88:91], a[244:247], v[28:31], a[88:91]
    v_mfma_f32_16x16x32_bf16 a[92:95], a[244:247], v[32:35], a[92:95]
    buffer_load_dwordx4 v121, s[60:63], s77 offen offset:1024 lds
    v_mfma_f32_16x16x32_bf16 a[96:99], a[248:251], v[20:23], a[96:99]
    v_mfma_f32_16x16x32_bf16 a[100:103], a[248:251], v[24:27], a[100:103]
    ds_read_b128 a[212:215], v105 offset:53248
    v_mfma_f32_16x16x32_bf16 a[104:107], a[248:251], v[28:31], a[104:107]
    v_mfma_f32_16x16x32_bf16 a[108:111], a[248:251], v[32:35], a[108:111]
    buffer_load_dwordx4 v120, s[60:63], s77 offen offset:2048 lds
    v_mfma_f32_16x16x32_bf16 a[112:115], a[252:255], v[20:23], a[112:115]
    v_mfma_f32_16x16x32_bf16 a[116:119], a[252:255], v[24:27], a[116:119]
    ds_read_b128 a[216:219], v106 offset:53248
    v_mfma_f32_16x16x32_bf16 a[120:123], a[252:255], v[28:31], a[120:123]
    v_mfma_f32_16x16x32_bf16 a[124:127], a[252:255], v[32:35], a[124:127]
    buffer_load_dwordx4 v121, s[60:63], s77 offen offset:3072 lds
    s_add_u32 s77, s77, 0x4000
    s_and_b32 s77, s77, 0x7ffff
    s_cbranch_vccnz at_rare1
at_back1:
    s_waitcnt lgkmcnt(3)
    v_mfma_f32_16x16x32_bf16 v[192:195], a[192:195], a[128:131], v[64:67]
    s_waitcnt vmcnt(8)
    s_barrier
    v_mfma_f32_16x16x32_bf16 v[196:199], a[192:195], a[144:147], v[68:71]
    ds_read_b128 a[220:223], v107 offset:53248
    v_mfma_f32_16x16x32_bf16 v[200:203], a[192:195], a[160:163], v[72:75]
    v_exp_f32 v128, v128
    v_mfma_f32_16x16x32_bf16 v[204:207], a[192:195], a[176:179], v[76:79]
    v_exp_f32 v129, v129
    v_mfma_f32_16x16x32_bf16 v[192:195], a[196:199], a[132:135], v[192:195]
    v_exp_f32 v130, v130
    v_mfma_f32_16x16x32_bf16 v[196:199], a[196:199], a[148:151], v[196:199]
    ds_read_b128 a[224:227], v104 offset:57344
    v_exp_f32 v131, v131
    v_mfma_f32_16x16x32_bf16 v[200:203], a[196:199], a[164:167], v[200:203]
    v_exp_f32 v144, v144
    v_mfma_f32_16x16x32_bf16 v[204:207], a[196:199], a[180:183], v[204:207]
    v_exp_f32 v145, v145
    v_mfma_f32_16x16x32_bf16 v[192:195], a[200:203], a[136:139], v[192:195]
    v_exp_f32 v146, v146
    v_mfma_f32_16x16x32_bf16 v[196:199], a[200:203], a[152:155], v[196:199]
    ds_read_b128 a[228:231], v105 offset:57344
    v_exp_f32 v147, v147
    v_mfma_f32_16x16x32_bf16 v[200:203], a[200:203], a[168:171], v[200:203]
    v_exp_f32 v132, v132
    v_mfma_f32_16x16x32_bf16 v[204:207], a[200:203], a[184:187], v[204:207]
    v_exp_f32 v133, v133
    v_mfma_f32_16x16x32_bf16 v[192:195], a[204:207], a[140:143], v[192:195]
    v_cvt_pk_bf16_f32 v4, v128, v129
    v_exp_f32 v134, v134
    v_mfma_f32_16x16x32_bf16 v[196:199], a[204:207], a[156:159], v[196:199]
    ds_read_b128 a[232:235], v106 offset:57344
    v_mfma_f32_16x16x32_bf16 v[200:203], a[204:207], a[172:175], v[200:203]
    v_exp_f32 v135, v135
    v_cvt_pk_bf16_f32 v5, v130, v131
    v_mfma_f32_16x16x32_bf16 v[204:207], a[204:207], a[188:191], v[204:207]
    v_exp_f32 v148, v148
    s_waitcnt lgkmcnt(3)
    v_mfma_f32_16x16x32_bf16 v[208:211], a[208:211], a[128:131], v[64:67]
    v_mfma_f32_16x16x32_bf16 v[212:215], a[208:211], a[144:147], v[68:71]
    ds_read_b128 a[236:239], v107 offset:57344
    v_exp_f32 v149, v149
    v_mfma_f32_16x16x32_bf16 v[216:219], a[208:211], a[160:163], v[72:75]
    v_cvt_pk_bf16_f32 v6, v144, v145
    v_exp_f32 v150, v150
    v_mfma_f32_16x16x32_bf16 v[220:223], a[208:211], a[176:179], v[76:79]
    v_exp_f32 v151, v151
    v_mfma_f32_16x16x32_bf16 v[208:211], a[212:215], a[132:135], v[208:211]
    v_cvt_pk_bf16_f32 v7, v146, v147
    v_mfma_f32_16x16x32_bf16 v[212:215], a[212:215], a[148:151], v[212:215]
    ds_read_b128 a[240:243], v104 offset:61440
    v_exp_f32 v136, v136
    v_mfma_f32_16x16x32_bf16 v[216:219], a[212:215], a[164:167], v[216:219]
    v_exp_f32 v137, v137
    v_mfma_f32_16x16x32_bf16 v[220:223], a[212:215], a[180:183], v[220:223]
    v_cvt_pk_bf16_f32 v8, v132, v133
    v_exp_f32 v138, v138
    v_mfma_f32_16x16x32_bf16 v[208:211], a[216:219], a[136:139], v[208:211]
    v_exp_f32 v139, v139
    v_mfma_f32_16x16x32_bf16 v[212:215], a[216:219], a[152:155], v[212:215]
    ds_read_b128 a[244:247], v105 offset:61440
    v_cvt_pk_bf16_f32 v9, v134, v135
    v_mfma_f32_16x16x32_bf16 v[216:219], a[216:219], a[168:171], v[216:219]
    v_exp_f32 v152, v152
    v_mfma_f32_16x16x32_bf16 v[220:223], a[216:219], a[184:187], v[220:223]
    v_exp_f32 v153, v153
    v_mfma_f32_16x16x32_bf16 v[208:211], a[220:223], a[140:143], v[208:211]
    v_cvt_pk_bf16_f32 v10, v148, v149
    v_exp_f32 v154, v154
    v_mfma_f32_16x16x32_bf16 v[212:215], a[220:223], a[156:159], v[212:215]
    ds_read_b128 a[248:251], v106 offset:61440
    v_mfma_f32_16x16x32_bf16 v[216:219], a[220:223], a[172:175], v[216:219]
    v_exp_f32 v155, v155
    v_cvt_pk_bf16_f32 v11, v150, v151
    v_mfma_f32_16x16x32_bf16 v[220:223], a[220:223], a[188:191], v[220:223]
    v_exp_f32 v140, v140
    s_waitcnt lgkmcnt(3)
    v_mfma_f32_16x16x32_bf16 v[224:227], a[224:227], a[128:131], v[64:67]
    v_exp_f32 v141, v141
    v_mfma_f32_16x16x32_bf16 v[228:231], a[224:227], a[144:147], v[68:71]
    ds_read_b128 a[252:255], v107 offset:61440
    v_cvt_pk_bf16_f32 v12, v136, v137
    v_mfma_f32_16x16x32_bf16 v[232:235], a[224:227], a[160:163], v[72:75]
    v_exp_f32 v142, v142
    v_mfma_f32_16x16x32_bf16 v[236:239], a[224:227], a[176:179], v[76:79]
    v_exp_f32 v143, v143
    v_mfma_f32_16x16x32_bf16 v[224:227], a[228:231], a[132:135], v[224:227]
    v_cvt_pk_bf16_f32 v13, v138, v139
    v_mfma_f32_16x16x32_bf16 v[228:231], a[228:231], a[148:151], v[228:231]
    ds_read_b64_tr_b16 a[192:193], v108 offset:32768
    ds_read_b64_tr_b16 a[194:195], v108 offset:36864
    v_exp_f32 v156, v156
    v_mfma_f32_16x16x32_bf16 v[232:235], a[228:231], a[164:167], v[232:235]
    v_exp_f32 v157, v157
    v_mfma_f32_16x16x32_bf16 v[236:239], a[228:231], a[180:183], v[236:239]
    v_cvt_pk_bf16_f32 v14, v152, v153
    v_mfma_f32_16x16x32_bf16 v[224:227], a[232:235], a[136:139], v[224:227]
    v_exp_f32 v158, v158
    v_mfma_f32_16x16x32_bf16 v[228:231], a[232:235], a[152:155], v[228:231]
    ds_read_b64_tr_b16 a[196:197], v109 offset:32768
    ds_read_b64_tr_b16 a[198:199], v109 offset:36864
    v_mfma_f32_16x16x32_bf16 v[232:235], a[232:235], a[168:171], v[232:235]
    v_exp_f32 v159, v159
    v_cvt_pk_bf16_f32 v15, v154, v155
    v_mfma_f32_16x16x32_bf16 v[236:239], a[232:235], a[184:187], v[236:239]
    v_exp_f32 v160, v160
    v_mfma_f32_16x16x32_bf16 v[224:227], a[236:239], a[140:143], v[224:227]
    v_exp_f32 v161, v161
    v_cvt_pk_bf16_f32 v16, v140, v141
    v_mfma_f32_16x16x32_bf16 v[228:231], a[236:239], a[156:159], v[228:231]
    ds_read_b64_tr_b16 a[200:201], v110 offset:32768
    ds_read_b64_tr_b16 a[202:203], v110 offset:36864
    v_mfma_f32_16x16x32_bf16 v[232:235], a[236:239], a[172:175], v[232:235]
    v_exp_f32 v162, v162
    v_mfma_f32_16x16x32_bf16 v[236:239], a[236:239], a[188:191], v[236:239]
    v_exp_f32 v163, v163
    s_waitcnt lgkmcnt(6)
    v_mfma_f32_16x16x32_bf16 v[240:243], a[240:243], a[128:131], v[64:67]
    v_cvt_pk_bf16_f32 v17, v142, v143
    v_mfma_f32_16x16x32_bf16 v[244:247], a[240:243], a[144:147], v[68:71]
    ds_read_b64_tr_b16 a[204:205], v111 offset:32768
    ds_read_b64_tr_b16 a[206:207], v111 offset:36864
    v_mfma_f32_16x16x32_bf16 v[248:251], a[240:243], a[160:163], v[72:75]
    v_exp_f32 v176, v176
    v_mfma_f32_16x16x32_bf16 v[252:255], a[240:243], a[176:179], v[76:79]
    v_exp_f32 v177, v177
    v_cvt_pk_bf16_f32 v18, v156, v157
    v_mfma_f32_16x16x32_bf16 v[240:243], a[244:247], a[132:135], v[240:243]
    v_exp_f32 v178, v178
    v_mfma_f32_16x16x32_bf16 v[244:247], a[244:247], a[148:151], v[244:247]
    ds_read_b64_tr_b16 a[208:209], v112 offset:32768
    ds_read_b64_tr_b16 a[210:211], v112 offset:36864
    v_mfma_f32_16x16x32_bf16 v[248:251], a[244:247], a[164:167], v[248:251]
    v_exp_f32 v179, v179
    v_cvt_pk_bf16_f32 v19, v158, v159
    v_mfma_f32_16x16x32_bf16 v[252:255], a[244:247], a[180:183], v[252:255]
    v_exp_f32 v164, v164
    v_mfma_f32_16x16x32_bf16 v[240:243], a[248:251], a[136:139], v[240:243]
    v_exp_f32 v165, v165
    v_mfma_f32_16x16x32_bf16 v[244:247], a[248:251], a[152:155], v[244:247]
    ds_read_b64_tr_b16 a[212:213], v113 offset:32768
    ds_read_b64_tr_b16 a[214:215], v113 offset:36864
    v_mfma_f32_16x16x32_bf16 v[248:251], a[248:251], a[168:171], v[248:251]
    v_cvt_pk_bf16_f32 v20, v160, v161
    v_exp_f32 v166, v166
    v_mfma_f32_16x16x32_bf16 v[252:255], a[248:251], a[184:187], v[252:255]
    v_exp_f32 v167, v167
    v_mfma_f32_16x16x32_bf16 v[240:243], a[252:255], a[140:143], v[240:243]
    v_cvt_pk_bf16_f32 v21, v162, v163
    v_mfma_f32_16x16x32_bf16 v[244:247], a[252:255], a[156:159], v[244:247]
    ds_read_b64_tr_b16 a[216:217], v114 offset:32768
    ds_read_b64_tr_b16 a[218:219], v114 offset:36864
    v_mfma_f32_16x16x32_bf16 v[248:251], a[252:255], a[172:175], v[248:251]
    v_exp_f32 v180, v180
    v_exp_f32 v181, v181
    v_mfma_f32_16x16x32_bf16 v[252:255], a[252:255], a[188:191], v[252:255]
    v_cvt_pk_bf16_f32 v22, v176, v177
    v_mfma_f32_16x16x32_bf16 v[80:83], v[60:63], v[4:7], v[80:83]
    v_exp_f32 v182, v182
    v_mfma_f32_16x16x32_bf16 v[84:87], v[60:63], v[8:11], v[84:87]
    v_exp_f32 v183, v183
    v_cvt_pk_bf16_f32 v23, v178, v179
    v_mfma_f32_16x16x32_bf16 v[88:91], v[60:63], v[12:15], v[88:91]
    v_exp_f32 v168, v168
    v_mfma_f32_16x16x32_bf16 v[92:95], v[60:63], v[16:19], v[92:95]
    v_exp_f32 v169, v169
    s_waitcnt lgkmcnt(6)
    v_mfma_f32_16x16x32_bf16 a[0:3], a[192:195], v[4:7], a[0:3]
    v_cvt_pk_bf16_f32 v24, v164, v165
    v_mfma_f32_16x16x32_bf16 a[4:7], a[192:195], v[8:11], a[4:7]
    ds_read_b64_tr_b16 a[220:221], v115 offset:32768
    ds_read_b64_tr_b16 a[222:223], v115 offset:36864
    v_mfma_f32_16x16x32_bf16 a[8:11], a[192:195], v[12:15], a[8:11]
    v_exp_f32 v170, v170
    v_mfma_f32_16x16x32_bf16 a[12:15], a[192:195], v[16:19], a[12:15]
    v_exp_f32 v171, v171
    v_cvt_pk_bf16_f32 v25, v166, v167
    v_mfma_f32_16x16x32_bf16 a[16:19], a[196:199], v[4:7], a[16:19]
    v_exp_f32 v184, v184
    v_mfma_f32_16x16x32_bf16 a[20:23], a[196:199], v[8:11], a[20:23]
    ds_read_b64_tr_b16 a[224:225], v108 offset:40960
    ds_read_b64_tr_b16 a[226:227], v108 offset:45056
    v_mfma_f32_16x16x32_bf16 a[24:27], a[196:199], v[12:15], a[24:27]
    v_exp_f32 v185, v185
    v_cvt_pk_bf16_f32 v26, v180, v181
    v_mfma_f32_16x16x32_bf16 a[28:31], a[196:199], v[16:19], a[28:31]
    v_exp_f32 v186, v186
    v_mfma_f32_16x16x32_bf16 a[32:35], a[200:203], v[4:7], a[32:35]
    v_exp_f32 v187, v187
    v_mfma_f32_16x16x32_bf16 a[36:39], a[200:203], v[8:11], a[36:39]
    ds_read_b64_tr_b16 a[228:229], v109 offset:40960
    ds_read_b64_tr_b16 a[230:231], v109 offset:45056
    v_mfma_f32_16x16x32_bf16 a[40:43], a[200:203], v[12:15], a[40:43]
    v_cvt_pk_bf16_f32 v27, v182, v183
    v_exp_f32 v172, v172
    v_mfma_f32_16x16x32_bf16 a[44:47], a[200:203], v[16:19], a[44:47]
    v_exp_f32 v173, v173
    v_mfma_f32_16x16x32_bf16 a[48:51], a[204:207], v[4:7], a[48:51]
    v_cvt_pk_bf16_f32 v28, v168, v169
    v_mfma_f32_16x16x32_bf16 a[52:55], a[204:207], v[8:11], a[52:55]
    ds_read_b64_tr_b16 a[232:233], v110 offset:40960
    ds_read_b64_tr_b16 a[234:235], v110 offset:45056
    v_mfma_f32_16x16x32_bf16 a[56:59], a[204:207], v[12:15], a[56:59]
    v_exp_f32 v174, v174
    v_exp_f32 v175, v175
    v_mfma_f32_16x16x32_bf16 a[60:63], a[204:207], v[16:19], a[60:63]
    v_cvt_pk_bf16_f32 v29, v170, v171
    s_waitcnt lgkmcnt(6)
    v_mfma_f32_16x16x32_bf16 a[64:67], a[208:211], v[4:7], a[64:67]
    v_exp_f32 v188, v188
    v_mfma_f32_16x16x32_bf16 a[68:71], a[208:211], v[8:11], a[68:71]
    ds_read_b64_tr_b16 a[236:237], v111 offset:40960
    ds_read_b64_tr_b16 a[238:239], v111 offset:45056
    v_mfma_f32_16x16x32_bf16 a[72:75], a[208:211], v[12:15], a[72:75]
    v_exp_f32 v189, v189
    v_mfma_f32_16x16x32_bf16 a[76:79], a[208:211], v[16:19], a[76:79]
    v_cvt_pk_bf16_f32 v30, v184, v185
    v_exp_f32 v190, v190
    v_mfma_f32_16x16x32_bf16 a[80:83], a[212:215], v[4:7], a[80:83]
    v_exp_f32 v191, v191
    v_mfma_f32_16x16x32_bf16 a[84:87], a[212:215], v[8:11], a[84:87]
    ds_read_b64_tr_b16 a[240:241], v112 offset:40960
    ds_read_b64_tr_b16 a[242:243], v112 offset:45056
    v_mfma_f32_16x16x32_bf16 a[88:91], a[212:215], v[12:15], a[88:91]
    v_cvt_pk_bf16_f32 v31, v186, v187
    v_cvt_pk_bf16_f32 v32, v172, v173
    v_mfma_f32_16x16x32_bf16 a[92:95], a[212:215], v[16:19], a[92:95]
    v_cvt_pk_bf16_f32 v33, v174, v175
    v_cvt_pk_bf16_f32 v34, v188, v189
    v_mfma_f32_16x16x32_bf16 a[96:99], a[216:219], v[4:7], a[96:99]
    v_cvt_pk_bf16_f32 v35, v190, v191
    v_max3_f32 v124, v192, v193, v194
    v_mfma_f32_16x16x32_bf16 a[100:103], a[216:219], v[8:11], a[100:103]
    ds_read_b64_tr_b16 a[244:245], v113 offset:40960
    ds_read_b64_tr_b16 a[246:247], v113 offset:45056
    v_mfma_f32_16x16x32_bf16 a[104:107], a[216:219], v[12:15], a[104:107]
    v_max3_f32 v125, v196, v197, v198
    v_max3_f32 v124, v124, v195, v200
    v_mfma_f32_16x16x32_bf16 a[108:111], a[216:219], v[16:19], a[108:111]
    v_max3_f32 v125, v125, v199, v204
    v_max3_f32 v124, v124, v201, v202
    v_mfma_f32_16x16x32_bf16 a[112:115], a[220:223], v[4:7], a[112:115]
    v_max3_f32 v125, v125, v205, v206
    v_max3_f32 v124, v124, v203, v208
    v_mfma_f32_16x16x32_bf16 a[116:119], a[220:223], v[8:11], a[116:119]
    ds_read_b64_tr_b16 a[248:249], v114 offset:40960
    ds_read_b64_tr_b16 a[250:251], v114 offset:45056
    v_mfma_f32_16x16x32_bf16 a[120:123], a[220:223], v[12:15], a[120:123]
    v_max3_f32 v125, v125, v207, v212
    v_max3_f32 v124, v124, v209, v210
    v_mfma_f32_16x16x32_bf16 a[124:127], a[220:223], v[16:19], a[124:127]
    v_max3_f32 v125, v125, v213, v214
    v_max3_f32 v124, v124, v211, v216
    v_mfma_f32_16x16x32_bf16 v[80:83], v[60:63], v[20:23], v[80:83]
    v_max3_f32 v125, v125, v215, v220
    v_max3_f32 v124, v124, v217, v218
    v_mfma_f32_16x16x32_bf16 v[84:87], v[60:63], v[24:27], v[84:87]
    v_max3_f32 v125, v125, v221, v222
    v_max3_f32 v124, v124, v219, v224
    v_mfma_f32_16x16x32_bf16 v[88:91], v[60:63], v[28:31], v[88:91]
    v_max3_f32 v125, v125, v223, v228
    v_max3_f32 v124, v124, v225, v226
    v_mfma_f32_16x16x32_bf16 v[92:95], v[60:63], v[32:35], v[92:95]
    v_max3_f32 v125, v125, v229, v230
    v_max3_f32 v124, v124, v227, v232
    s_waitcnt lgkmcnt(6)
    v_mfma_f32_16x16x32_bf16 a[0:3], a[224:227], v[20:23], a[0:3]
    v_max3_f32 v125, v125, v231, v236
    v_mfma_f32_16x16x32_bf16 a[4:7], a[224:227], v[24:27], a[4:7]
    ds_read_b64_tr_b16 a[252:253], v115 offset:40960
    ds_read_b64_tr_b16 a[254:255], v115 offset:45056
    v_mfma_f32_16x16x32_bf16 a[8:11], a[224:227], v[28:31], a[8:11]
    v_max3_f32 v124, v124, v233, v234
    v_max3_f32 v125, v125, v237, v238
    v_mfma_f32_16x16x32_bf16 a[12:15], a[224:227], v[32:35], a[12:15]
    s_add_u32 m0, s78, 0x8000
    s_nop 0
    buffer_load_dwordx4 v116, s[56:59], s76 offen offset:0 lds
    v_mfma_f32_16x16x32_bf16 a[16:19], a[228:231], v[20:23], a[16:19]
    v_max3_f32 v124, v124, v235, v240
    v_mfma_f32_16x16x32_bf16 a[20:23], a[228:231], v[24:27], a[20:23]
    ds_read_b128 a[192:195], v104 offset:0
    v_max3_f32 v125, v125, v239, v244
    v_mfma_f32_16x16x32_bf16 a[24:27], a[228:231], v[28:31], a[24:27]
    v_max3_f32 v124, v124, v241, v242
    v_max3_f32 v125, v125, v245, v246
    v_mfma_f32_16x16x32_bf16 a[28:31], a[228:231], v[32:35], a[28:31]
    buffer_load_dwordx4 v117, s[56:59], s76 offen offset:1024 lds
    v_max3_f32 v124, v124, v243, v248
    v_mfma_f32_16x16x32_bf16 a[32:35], a[232:235], v[20:23], a[32:35]
    v_max3_f32 v125, v125, v247, v252
    v_max3_f32 v124, v124, v249, v250
    v_mfma_f32_16x16x32_bf16 a[36:39], a[232:235], v[24:27], a[36:39]
    ds_read_b128 a[196:199], v105 offset:0
    v_max3_f32 v125, v125, v253, v254
    v_mfma_f32_16x16x32_bf16 a[40:43], a[232:235], v[28:31], a[40:43]
    v_max3_f32 v124, v124, v251, v251
    v_max3_f32 v125, v125, v255, v255
    v_mfma_f32_16x16x32_bf16 a[44:47], a[232:235], v[32:35], a[44:47]
    buffer_load_dwordx4 v118, s[56:59], s76 offen offset:2048 lds
    v_max_f32 v126, v124, v125
    v_mfma_f32_16x16x32_bf16 a[48:51], a[236:239], v[20:23], a[48:51]
    v_cmp_lt_f32 vcc, s79, v126
    v_mfma_f32_16x16x32_bf16 a[52:55], a[236:239], v[24:27], a[52:55]
    ds_read_b128 a[200:203], v106 offset:0
    v_mfma_f32_16x16x32_bf16 a[56:59], a[236:239], v[28:31], a[56:59]
    v_mfma_f32_16x16x32_bf16 a[60:63], a[236:239], v[32:35], a[60:63]
    buffer_load_dwordx4 v119, s[56:59], s76 offen offset:3072 lds
    s_add_u32 s76, s76, 0x4000
    s_and_b32 s76, s76, 0x7ffff
    s_waitcnt lgkmcnt(3)
    v_mfma_f32_16x16x32_bf16 a[64:67], a[240:243], v[20:23], a[64:67]
    v_mfma_f32_16x16x32_bf16 a[68:71], a[240:243], v[24:27], a[68:71]
    ds_read_b128 a[204:207], v107 offset:0
    v_mfma_f32_16x16x32_bf16 a[72:75], a[240:243], v[28:31], a[72:75]
    v_mfma_f32_16x16x32_bf16 a[76:79], a[240:243], v[32:35], a[76:79]
    s_add_u32 m0, s78, 0x14000
    s_nop 0
    buffer_load_dwordx4 v120, s[60:63], s77 offen offset:0 lds
    v_mfma_f32_16x16x32_bf16 a[80:83], a[244:247], v[20:23], a[80:83]
    v_mfma_f32_16x16x32_bf16 a[84:87], a[244:247], v[24:27], a[84:87]
    ds_read_b128 a[208:211], v104 offset:4096
    v_mfma_f32_16x16x32_bf16 a[88:91], a[244:247], v[28:31], a[88:91]
    v_mfma_f32_16x16x32_bf16 a[92:95], a[244:247], v[32:35], a[92:95]
    buffer_load_dwordx4 v121, s[60:63], s77 offen offset:1024 lds
    v_mfma_f32_16x16x32_bf16 a[96:99], a[248:251], v[20:23], a[96:99]
    v_mfma_f32_16x16x32_bf16 a[100:103], a[248:251], v[24:27], a[100:103]
    ds_read_b128 a[212:215], v105 offset:4096
    v_mfma_f32_16x16x32_bf16 a[104:107], a[248:251], v[28:31], a[104:107]
    v_mfma_f32_16x16x32_bf16 a[108:111], a[248:251], v[32:35], a[108:111]
    buffer_load_dwordx4 v120, s[60:63], s77 offen offset:2048 lds
    v_mfma_f32_16x16x32_bf16 a[112:115], a[252:255], v[20:23], a[112:115]
    v_mfma_f32_16x16x32_bf16 a[116:119], a[252:255], v[24:27], a[116:119]
    ds_read_b128 a[216:219], v106 offset:4096
    v_mfma_f32_16x16x32_bf16 a[120:123], a[252:255], v[28:31], a[120:123]
    v_mfma_f32_16x16x32_bf16 a[124:127], a[252:255], v[32:35], a[124:127]
    buffer_load_dwordx4 v121, s[60:63], s77 offen offset:3072 lds
    s_add_u32 s77, s77, 0x4000
    s_and_b32 s77, s77, 0x7ffff
    buffer_load_dword v123, v122, s[72:75], s80 offen
    s_add_u32 s80, s80, 0x400000
    s_cbranch_vccnz at_rare2
at_back2:
    s_waitcnt lgkmcnt(3)
    v_mfma_f32_16x16x32_bf16 v[128:131], a[192:195], a[128:131], v[64:67]
    s_waitcnt vmcnt(9)
    s_barrier
    v_mfma_f32_16x16x32_bf16 v[132:135], a[192:195], a[144:147], v[68:71]
    ds_read_b128 a[220:223], v107 offset:4096
    v_mfma_f32_16x16x32_bf16 v[136:139], a[192:195], a[160:163], v[72:75]
    v_exp_f32 v192, v192
    v_mfma_f32_16x16x32_bf16 v[140:143], a[192:195], a[176:179], v[76:79]
    v_exp_f32 v193, v193
    v_mfma_f32_16x16x32_bf16 v[128:131], a[196:199], a[132:135], v[128:131]
    v_exp_f32 v194, v194
    v_mfma_f32_16x16x32_bf16 v[132:135], a[196:199], a[148:151], v[132:135]
    ds_read_b128 a[224:227], v104 offset:8192
    v_exp_f32 v195, v195
    v_mfma_f32_16x16x32_bf16 v[136:139], a[196:199], a[164:167], v[136:139]
    v_exp_f32 v208, v208
    v_mfma_f32_16x16x32_bf16 v[140:143], a[196:199], a[180:183], v[140:143]
    v_exp_f32 v209, v209
    v_mfma_f32_16x16x32_bf16 v[128:131], a[200:203], a[136:139], v[128:131]
    v_exp_f32 v210, v210
    v_mfma_f32_16x16x32_bf16 v[132:135], a[200:203], a[152:155], v[132:135]
    ds_read_b128 a[228:231], v105 offset:8192
    v_exp_f32 v211, v211
    v_mfma_f32_16x16x32_bf16 v[136:139], a[200:203], a[168:171], v[136:139]
    v_exp_f32 v196, v196
    v_mfma_f32_16x16x32_bf16 v[140:143], a[200:203], a[184:187], v[140:143]
    v_exp_f32 v197, v197
    v_mfma_f32_16x16x32_bf16 v[128:131], a[204:207], a[140:143], v[128:131]
    v_cvt_pk_bf16_f32 v4, v192, v193
    v_exp_f32 v198, v198
    v_mfma_f32_16x16x32_bf16 v[132:135], a[204:207], a[156:159], v[132:135]
    ds_read_b128 a[232:235], v106 offset:8192
    v_mfma_f32_16x16x32_bf16 v[136:139], a[204:207], a[172:175], v[136:139]
    v_exp_f32 v199, v199
    v_cvt_pk_bf16_f32 v5, v194, v195
    v_mfma_f32_16x16x32_bf16 v[140:143], a[204:207], a[188:191], v[140:143]
    v_exp_f32 v212, v212
    s_waitcnt lgkmcnt(3)
    v_mfma_f32_16x16x32_bf16 v[144:147], a[208:211], a[128:131], v[64:67]
    v_mfma_f32_16x16x32_bf16 v[148:151], a[208:211], a[144:147], v[68:71]
    ds_read_b128 a[236:239], v107 offset:8192
    v_exp_f32 v213, v213
    v_mfma_f32_16x16x32_bf16 v[152:155], a[208:211], a[160:163], v[72:75]
    v_cvt_pk_bf16_f32 v6, v208, v209
    v_exp_f32 v214, v214
    v_mfma_f32_16x16x32_bf16 v[156:159], a[208:211], a[176:179], v[76:79]
    v_exp_f32 v215, v215
    v_mfma_f32_16x16x32_bf16 v[144:147], a[212:215], a[132:135], v[144:147]
    v_cvt_pk_bf16_f32 v7, v210, v211
    v_mfma_f32_16x16x32_bf16 v[148:151], a[212:215], a[148:151], v[148:151]
    ds_read_b128 a[240:243], v104 offset:12288
    v_exp_f32 v200, v200
    v_mfma_f32_16x16x32_bf16 v[152:155], a[212:215], a[164:167], v[152:155]
    v_exp_f32 v201, v201
    v_mfma_f32_16x16x32_bf16 v[156:159], a[212:215], a[180:183], v[156:159]
    v_cvt_pk_bf16_f32 v8, v196, v197
    v_exp_f32 v202, v202
    v_mfma_f32_16x16x32_bf16 v[144:147], a[216:219], a[136:139], v[144:147]
    v_exp_f32 v203, v203
    v_mfma_f32_16x16x32_bf16 v[148:151], a[216:219], a[152:155], v[148:151]
    ds_read_b128 a[244:247], v105 offset:12288
    v_cvt_pk_bf16_f32 v9, v198, v199
    v_mfma_f32_16x16x32_bf16 v[152:155], a[216:219], a[168:171], v[152:155]
    v_exp_f32 v216, v216
    v_mfma_f32_16x16x32_bf16 v[156:159], a[216:219], a[184:187], v[156:159]
    v_exp_f32 v217, v217
    v_mfma_f32_16x16x32_bf16 v[144:147], a[220:223], a[140:143], v[144:147]
    v_cvt_pk_bf16_f32 v10, v212, v213
    v_exp_f32 v218, v218
    v_mfma_f32_16x16x32_bf16 v[148:151], a[220:223], a[156:159], v[148:151]
    ds_read_b128 a[248:251], v106 offset:12288
    v_mfma_f32_16x16x32_bf16 v[152:155], a[220:223], a[172:175], v[152:155]
    v_exp_f32 v219, v219
    v_cvt_pk_bf16_f32 v11, v214, v215
    v_mfma_f32_16x16x32_bf16 v[156:159], a[220:223], a[188:191], v[156:159]
    v_exp_f32 v204, v204
    s_waitcnt lgkmcnt(3)
    v_mfma_f32_16x16x32_bf16 v[160:163], a[224:227], a[128:131], v[64:67]
    v_exp_f32 v205, v205
    v_mfma_f32_16x16x32_bf16 v[164:167], a[224:227], a[144:147], v[68:71]
    ds_read_b128 a[252:255], v107 offset:12288
    v_cvt_pk_bf16_f32 v12, v200, v201
    v_mfma_f32_16x16x32_bf16 v[168:171], a[224:227], a[160:163], v[72:75]
    v_exp_f32 v206, v206
    v_mfma_f32_16x16x32_bf16 v[172:175], a[224:227], a[176:179], v[76:79]
    v_exp_f32 v207, v207
    v_mfma_f32_16x16x32_bf16 v[160:163], a[228:231], a[132:135], v[160:163]
    v_cvt_pk_bf16_f32 v13, v202, v203
    v_mfma_f32_16x16x32_bf16 v[164:167], a[228:231], a[148:151], v[164:167]
    ds_read_b64_tr_b16 a[192:193], v108 offset:49152
    ds_read_b64_tr_b16 a[194:195], v108 offset:53248
    v_exp_f32 v220, v220
    v_mfma_f32_16x16x32_bf16 v[168:171], a[228:231], a[164:167], v[168:171]
    v_exp_f32 v221, v221
    v_mfma_f32_16x16x32_bf16 v[172:175], a[228:231], a[180:183], v[172:175]
    v_cvt_pk_bf16_f32 v14, v216, v217
    v_mfma_f32_16x16x32_bf16 v[160:163], a[232:235], a[136:139], v[160:163]
    v_exp_f32 v222, v222
    v_mfma_f32_16x16x32_bf16 v[164:167], a[232:235], a[152:155], v[164:167]
    ds_read_b64_tr_b16 a[196:197], v109 offset:49152
    ds_read_b64_tr_b16 a[198:199], v109 offset:53248
    v_mfma_f32_16x16x32_bf16 v[168:171], a[232:235], a[168:171], v[168:171]
    v_exp_f32 v223, v223
    v_cvt_pk_bf16_f32 v15, v218, v219
    v_mfma_f32_16x16x32_bf16 v[172:175], a[232:235], a[184:187], v[172:175]
    v_exp_f32 v224, v224
    v_mfma_f32_16x16x32_bf16 v[160:163], a[236:239], a[140:143], v[160:163]
    v_exp_f32 v225, v225
    v_cvt_pk_bf16_f32 v16, v204, v205
    v_mfma_f32_16x16x32_bf16 v[164:167], a[236:239], a[156:159], v[164:167]
    ds_read_b64_tr_b16 a[200:201], v110 offset:49152
    ds_read_b64_tr_b16 a[202:203], v110 offset:53248
    v_mfma_f32_16x16x32_bf16 v[168:171], a[236:239], a[172:175], v[168:171]
    v_exp_f32 v226, v226
    v_mfma_f32_16x16x32_bf16 v[172:175], a[236:239], a[188:191], v[172:175]
    v_exp_f32 v227, v227
    s_waitcnt lgkmcnt(6)
    v_mfma_f32_16x16x32_bf16 v[176:179], a[240:243], a[128:131], v[64:67]
    v_cvt_pk_bf16_f32 v17, v206, v207
    v_mfma_f32_16x16x32_bf16 v[180:183], a[240:243], a[144:147], v[68:71]
    ds_read_b64_tr_b16 a[204:205], v111 offset:49152
    ds_read_b64_tr_b16 a[206:207], v111 offset:53248
    v_mfma_f32_16x16x32_bf16 v[184:187], a[240:243], a[160:163], v[72:75]
    v_exp_f32 v240, v240
    v_mfma_f32_16x16x32_bf16 v[188:191], a[240:243], a[176:179], v[76:79]
    v_exp_f32 v241, v241
    v_cvt_pk_bf16_f32 v18, v220, v221
    v_mfma_f32_16x16x32_bf16 v[176:179], a[244:247], a[132:135], v[176:179]
    v_exp_f32 v242, v242
    v_mfma_f32_16x16x32_bf16 v[180:183], a[244:247], a[148:151], v[180:183]
    ds_read_b64_tr_b16 a[208:209], v112 offset:49152
    ds_read_b64_tr_b16 a[210:211], v112 offset:53248
    v_mfma_f32_16x16x32_bf16 v[184:187], a[244:247], a[164:167], v[184:187]
    v_exp_f32 v243, v243
    v_cvt_pk_bf16_f32 v19, v222, v223
    v_mfma_f32_16x16x32_bf16 v[188:191], a[244:247], a[180:183], v[188:191]
    v_exp_f32 v228, v228
    v_mfma_f32_16x16x32_bf16 v[176:179], a[248:251], a[136:139], v[176:179]
    v_exp_f32 v229, v229
    v_mfma_f32_16x16x32_bf16 v[180:183], a[248:251], a[152:155], v[180:183]
    ds_read_b64_tr_b16 a[212:213], v113 offset:49152
    ds_read_b64_tr_b16 a[214:215], v113 offset:53248
    v_mfma_f32_16x16x32_bf16 v[184:187], a[248:251], a[168:171], v[184:187]
    v_cvt_pk_bf16_f32 v20, v224, v225
    v_exp_f32 v230, v230
    v_mfma_f32_16x16x32_bf16 v[188:191], a[248:251], a[184:187], v[188:191]
    v_exp_f32 v231, v231
    v_mfma_f32_16x16x32_bf16 v[176:179], a[252:255], a[140:143], v[176:179]
    v_cvt_pk_bf16_f32 v21, v226, v227
    v_mfma_f32_16x16x32_bf16 v[180:183], a[252:255], a[156:159], v[180:183]
    ds_read_b64_tr_b16 a[216:217], v114 offset:49152
    ds_read_b64_tr_b16 a[218:219], v114 offset:53248
    v_mfma_f32_16x16x32_bf16 v[184:187], a[252:255], a[172:175], v[184:187]
    v_exp_f32 v244, v244
    v_exp_f32 v245, v245
    v_mfma_f32_16x16x32_bf16 v[188:191], a[252:255], a[188:191], v[188:191]
    v_cvt_pk_bf16_f32 v22, v240, v241
    v_mfma_f32_16x16x32_bf16 v[80:83], v[60:63], v[4:7], v[80:83]
    v_exp_f32 v246, v246
    v_mfma_f32_16x16x32_bf16 v[84:87], v[60:63], v[8:11], v[84:87]
    v_exp_f32 v247, v247
    v_cvt_pk_bf16_f32 v23, v242, v243
    v_mfma_f32_16x16x32_bf16 v[88:91], v[60:63], v[12:15], v[88:91]
    v_exp_f32 v232, v232
    v_mfma_f32_16x16x32_bf16 v[92:95], v[60:63], v[16:19], v[92:95]
    v_exp_f32 v233, v233
    s_waitcnt lgkmcnt(6)
    v_mfma_f32_16x16x32_bf16 a[0:3], a[192:195], v[4:7], a[0:3]
    v_cvt_pk_bf16_f32 v24, v228, v229
    v_mfma_f32_16x16x32_bf16 a[4:7], a[192:195], v[8:11], a[4:7]
    ds_read_b64_tr_b16 a[220:221], v115 offset:49152
    ds_read_b64_tr_b16 a[222:223], v115 offset:53248
    v_mfma_f32_16x16x32_bf16 a[8:11], a[192:195], v[12:15], a[8:11]
    v_exp_f32 v234, v234
    v_mfma_f32_16x16x32_bf16 a[12:15], a[192:195], v[16:19], a[12:15]
    v_exp_f32 v235, v235
    v_cvt_pk_bf16_f32 v25, v230, v231
    v_mfma_f32_16x16x32_bf16 a[16:19], a[196:199], v[4:7], a[16:19]
    v_exp_f32 v248, v248
    v_mfma_f32_16x16x32_bf16 a[20:23], a[196:199], v[8:11], a[20:23]
    ds_read_b64_tr_b16 a[224:225], v108 offset:57344
    ds_read_b64_tr_b16 a[226:227], v108 offset:61440
    v_mfma_f32_16x16x32_bf16 a[24:27], a[196:199], v[12:15], a[24:27]
    v_exp_f32 v249, v249
    v_cvt_pk_bf16_f32 v26, v244, v245
    v_mfma_f32_16x16x32_bf16 a[28:31], a[196:199], v[16:19], a[28:31]
    v_exp_f32 v250, v250
    v_mfma_f32_16x16x32_bf16 a[32:35], a[200:203], v[4:7], a[32:35]
    v_exp_f32 v251, v251
    v_mfma_f32_16x16x32_bf16 a[36:39], a[200:203], v[8:11], a[36:39]
    ds_read_b64_tr_b16 a[228:229], v109 offset:57344
    ds_read_b64_tr_b16 a[230:231], v109 offset:61440
    v_mfma_f32_16x16x32_bf16 a[40:43], a[200:203], v[12:15], a[40:43]
    v_cvt_pk_bf16_f32 v27, v246, v247
    v_exp_f32 v236, v236
    v_mfma_f32_16x16x32_bf16 a[44:47], a[200:203], v[16:19], a[44:47]
    v_exp_f32 v237, v237
    v_mfma_f32_16x16x32_bf16 a[48:51], a[204:207], v[4:7], a[48:51]
    v_cvt_pk_bf16_f32 v28, v232, v233
    v_mfma_f32_16x16x32_bf16 a[52:55], a[204:207], v[8:11], a[52:55]
    ds_read_b64_tr_b16 a[232:233], v110 offset:57344
    ds_read_b64_tr_b16 a[234:235], v110 offset:61440
    v_mfma_f32_16x16x32_bf16 a[56:59], a[204:207], v[12:15], a[56:59]
    v_exp_f32 v238, v238
    v_exp_f32 v239, v239
    v_mfma_f32_16x16x32_bf16 a[60:63], a[204:207], v[16:19], a[60:63]
    v_cvt_pk_bf16_f32 v29, v234, v235
    s_waitcnt lgkmcnt(6)
    v_mfma_f32_16x16x32_bf16 a[64:67], a[208:211], v[4:7], a[64:67]
    v_exp_f32 v252, v252
    v_mfma_f32_16x16x32_bf16 a[68:71], a[208:211], v[8:11], a[68:71]
    ds_read_b64_tr_b16 a[236:237], v111 offset:57344
    ds_read_b64_tr_b16 a[238:239], v111 offset:61440
    v_mfma_f32_16x16x32_bf16 a[72:75], a[208:211], v[12:15], a[72:75]
    v_exp_f32 v253, v253
    v_mfma_f32_16x16x32_bf16 a[76:79], a[208:211], v[16:19], a[76:79]
    v_cvt_pk_bf16_f32 v30, v248, v249
    v_exp_f32 v254, v254
    v_mfma_f32_16x16x32_bf16 a[80:83], a[212:215], v[4:7], a[80:83]
    v_exp_f32 v255, v255
    v_mfma_f32_16x16x32_bf16 a[84:87], a[212:215], v[8:11], a[84:87]
    ds_read_b64_tr_b16 a[240:241], v112 offset:57344
    ds_read_b64_tr_b16 a[242:243], v112 offset:61440
    v_mfma_f32_16x16x32_bf16 a[88:91], a[212:215], v[12:15], a[88:91]
    v_cvt_pk_bf16_f32 v31, v250, v251
    v_cvt_pk_bf16_f32 v32, v236, v237
    v_mfma_f32_16x16x32_bf16 a[92:95], a[212:215], v[16:19], a[92:95]
    v_cvt_pk_bf16_f32 v33, v238, v239
    v_cvt_pk_bf16_f32 v34, v252, v253
    v_mfma_f32_16x16x32_bf16 a[96:99], a[216:219], v[4:7], a[96:99]
    v_cvt_pk_bf16_f32 v35, v254, v255
    v_max3_f32 v124, v128, v129, v130
    v_mfma_f32_16x16x32_bf16 a[100:103], a[216:219], v[8:11], a[100:103]
    ds_read_b64_tr_b16 a[244:245], v113 offset:57344
    ds_read_b64_tr_b16 a[246:247], v113 offset:61440
    v_mfma_f32_16x16x32_bf16 a[104:107], a[216:219], v[12:15], a[104:107]
    v_max3_f32 v125, v132, v133, v134
    v_max3_f32 v124, v124, v131, v136
    v_mfma_f32_16x16x32_bf16 a[108:111], a[216:219], v[16:19], a[108:111]
    v_max3_f32 v125, v125, v135, v140
    v_max3_f32 v124, v124, v137, v138
    v_mfma_f32_16x16x32_bf16 a[112:115], a[220:223], v[4:7], a[112:115]
    v_max3_f32 v125, v125, v141, v142
    v_max3_f32 v124, v124, v139, v144
    v_mfma_f32_16x16x32_bf16 a[116:119], a[220:223], v[8:11], a[116:119]
    ds_read_b64_tr_b16 a[248:249], v114 offset:57344
    ds_read_b64_tr_b16 a[250:251], v114 offset:61440
    v_mfma_f32_16x16x32_bf16 a[120:123], a[220:223], v[12:15], a[120:123]
    v_max3_f32 v125, v125, v143, v148
    v_max3_f32 v124, v124, v145, v146
    v_mfma_f32_16x16x32_bf16 a[124:127], a[220:223], v[16:19], a[124:127]
    v_max3_f32 v125, v125, v149, v150
    v_max3_f32 v124, v124, v147, v152
    v_mfma_f32_16x16x32_bf16 v[80:83], v[60:63], v[20:23], v[80:83]
    v_max3_f32 v125, v125, v151, v156
    v_max3_f32 v124, v124, v153, v154
    v_mfma_f32_16x16x32_bf16 v[84:87], v[60:63], v[24:27], v[84:87]
    v_max3_f32 v125, v125, v157, v158
    v_max3_f32 v124, v124, v155, v160
    v_mfma_f32_16x16x32_bf16 v[88:91], v[60:63], v[28:31], v[88:91]
    v_max3_f32 v125, v125, v159, v164
    v_max3_f32 v124, v124, v161, v162
    v_mfma_f32_16x16x32_bf16 v[92:95], v[60:63], v[32:35], v[92:95]
    v_max3_f32 v125, v125, v165, v166
    v_max3_f32 v124, v124, v163, v168
    s_waitcnt lgkmcnt(6)
    v_mfma_f32_16x16x32_bf16 a[0:3], a[224:227], v[20:23], a[0:3]
    v_max3_f32 v125, v125, v167, v172
    v_mfma_f32_16x16x32_bf16 a[4:7], a[224:227], v[24:27], a[4:7]
    ds_read_b64_tr_b16 a[252:253], v115 offset:57344
    ds_read_b64_tr_b16 a[254:255], v115 offset:61440
    v_mfma_f32_16x16x32_bf16 a[8:11], a[224:227], v[28:31], a[8:11]
    v_max3_f32 v124, v124, v169, v170
    v_max3_f32 v125, v125, v173, v174
    v_mfma_f32_16x16x32_bf16 a[12:15], a[224:227], v[32:35], a[12:15]
    s_add_u32 m0, s78, 0xc000
    s_nop 0
    buffer_load_dwordx4 v116, s[56:59], s76 offen offset:0 lds
    v_mfma_f32_16x16x32_bf16 a[16:19], a[228:231], v[20:23], a[16:19]
    v_max3_f32 v124, v124, v171, v176
    v_mfma_f32_16x16x32_bf16 a[20:23], a[228:231], v[24:27], a[20:23]
    ds_read_b128 a[192:195], v104 offset:16384
    v_max3_f32 v125, v125, v175, v180
    v_mfma_f32_16x16x32_bf16 a[24:27], a[228:231], v[28:31], a[24:27]
    v_max3_f32 v124, v124, v177, v178
    v_max3_f32 v125, v125, v181, v182
    v_mfma_f32_16x16x32_bf16 a[28:31], a[228:231], v[32:35], a[28:31]
    buffer_load_dwordx4 v117, s[56:59], s76 offen offset:1024 lds
    v_max3_f32 v124, v124, v179, v184
    v_mfma_f32_16x16x32_bf16 a[32:35], a[232:235], v[20:23], a[32:35]
    v_max3_f32 v125, v125, v183, v188
    v_max3_f32 v124, v124, v185, v186
    v_mfma_f32_16x16x32_bf16 a[36:39], a[232:235], v[24:27], a[36:39]
    ds_read_b128 a[196:199], v105 offset:16384
    v_max3_f32 v125, v125, v189, v190
    v_mfma_f32_16x16x32_bf16 a[40:43], a[232:235], v[28:31], a[40:43]
    v_max3_f32 v124, v124, v187, v187
    v_max3_f32 v125, v125, v191, v191
    v_mfma_f32_16x16x32_bf16 a[44:47], a[232:235], v[32:35], a[44:47]
    buffer_load_dwordx4 v118, s[56:59], s76 offen offset:2048 lds
    v_max_f32 v126, v124, v125
    v_mfma_f32_16x16x32_bf16 a[48:51], a[236:239], v[20:23], a[48:51]
    v_cmp_lt_f32 vcc, s79, v126
    v_mfma_f32_16x16x32_bf16 a[52:55], a[236:239], v[24:27], a[52:55]
    ds_read_b128 a[200:203], v106 offset:16384
    v_mfma_f32_16x16x32_bf16 a[56:59], a[236:239], v[28:31], a[56:59]
    v_mfma_f32_16x16x32_bf16 a[60:63], a[236:239], v[32:35], a[60:63]
    buffer_load_dwordx4 v119, s[56:59], s76 offen offset:3072 lds
    s_add_u32 s76, s76, 0x4000
    s_and_b32 s76, s76, 0x7ffff
    s_waitcnt lgkmcnt(3)
    v_mfma_f32_16x16x32_bf16 a[64:67], a[240:243], v[20:23], a[64:67]
    v_mfma_f32_16x16x32_bf16 a[68:71], a[240:243], v[24:27], a[68:71]
    ds_read_b128 a[204:207], v107 offset:16384
    v_mfma_f32_16x16x32_bf16 a[72:75], a[240:243], v[28:31], a[72:75]
    v_mfma_f32_16x16x32_bf16 a[76:79], a[240:243], v[32:35], a[76:79]
    s_add_u32 m0, s78, 0x18000
    s_nop 0
    buffer_load_dwordx4 v120, s[60:63], s77 offen offset:0 lds
    v_mfma_f32_16x16x32_bf16 a[80:83], a[244:247], v[20:23], a[80:83]
    v_mfma_f32_16x16x32_bf16 a[84:87], a[244:247], v[24:27], a[84:87]
    ds_read_b128 a[208:211], v104 offset:20480
    v_mfma_f32_16x16x32_bf16 a[88:91], a[244:247], v[28:31], a[88:91]
    v_mfma_f32_16x16x32_bf16 a[92:95], a[244:247], v[32:35], a[92:95]
    buffer_load_dwordx4 v121, s[60:63], s77 offen offset:1024 lds
    v_mfma_f32_16x16x32_bf16 a[96:99], a[248:251], v[20:23], a[96:99]
    v_mfma_f32_16x16x32_bf16 a[100:103], a[248:251], v[24:27], a[100:103]
    ds_read_b128 a[212:215], v105 offset:20480
    v_mfma_f32_16x16x32_bf16 a[104:107], a[248:251], v[28:31], a[104:107]
    v_mfma_f32_16x16x32_bf16 a[108:111], a[248:251], v[32:35], a[108:111]
    buffer_load_dwordx4 v120, s[60:63], s77 offen offset:2048 lds
    v_mfma_f32_16x16x32_bf16 a[112:115], a[252:255], v[20:23], a[112:115]
    v_mfma_f32_16x16x32_bf16 a[116:119], a[252:255], v[24:27], a[116:119]
    ds_read_b128 a[216:219], v106 offset:20480
    v_mfma_f32_16x16x32_bf16 a[120:123], a[252:255], v[28:31], a[120:123]
    v_mfma_f32_16x16x32_bf16 a[124:127], a[252:255], v[32:35], a[124:127]
    buffer_load_dwordx4 v121, s[60:63], s77 offen offset:3072 lds
    s_add_u32 s77, s77, 0x4000
    s_and_b32 s77, s77, 0x7ffff
    s_cbranch_vccnz at_rare3
at_back3:
    s_add_u32 s41, s41, 1
    s_cmp_lt_u32 s41, 8
    s_cbranch_scc1 at_loop
    s_waitcnt vmcnt(0) lgkmcnt(0)
    s_nop 7
    s_nop 7
    v_lshlrev_b32 v36, 4, v127
    v_mul_u32_u24 v40, 8192, v3
    v_add_u32 v40, v40, v36
    v_rcp_f32 v38, v80
    s_nop 0
    v_accvgpr_read_b32 v128, a0
    v_accvgpr_read_b32 v129, a1
    v_accvgpr_read_b32 v130, a2
    v_accvgpr_read_b32 v131, a3
    v_accvgpr_read_b32 v132, a16
    v_accvgpr_read_b32 v133, a17
    v_accvgpr_read_b32 v134, a18
    v_accvgpr_read_b32 v135, a19
    v_mul_f32 v128, v128, v38
    v_mul_f32 v129, v129, v38
    v_mul_f32 v130, v130, v38
    v_mul_f32 v131, v131, v38
    v_mul_f32 v132, v132, v38
    v_mul_f32 v133, v133, v38
    v_mul_f32 v134, v134, v38
    v_mul_f32 v135, v135, v38
    v_cvt_pk_bf16_f32 v136, v128, v129
    v_cvt_pk_bf16_f32 v137, v130, v131
    v_cvt_pk_bf16_f32 v138, v132, v133
    v_cvt_pk_bf16_f32 v139, v134, v135
    s_nop 1
    v_permlane16_swap_b32 v136, v138
    v_permlane16_swap_b32 v137, v139
    buffer_store_dwordx4 v[136:139], v40, s[64:67], s81 offen offset:0
    v_accvgpr_read_b32 v140, a32
    v_accvgpr_read_b32 v141, a33
    v_accvgpr_read_b32 v142, a34
    v_accvgpr_read_b32 v143, a35
    v_accvgpr_read_b32 v144, a48
    v_accvgpr_read_b32 v145, a49
    v_accvgpr_read_b32 v146, a50
    v_accvgpr_read_b32 v147, a51
    v_mul_f32 v140, v140, v38
    v_mul_f32 v141, v141, v38
    v_mul_f32 v142, v142, v38
    v_mul_f32 v143, v143, v38
    v_mul_f32 v144, v144, v38
    v_mul_f32 v145, v145, v38
    v_mul_f32 v146, v146, v38
    v_mul_f32 v147, v147, v38
    v_cvt_pk_bf16_f32 v148, v140, v141
    v_cvt_pk_bf16_f32 v149, v142, v143
    v_cvt_pk_bf16_f32 v150, v144, v145
    v_cvt_pk_bf16_f32 v151, v146, v147
    s_nop 1
    v_permlane16_swap_b32 v148, v150
    v_permlane16_swap_b32 v149, v151
    buffer_store_dwordx4 v[148:151], v40, s[64:67], s81 offen offset:64
    v_accvgpr_read_b32 v152, a64
    v_accvgpr_read_b32 v153, a65
    v_accvgpr_read_b32 v154, a66
    v_accvgpr_read_b32 v155, a67
    v_accvgpr_read_b32 v156, a80
    v_accvgpr_read_b32 v157, a81
    v_accvgpr_read_b32 v158, a82
    v_accvgpr_read_b32 v159, a83
    v_mul_f32 v152, v152, v38
    v_mul_f32 v153, v153, v38
    v_mul_f32 v154, v154, v38
    v_mul_f32 v155, v155, v38
    v_mul_f32 v156, v156, v38
    v_mul_f32 v157, v157, v38
    v_mul_f32 v158, v158, v38
    v_mul_f32 v159, v159, v38
    v_cvt_pk_bf16_f32 v160, v152, v153
    v_cvt_pk_bf16_f32 v161, v154, v155
    v_cvt_pk_bf16_f32 v162, v156, v157
    v_cvt_pk_bf16_f32 v163, v158, v159
    s_nop 1
    v_permlane16_swap_b32 v160, v162
    v_permlane16_swap_b32 v161, v163
    buffer_store_dwordx4 v[160:163], v40, s[64:67], s81 offen offset:128
    v_accvgpr_read_b32 v164, a96
    v_accvgpr_read_b32 v165, a97
    v_accvgpr_read_b32 v166, a98
    v_accvgpr_read_b32 v167, a99
    v_accvgpr_read_b32 v168, a112
    v_accvgpr_read_b32 v169, a113
    v_accvgpr_read_b32 v170, a114
    v_accvgpr_read_b32 v171, a115
    v_mul_f32 v164, v164, v38
    v_mul_f32 v165, v165, v38
    v_mul_f32 v166, v166, v38
    v_mul_f32 v167, v167, v38
    v_mul_f32 v168, v168, v38
    v_mul_f32 v169, v169, v38
    v_mul_f32 v170, v170, v38
    v_mul_f32 v171, v171, v38
    v_cvt_pk_bf16_f32 v172, v164, v165
    v_cvt_pk_bf16_f32 v173, v166, v167
    v_cvt_pk_bf16_f32 v174, v168, v169
    v_cvt_pk_bf16_f32 v175, v170, v171
    s_nop 1
    v_permlane16_swap_b32 v172, v174
    v_permlane16_swap_b32 v173, v175
    buffer_store_dwordx4 v[172:175], v40, s[64:67], s81 offen offset:192
    s_add_u32 s81, s81, 0x20000
    v_rcp_f32 v38, v84
    s_nop 0
    v_accvgpr_read_b32 v176, a4
    v_accvgpr_read_b32 v177, a5
    v_accvgpr_read_b32 v178, a6
    v_accvgpr_read_b32 v179, a7
    v_accvgpr_read_b32 v180, a20
    v_accvgpr_read_b32 v181, a21
    v_accvgpr_read_b32 v182, a22
    v_accvgpr_read_b32 v183, a23
    v_mul_f32 v176, v176, v38
    v_mul_f32 v177, v177, v38
    v_mul_f32 v178, v178, v38
    v_mul_f32 v179, v179, v38
    v_mul_f32 v180, v180, v38
    v_mul_f32 v181, v181, v38
    v_mul_f32 v182, v182, v38
    v_mul_f32 v183, v183, v38
    v_cvt_pk_bf16_f32 v184, v176, v177
    v_cvt_pk_bf16_f32 v185, v178, v179
    v_cvt_pk_bf16_f32 v186, v180, v181
    v_cvt_pk_bf16_f32 v187, v182, v183
    s_nop 1
    v_permlane16_swap_b32 v184, v186
    v_permlane16_swap_b32 v185, v187
    buffer_store_dwordx4 v[184:187], v40, s[64:67], s81 offen offset:0
    v_accvgpr_read_b32 v188, a36
    v_accvgpr_read_b32 v189, a37
    v_accvgpr_read_b32 v190, a38
    v_accvgpr_read_b32 v191, a39
    v_accvgpr_read_b32 v192, a52
    v_accvgpr_read_b32 v193, a53
    v_accvgpr_read_b32 v194, a54
    v_accvgpr_read_b32 v195, a55
    v_mul_f32 v188, v188, v38
    v_mul_f32 v189, v189, v38
    v_mul_f32 v190, v190, v38
    v_mul_f32 v191, v191, v38
    v_mul_f32 v192, v192, v38
    v_mul_f32 v193, v193, v38
    v_mul_f32 v194, v194, v38
    v_mul_f32 v195, v195, v38
    v_cvt_pk_bf16_f32 v196, v188, v189
    v_cvt_pk_bf16_f32 v197, v190, v191
    v_cvt_pk_bf16_f32 v198, v192, v193
    v_cvt_pk_bf16_f32 v199, v194, v195
    s_nop 1
    v_permlane16_swap_b32 v196, v198
    v_permlane16_swap_b32 v197, v199
    buffer_store_dwordx4 v[196:199], v40, s[64:67], s81 offen offset:64
    v_accvgpr_read_b32 v200, a68
    v_accvgpr_read_b32 v201, a69
    v_accvgpr_read_b32 v202, a70
    v_accvgpr_read_b32 v203, a71
    v_accvgpr_read_b32 v204, a84
    v_accvgpr_read_b32 v205, a85
    v_accvgpr_read_b32 v206, a86
    v_accvgpr_read_b32 v207, a87
    v_mul_f32 v200, v200, v38
    v_mul_f32 v201, v201, v38
    v_mul_f32 v202, v202, v38
    v_mul_f32 v203, v203, v38
    v_mul_f32 v204, v204, v38
    v_mul_f32 v205, v205, v38
    v_mul_f32 v206, v206, v38
    v_mul_f32 v207, v207, v38
    v_cvt_pk_bf16_f32 v208, v200, v201
    v_cvt_pk_bf16_f32 v209, v202, v203
    v_cvt_pk_bf16_f32 v210, v204, v205
    v_cvt_pk_bf16_f32 v211, v206, v207
    s_nop 1
    v_permlane16_swap_b32 v208, v210
    v_permlane16_swap_b32 v209, v211
    buffer_store_dwordx4 v[208:211], v40, s[64:67], s81 offen offset:128
    v_accvgpr_read_b32 v212, a100
    v_accvgpr_read_b32 v213, a101
    v_accvgpr_read_b32 v214, a102
    v_accvgpr_read_b32 v215, a103
    v_accvgpr_read_b32 v216, a116
    v_accvgpr_read_b32 v217, a117
    v_accvgpr_read_b32 v218, a118
    v_accvgpr_read_b32 v219, a119
    v_mul_f32 v212, v212, v38
    v_mul_f32 v213, v213, v38
    v_mul_f32 v214, v214, v38
    v_mul_f32 v215, v215, v38
    v_mul_f32 v216, v216, v38
    v_mul_f32 v217, v217, v38
    v_mul_f32 v218, v218, v38
    v_mul_f32 v219, v219, v38
    v_cvt_pk_bf16_f32 v220, v212, v213
    v_cvt_pk_bf16_f32 v221, v214, v215
    v_cvt_pk_bf16_f32 v222, v216, v217
    v_cvt_pk_bf16_f32 v223, v218, v219
    s_nop 1
    v_permlane16_swap_b32 v220, v222
    v_permlane16_swap_b32 v221, v223
    buffer_store_dwordx4 v[220:223], v40, s[64:67], s81 offen offset:192
    s_add_u32 s81, s81, 0x20000
    v_rcp_f32 v38, v88
    s_nop 0
    v_accvgpr_read_b32 v128, a8
    v_accvgpr_read_b32 v129, a9
    v_accvgpr_read_b32 v130, a10
    v_accvgpr_read_b32 v131, a11
    v_accvgpr_read_b32 v132, a24
    v_accvgpr_read_b32 v133, a25
    v_accvgpr_read_b32 v134, a26
    v_accvgpr_read_b32 v135, a27
    v_mul_f32 v128, v128, v38
    v_mul_f32 v129, v129, v38
    v_mul_f32 v130, v130, v38
    v_mul_f32 v131, v131, v38
    v_mul_f32 v132, v132, v38
    v_mul_f32 v133, v133, v38
    v_mul_f32 v134, v134, v38
    v_mul_f32 v135, v135, v38
    v_cvt_pk_bf16_f32 v136, v128, v129
    v_cvt_pk_bf16_f32 v137, v130, v131
    v_cvt_pk_bf16_f32 v138, v132, v133
    v_cvt_pk_bf16_f32 v139, v134, v135
    s_nop 1
    v_permlane16_swap_b32 v136, v138
    v_permlane16_swap_b32 v137, v139
    buffer_store_dwordx4 v[136:139], v40, s[64:67], s81 offen offset:0
    v_accvgpr_read_b32 v140, a40
    v_accvgpr_read_b32 v141, a41
    v_accvgpr_read_b32 v142, a42
    v_accvgpr_read_b32 v143, a43
    v_accvgpr_read_b32 v144, a56
    v_accvgpr_read_b32 v145, a57
    v_accvgpr_read_b32 v146, a58
    v_accvgpr_read_b32 v147, a59
    v_mul_f32 v140, v140, v38
    v_mul_f32 v141, v141, v38
    v_mul_f32 v142, v142, v38
    v_mul_f32 v143, v143, v38
    v_mul_f32 v144, v144, v38
    v_mul_f32 v145, v145, v38
    v_mul_f32 v146, v146, v38
    v_mul_f32 v147, v147, v38
    v_cvt_pk_bf16_f32 v148, v140, v141
    v_cvt_pk_bf16_f32 v149, v142, v143
    v_cvt_pk_bf16_f32 v150, v144, v145
    v_cvt_pk_bf16_f32 v151, v146, v147
    s_nop 1
    v_permlane16_swap_b32 v148, v150
    v_permlane16_swap_b32 v149, v151
    buffer_store_dwordx4 v[148:151], v40, s[64:67], s81 offen offset:64
    v_accvgpr_read_b32 v152, a72
    v_accvgpr_read_b32 v153, a73
    v_accvgpr_read_b32 v154, a74
    v_accvgpr_read_b32 v155, a75
    v_accvgpr_read_b32 v156, a88
    v_accvgpr_read_b32 v157, a89
    v_accvgpr_read_b32 v158, a90
    v_accvgpr_read_b32 v159, a91
    v_mul_f32 v152, v152, v38
    v_mul_f32 v153, v153, v38
    v_mul_f32 v154, v154, v38
    v_mul_f32 v155, v155, v38
    v_mul_f32 v156, v156, v38
    v_mul_f32 v157, v157, v38
    v_mul_f32 v158, v158, v38
    v_mul_f32 v159, v159, v38
    v_cvt_pk_bf16_f32 v160, v152, v153
    v_cvt_pk_bf16_f32 v161, v154, v155
    v_cvt_pk_bf16_f32 v162, v156, v157
    v_cvt_pk_bf16_f32 v163, v158, v159
    s_nop 1
    v_permlane16_swap_b32 v160, v162
    v_permlane16_swap_b32 v161, v163
    buffer_store_dwordx4 v[160:163], v40, s[64:67], s81 offen offset:128
    v_accvgpr_read_b32 v164, a104
    v_accvgpr_read_b32 v165, a105
    v_accvgpr_read_b32 v166, a106
    v_accvgpr_read_b32 v167, a107
    v_accvgpr_read_b32 v168, a120
    v_accvgpr_read_b32 v169, a121
    v_accvgpr_read_b32 v170, a122
    v_accvgpr_read_b32 v171, a123
    v_mul_f32 v164, v164, v38
    v_mul_f32 v165, v165, v38
    v_mul_f32 v166, v166, v38
    v_mul_f32 v167, v167, v38
    v_mul_f32 v168, v168, v38
    v_mul_f32 v169, v169, v38
    v_mul_f32 v170, v170, v38
    v_mul_f32 v171, v171, v38
    v_cvt_pk_bf16_f32 v172, v164, v165
    v_cvt_pk_bf16_f32 v173, v166, v167
    v_cvt_pk_bf16_f32 v174, v168, v169
    v_cvt_pk_bf16_f32 v175, v170, v171
    s_nop 1
    v_permlane16_swap_b32 v172, v174
    v_permlane16_swap_b32 v173, v175
    buffer_store_dwordx4 v[172:175], v40, s[64:67], s81 offen offset:192
    s_add_u32 s81, s81, 0x20000
    v_rcp_f32 v38, v92
    s_nop 0
    v_accvgpr_read_b32 v176, a12
    v_accvgpr_read_b32 v177, a13
    v_accvgpr_read_b32 v178, a14
    v_accvgpr_read_b32 v179, a15
    v_accvgpr_read_b32 v180, a28
    v_accvgpr_read_b32 v181, a29
    v_accvgpr_read_b32 v182, a30
    v_accvgpr_read_b32 v183, a31
    v_mul_f32 v176, v176, v38
    v_mul_f32 v177, v177, v38
    v_mul_f32 v178, v178, v38
    v_mul_f32 v179, v179, v38
    v_mul_f32 v180, v180, v38
    v_mul_f32 v181, v181, v38
    v_mul_f32 v182, v182, v38
    v_mul_f32 v183, v183, v38
    v_cvt_pk_bf16_f32 v184, v176, v177
    v_cvt_pk_bf16_f32 v185, v178, v179
    v_cvt_pk_bf16_f32 v186, v180, v181
    v_cvt_pk_bf16_f32 v187, v182, v183
    s_nop 1
    v_permlane16_swap_b32 v184, v186
    v_permlane16_swap_b32 v185, v187
    buffer_store_dwordx4 v[184:187], v40, s[64:67], s81 offen offset:0
    v_accvgpr_read_b32 v188, a44
    v_accvgpr_read_b32 v189, a45
    v_accvgpr_read_b32 v190, a46
    v_accvgpr_read_b32 v191, a47
    v_accvgpr_read_b32 v192, a60
    v_accvgpr_read_b32 v193, a61
    v_accvgpr_read_b32 v194, a62
    v_accvgpr_read_b32 v195, a63
    v_mul_f32 v188, v188, v38
    v_mul_f32 v189, v189, v38
    v_mul_f32 v190, v190, v38
    v_mul_f32 v191, v191, v38
    v_mul_f32 v192, v192, v38
    v_mul_f32 v193, v193, v38
    v_mul_f32 v194, v194, v38
    v_mul_f32 v195, v195, v38
    v_cvt_pk_bf16_f32 v196, v188, v189
    v_cvt_pk_bf16_f32 v197, v190, v191
    v_cvt_pk_bf16_f32 v198, v192, v193
    v_cvt_pk_bf16_f32 v199, v194, v195
    s_nop 1
    v_permlane16_swap_b32 v196, v198
    v_permlane16_swap_b32 v197, v199
    buffer_store_dwordx4 v[196:199], v40, s[64:67], s81 offen offset:64
    v_accvgpr_read_b32 v200, a76
    v_accvgpr_read_b32 v201, a77
    v_accvgpr_read_b32 v202, a78
    v_accvgpr_read_b32 v203, a79
    v_accvgpr_read_b32 v204, a92
    v_accvgpr_read_b32 v205, a93
    v_accvgpr_read_b32 v206, a94
    v_accvgpr_read_b32 v207, a95
    v_mul_f32 v200, v200, v38
    v_mul_f32 v201, v201, v38
    v_mul_f32 v202, v202, v38
    v_mul_f32 v203, v203, v38
    v_mul_f32 v204, v204, v38
    v_mul_f32 v205, v205, v38
    v_mul_f32 v206, v206, v38
    v_mul_f32 v207, v207, v38
    v_cvt_pk_bf16_f32 v208, v200, v201
    v_cvt_pk_bf16_f32 v209, v202, v203
    v_cvt_pk_bf16_f32 v210, v204, v205
    v_cvt_pk_bf16_f32 v211, v206, v207
    s_nop 1
    v_permlane16_swap_b32 v208, v210
    v_permlane16_swap_b32 v209, v211
    buffer_store_dwordx4 v[208:211], v40, s[64:67], s81 offen offset:128
    v_accvgpr_read_b32 v212, a108
    v_accvgpr_read_b32 v213, a109
    v_accvgpr_read_b32 v214, a110
    v_accvgpr_read_b32 v215, a111
    v_accvgpr_read_b32 v216, a124
    v_accvgpr_read_b32 v217, a125
    v_accvgpr_read_b32 v218, a126
    v_accvgpr_read_b32 v219, a127
    v_mul_f32 v212, v212, v38
    v_mul_f32 v213, v213, v38
    v_mul_f32 v214, v214, v38
    v_mul_f32 v215, v215, v38
    v_mul_f32 v216, v216, v38
    v_mul_f32 v217, v217, v38
    v_mul_f32 v218, v218, v38
    v_mul_f32 v219, v219, v38
    v_cvt_pk_bf16_f32 v220, v212, v213
    v_cvt_pk_bf16_f32 v221, v214, v215
    v_cvt_pk_bf16_f32 v222, v216, v217
    v_cvt_pk_bf16_f32 v223, v218, v219
    s_nop 1
    v_permlane16_swap_b32 v220, v222
    v_permlane16_swap_b32 v221, v223
    buffer_store_dwordx4 v[220:223], v40, s[64:67], s81 offen offset:192
    s_endpgm
at_rare0:
    s_nop 7
    s_nop 7
    v_max3_f32 v124, v192, v193, v194
    v_max3_f32 v124, v124, v195, v208
    v_max3_f32 v124, v124, v209, v210
    v_max3_f32 v124, v124, v211, v224
    v_max3_f32 v124, v124, v225, v226
    v_max3_f32 v124, v124, v227, v240
    v_max3_f32 v124, v124, v241, v242
    v_max3_f32 v124, v124, v243, v243
    v_mov_b32 v36, v124
    v_mov_b32 v37, v124
    s_nop 1
    v_permlane16_swap_b32 v36, v37
    s_nop 1
    v_max_f32 v36, v36, v37
    v_mov_b32 v37, v36
    s_nop 1
    v_permlane32_swap_b32 v36, v37
    s_nop 1
    v_max_f32 v38, v36, v37
    v_max_f32 v38, 0, v38
    v_sub_f32 v39, 0, v38
    v_exp_f32 v39, v39
    v_sub_f32 v192, v192, v38
    v_sub_f32 v193, v193, v38
    v_sub_f32 v194, v194, v38
    v_sub_f32 v195, v195, v38
    v_sub_f32 v208, v208, v38
    v_sub_f32 v209, v209, v38
    v_sub_f32 v210, v210, v38
    v_sub_f32 v211, v211, v38
    v_sub_f32 v224, v224, v38
    v_sub_f32 v225, v225, v38
    v_sub_f32 v226, v226, v38
    v_sub_f32 v227, v227, v38
    v_sub_f32 v240, v240, v38
    v_sub_f32 v241, v241, v38
    v_sub_f32 v242, v242, v38
    v_sub_f32 v243, v243, v38
    v_sub_f32 v64, v64, v38
    v_sub_f32 v65, v65, v38
    v_sub_f32 v66, v66, v38
    v_sub_f32 v67, v67, v38
    v_mul_f32 v80, v80, v39
    v_mul_f32 v81, v81, v39
    v_mul_f32 v82, v82, v39
    v_mul_f32 v83, v83, v39
    v_accvgpr_read_b32 v44, a0
    v_accvgpr_read_b32 v45, a1
    v_accvgpr_read_b32 v46, a2
    v_accvgpr_read_b32 v47, a3
    v_accvgpr_read_b32 v48, a16
    v_accvgpr_read_b32 v49, a17
    v_accvgpr_read_b32 v50, a18
    v_accvgpr_read_b32 v51, a19
    v_mul_f32 v44, v44, v39
    v_mul_f32 v45, v45, v39
    v_mul_f32 v46, v46, v39
    v_mul_f32 v47, v47, v39
    v_mul_f32 v48, v48, v39
    v_mul_f32 v49, v49, v39
    v_mul_f32 v50, v50, v39
    v_mul_f32 v51, v51, v39
    v_accvgpr_write_b32 a0, v44
    v_accvgpr_write_b32 a1, v45
    v_accvgpr_write_b32 a2, v46
    v_accvgpr_write_b32 a3, v47
    v_accvgpr_write_b32 a16, v48
    v_accvgpr_write_b32 a17, v49
    v_accvgpr_write_b32 a18, v50
    v_accvgpr_write_b32 a19, v51
    v_accvgpr_read_b32 v44, a32
    v_accvgpr_read_b32 v45, a33
    v_accvgpr_read_b32 v46, a34
    v_accvgpr_read_b32 v47, a35
    v_accvgpr_read_b32 v48, a48
    v_accvgpr_read_b32 v49, a49
    v_accvgpr_read_b32 v50, a50
    v_accvgpr_read_b32 v51, a51
    v_mul_f32 v44, v44, v39
    v_mul_f32 v45, v45, v39
    v_mul_f32 v46, v46, v39
    v_mul_f32 v47, v47, v39
    v_mul_f32 v48, v48, v39
    v_mul_f32 v49, v49, v39
    v_mul_f32 v50, v50, v39
    v_mul_f32 v51, v51, v39
    v_accvgpr_write_b32 a32, v44
    v_accvgpr_write_b32 a33, v45
    v_accvgpr_write_b32 a34, v46
    v_accvgpr_write_b32 a35, v47
    v_accvgpr_write_b32 a48, v48
    v_accvgpr_write_b32 a49, v49
    v_accvgpr_write_b32 a50, v50
    v_accvgpr_write_b32 a51, v51
    v_accvgpr_read_b32 v44, a64
    v_accvgpr_read_b32 v45, a65
    v_accvgpr_read_b32 v46, a66
    v_accvgpr_read_b32 v47, a67
    v_accvgpr_read_b32 v48, a80
    v_accvgpr_read_b32 v49, a81
    v_accvgpr_read_b32 v50, a82
    v_accvgpr_read_b32 v51, a83
    v_mul_f32 v44, v44, v39
    v_mul_f32 v45, v45, v39
    v_mul_f32 v46, v46, v39
    v_mul_f32 v47, v47, v39
    v_mul_f32 v48, v48, v39
    v_mul_f32 v49, v49, v39
    v_mul_f32 v50, v50, v39
    v_mul_f32 v51, v51, v39
    v_accvgpr_write_b32 a64, v44
    v_accvgpr_write_b32 a65, v45
    v_accvgpr_write_b32 a66, v46
    v_accvgpr_write_b32 a67, v47
    v_accvgpr_write_b32 a80, v48
    v_accvgpr_write_b32 a81, v49
    v_accvgpr_write_b32 a82, v50
    v_accvgpr_write_b32 a83, v51
    v_accvgpr_read_b32 v44, a96
    v_accvgpr_read_b32 v45, a97
    v_accvgpr_read_b32 v46, a98
    v_accvgpr_read_b32 v47, a99
    v_accvgpr_read_b32 v48, a112
    v_accvgpr_read_b32 v49, a113
    v_accvgpr_read_b32 v50, a114
    v_accvgpr_read_b32 v51, a115
    v_mul_f32 v44, v44, v39
    v_mul_f32 v45, v45, v39
    v_mul_f32 v46, v46, v39
    v_mul_f32 v47, v47, v39
    v_mul_f32 v48, v48, v39
    v_mul_f32 v49, v49, v39
    v_mul_f32 v50, v50, v39
    v_mul_f32 v51, v51, v39
    v_accvgpr_write_b32 a96, v44
    v_accvgpr_write_b32 a97, v45
    v_accvgpr_write_b32 a98, v46
    v_accvgpr_write_b32 a99, v47
    v_accvgpr_write_b32 a112, v48
    v_accvgpr_write_b32 a113, v49
    v_accvgpr_write_b32 a114, v50
    v_accvgpr_write_b32 a115, v51
    v_max3_f32 v124, v196, v197, v198
    v_max3_f32 v124, v124, v199, v212
    v_max3_f32 v124, v124, v213, v214
    v_max3_f32 v124, v124, v215, v228
    v_max3_f32 v124, v124, v229, v230
    v_max3_f32 v124, v124, v231, v244
    v_max3_f32 v124, v124, v245, v246
    v_max3_f32 v124, v124, v247, v247
    v_mov_b32 v36, v124
    v_mov_b32 v37, v124
    s_nop 1
    v_permlane16_swap_b32 v36, v37
    s_nop 1
    v_max_f32 v36, v36, v37
    v_mov_b32 v37, v36
    s_nop 1
    v_permlane32_swap_b32 v36, v37
    s_nop 1
    v_max_f32 v38, v36, v37
    v_max_f32 v38, 0, v38
    v_sub_f32 v39, 0, v38
    v_exp_f32 v39, v39
    v_sub_f32 v196, v196, v38
    v_sub_f32 v197, v197, v38
    v_sub_f32 v198, v198, v38
    v_sub_f32 v199, v199, v38
    v_sub_f32 v212, v212, v38
    v_sub_f32 v213, v213, v38
    v_sub_f32 v214, v214, v38
    v_sub_f32 v215, v215, v38
    v_sub_f32 v228, v228, v38
    v_sub_f32 v229, v229, v38
    v_sub_f32 v230, v230, v38
    v_sub_f32 v231, v231, v38
    v_sub_f32 v244, v244, v38
    v_sub_f32 v245, v245, v38
    v_sub_f32 v246, v246, v38
    v_sub_f32 v247, v247, v38
    v_sub_f32 v68, v68, v38
    v_sub_f32 v69, v69, v38
    v_sub_f32 v70, v70, v38
    v_sub_f32 v71, v71, v38
    v_mul_f32 v84, v84, v39
    v_mul_f32 v85, v85, v39
    v_mul_f32 v86, v86, v39
    v_mul_f32 v87, v87, v39
    v_accvgpr_read_b32 v44, a4
    v_accvgpr_read_b32 v45, a5
    v_accvgpr_read_b32 v46, a6
    v_accvgpr_read_b32 v47, a7
    v_accvgpr_read_b32 v48, a20
    v_accvgpr_read_b32 v49, a21
    v_accvgpr_read_b32 v50, a22
    v_accvgpr_read_b32 v51, a23
    v_mul_f32 v44, v44, v39
    v_mul_f32 v45, v45, v39
    v_mul_f32 v46, v46, v39
    v_mul_f32 v47, v47, v39
    v_mul_f32 v48, v48, v39
    v_mul_f32 v49, v49, v39
    v_mul_f32 v50, v50, v39
    v_mul_f32 v51, v51, v39
    v_accvgpr_write_b32 a4, v44
    v_accvgpr_write_b32 a5, v45
    v_accvgpr_write_b32 a6, v46
    v_accvgpr_write_b32 a7, v47
    v_accvgpr_write_b32 a20, v48
    v_accvgpr_write_b32 a21, v49
    v_accvgpr_write_b32 a22, v50
    v_accvgpr_write_b32 a23, v51
    v_accvgpr_read_b32 v44, a36
    v_accvgpr_read_b32 v45, a37
    v_accvgpr_read_b32 v46, a38
    v_accvgpr_read_b32 v47, a39
    v_accvgpr_read_b32 v48, a52
    v_accvgpr_read_b32 v49, a53
    v_accvgpr_read_b32 v50, a54
    v_accvgpr_read_b32 v51, a55
    v_mul_f32 v44, v44, v39
    v_mul_f32 v45, v45, v39
    v_mul_f32 v46, v46, v39
    v_mul_f32 v47, v47, v39
    v_mul_f32 v48, v48, v39
    v_mul_f32 v49, v49, v39
    v_mul_f32 v50, v50, v39
    v_mul_f32 v51, v51, v39
    v_accvgpr_write_b32 a36, v44
    v_accvgpr_write_b32 a37, v45
    v_accvgpr_write_b32 a38, v46
    v_accvgpr_write_b32 a39, v47
    v_accvgpr_write_b32 a52, v48
    v_accvgpr_write_b32 a53, v49
    v_accvgpr_write_b32 a54, v50
    v_accvgpr_write_b32 a55, v51
    v_accvgpr_read_b32 v44, a68
    v_accvgpr_read_b32 v45, a69
    v_accvgpr_read_b32 v46, a70
    v_accvgpr_read_b32 v47, a71
    v_accvgpr_read_b32 v48, a84
    v_accvgpr_read_b32 v49, a85
    v_accvgpr_read_b32 v50, a86
    v_accvgpr_read_b32 v51, a87
    v_mul_f32 v44, v44, v39
    v_mul_f32 v45, v45, v39
    v_mul_f32 v46, v46, v39
    v_mul_f32 v47, v47, v39
    v_mul_f32 v48, v48, v39
    v_mul_f32 v49, v49, v39
    v_mul_f32 v50, v50, v39
    v_mul_f32 v51, v51, v39
    v_accvgpr_write_b32 a68, v44
    v_accvgpr_write_b32 a69, v45
    v_accvgpr_write_b32 a70, v46
    v_accvgpr_write_b32 a71, v47
    v_accvgpr_write_b32 a84, v48
    v_accvgpr_write_b32 a85, v49
    v_accvgpr_write_b32 a86, v50
    v_accvgpr_write_b32 a87, v51
    v_accvgpr_read_b32 v44, a100
    v_accvgpr_read_b32 v45, a101
    v_accvgpr_read_b32 v46, a102
    v_accvgpr_read_b32 v47, a103
    v_accvgpr_read_b32 v48, a116
    v_accvgpr_read_b32 v49, a117
    v_accvgpr_read_b32 v50, a118
    v_accvgpr_read_b32 v51, a119
    v_mul_f32 v44, v44, v39
    v_mul_f32 v45, v45, v39
    v_mul_f32 v46, v46, v39
    v_mul_f32 v47, v47, v39
    v_mul_f32 v48, v48, v39
    v_mul_f32 v49, v49, v39
    v_mul_f32 v50, v50, v39
    v_mul_f32 v51, v51, v39
    v_accvgpr_write_b32 a100, v44
    v_accvgpr_write_b32 a101, v45
    v_accvgpr_write_b32 a102, v46
    v_accvgpr_write_b32 a103, v47
    v_accvgpr_write_b32 a116, v48
    v_accvgpr_write_b32 a117, v49
    v_accvgpr_write_b32 a118, v50
    v_accvgpr_write_b32 a119, v51
    v_max3_f32 v124, v200, v201, v202
    v_max3_f32 v124, v124, v203, v216
    v_max3_f32 v124, v124, v217, v218
    v_max3_f32 v124, v124, v219, v232
    v_max3_f32 v124, v124, v233, v234
    v_max3_f32 v124, v124, v235, v248
    v_max3_f32 v124, v124, v249, v250
    v_max3_f32 v124, v124, v251, v251
    v_mov_b32 v36, v124
    v_mov_b32 v37, v124
    s_nop 1
    v_permlane16_swap_b32 v36, v37
    s_nop 1
    v_max_f32 v36, v36, v37
    v_mov_b32 v37, v36
    s_nop 1
    v_permlane32_swap_b32 v36, v37
    s_nop 1
    v_max_f32 v38, v36, v37
    v_max_f32 v38, 0, v38
    v_sub_f32 v39, 0, v38
    v_exp_f32 v39, v39
    v_sub_f32 v200, v200, v38
    v_sub_f32 v201, v201, v38
    v_sub_f32 v202, v202, v38
    v_sub_f32 v203, v203, v38
    v_sub_f32 v216, v216, v38
    v_sub_f32 v217, v217, v38
    v_sub_f32 v218, v218, v38
    v_sub_f32 v219, v219, v38
    v_sub_f32 v232, v232, v38
    v_sub_f32 v233, v233, v38
    v_sub_f32 v234, v234, v38
    v_sub_f32 v235, v235, v38
    v_sub_f32 v248, v248, v38
    v_sub_f32 v249, v249, v38
    v_sub_f32 v250, v250, v38
    v_sub_f32 v251, v251, v38
    v_sub_f32 v72, v72, v38
    v_sub_f32 v73, v73, v38
    v_sub_f32 v74, v74, v38
    v_sub_f32 v75, v75, v38
    v_mul_f32 v88, v88, v39
    v_mul_f32 v89, v89, v39
    v_mul_f32 v90, v90, v39
    v_mul_f32 v91, v91, v39
    v_accvgpr_read_b32 v44, a8
    v_accvgpr_read_b32 v45, a9
    v_accvgpr_read_b32 v46, a10
    v_accvgpr_read_b32 v47, a11
    v_accvgpr_read_b32 v48, a24
    v_accvgpr_read_b32 v49, a25
    v_accvgpr_read_b32 v50, a26
    v_accvgpr_read_b32 v51, a27
    v_mul_f32 v44, v44, v39
    v_mul_f32 v45, v45, v39
    v_mul_f32 v46, v46, v39
    v_mul_f32 v47, v47, v39
    v_mul_f32 v48, v48, v39
    v_mul_f32 v49, v49, v39
    v_mul_f32 v50, v50, v39
    v_mul_f32 v51, v51, v39
    v_accvgpr_write_b32 a8, v44
    v_accvgpr_write_b32 a9, v45
    v_accvgpr_write_b32 a10, v46
    v_accvgpr_write_b32 a11, v47
    v_accvgpr_write_b32 a24, v48
    v_accvgpr_write_b32 a25, v49
    v_accvgpr_write_b32 a26, v50
    v_accvgpr_write_b32 a27, v51
    v_accvgpr_read_b32 v44, a40
    v_accvgpr_read_b32 v45, a41
    v_accvgpr_read_b32 v46, a42
    v_accvgpr_read_b32 v47, a43
    v_accvgpr_read_b32 v48, a56
    v_accvgpr_read_b32 v49, a57
    v_accvgpr_read_b32 v50, a58
    v_accvgpr_read_b32 v51, a59
    v_mul_f32 v44, v44, v39
    v_mul_f32 v45, v45, v39
    v_mul_f32 v46, v46, v39
    v_mul_f32 v47, v47, v39
    v_mul_f32 v48, v48, v39
    v_mul_f32 v49, v49, v39
    v_mul_f32 v50, v50, v39
    v_mul_f32 v51, v51, v39
    v_accvgpr_write_b32 a40, v44
    v_accvgpr_write_b32 a41, v45
    v_accvgpr_write_b32 a42, v46
    v_accvgpr_write_b32 a43, v47
    v_accvgpr_write_b32 a56, v48
    v_accvgpr_write_b32 a57, v49
    v_accvgpr_write_b32 a58, v50
    v_accvgpr_write_b32 a59, v51
    v_accvgpr_read_b32 v44, a72
    v_accvgpr_read_b32 v45, a73
    v_accvgpr_read_b32 v46, a74
    v_accvgpr_read_b32 v47, a75
    v_accvgpr_read_b32 v48, a88
    v_accvgpr_read_b32 v49, a89
    v_accvgpr_read_b32 v50, a90
    v_accvgpr_read_b32 v51, a91
    v_mul_f32 v44, v44, v39
    v_mul_f32 v45, v45, v39
    v_mul_f32 v46, v46, v39
    v_mul_f32 v47, v47, v39
    v_mul_f32 v48, v48, v39
    v_mul_f32 v49, v49, v39
    v_mul_f32 v50, v50, v39
    v_mul_f32 v51, v51, v39
    v_accvgpr_write_b32 a72, v44
    v_accvgpr_write_b32 a73, v45
    v_accvgpr_write_b32 a74, v46
    v_accvgpr_write_b32 a75, v47
    v_accvgpr_write_b32 a88, v48
    v_accvgpr_write_b32 a89, v49
    v_accvgpr_write_b32 a90, v50
    v_accvgpr_write_b32 a91, v51
    v_accvgpr_read_b32 v44, a104
    v_accvgpr_read_b32 v45, a105
    v_accvgpr_read_b32 v46, a106
    v_accvgpr_read_b32 v47, a107
    v_accvgpr_read_b32 v48, a120
    v_accvgpr_read_b32 v49, a121
    v_accvgpr_read_b32 v50, a122
    v_accvgpr_read_b32 v51, a123
    v_mul_f32 v44, v44, v39
    v_mul_f32 v45, v45, v39
    v_mul_f32 v46, v46, v39
    v_mul_f32 v47, v47, v39
    v_mul_f32 v48, v48, v39
    v_mul_f32 v49, v49, v39
    v_mul_f32 v50, v50, v39
    v_mul_f32 v51, v51, v39
    v_accvgpr_write_b32 a104, v44
    v_accvgpr_write_b32 a105, v45
    v_accvgpr_write_b32 a106, v46
    v_accvgpr_write_b32 a107, v47
    v_accvgpr_write_b32 a120, v48
    v_accvgpr_write_b32 a121, v49
    v_accvgpr_write_b32 a122, v50
    v_accvgpr_write_b32 a123, v51
    v_max3_f32 v124, v204, v205, v206
    v_max3_f32 v124, v124, v207, v220
    v_max3_f32 v124, v124, v221, v222
    v_max3_f32 v124, v124, v223, v236
    v_max3_f32 v124, v124, v237, v238
    v_max3_f32 v124, v124, v239, v252
    v_max3_f32 v124, v124, v253, v254
    v_max3_f32 v124, v124, v255, v255
    v_mov_b32 v36, v124
    v_mov_b32 v37, v124
    s_nop 1
    v_permlane16_swap_b32 v36, v37
    s_nop 1
    v_max_f32 v36, v36, v37
    v_mov_b32 v37, v36
    s_nop 1
    v_permlane32_swap_b32 v36, v37
    s_nop 1
    v_max_f32 v38, v36, v37
    v_max_f32 v38, 0, v38
    v_sub_f32 v39, 0, v38
    v_exp_f32 v39, v39
    v_sub_f32 v204, v204, v38
    v_sub_f32 v205, v205, v38
    v_sub_f32 v206, v206, v38
    v_sub_f32 v207, v207, v38
    v_sub_f32 v220, v220, v38
    v_sub_f32 v221, v221, v38
    v_sub_f32 v222, v222, v38
    v_sub_f32 v223, v223, v38
    v_sub_f32 v236, v236, v38
    v_sub_f32 v237, v237, v38
    v_sub_f32 v238, v238, v38
    v_sub_f32 v239, v239, v38
    v_sub_f32 v252, v252, v38
    v_sub_f32 v253, v253, v38
    v_sub_f32 v254, v254, v38
    v_sub_f32 v255, v255, v38
    v_sub_f32 v76, v76, v38
    v_sub_f32 v77, v77, v38
    v_sub_f32 v78, v78, v38
    v_sub_f32 v79, v79, v38
    v_mul_f32 v92, v92, v39
    v_mul_f32 v93, v93, v39
    v_mul_f32 v94, v94, v39
    v_mul_f32 v95, v95, v39
    v_accvgpr_read_b32 v44, a12
    v_accvgpr_read_b32 v45, a13
    v_accvgpr_read_b32 v46, a14
    v_accvgpr_read_b32 v47, a15
    v_accvgpr_read_b32 v48, a28
    v_accvgpr_read_b32 v49, a29
    v_accvgpr_read_b32 v50, a30
    v_accvgpr_read_b32 v51, a31
    v_mul_f32 v44, v44, v39
    v_mul_f32 v45, v45, v39
    v_mul_f32 v46, v46, v39
    v_mul_f32 v47, v47, v39
    v_mul_f32 v48, v48, v39
    v_mul_f32 v49, v49, v39
    v_mul_f32 v50, v50, v39
    v_mul_f32 v51, v51, v39
    v_accvgpr_write_b32 a12, v44
    v_accvgpr_write_b32 a13, v45
    v_accvgpr_write_b32 a14, v46
    v_accvgpr_write_b32 a15, v47
    v_accvgpr_write_b32 a28, v48
    v_accvgpr_write_b32 a29, v49
    v_accvgpr_write_b32 a30, v50
    v_accvgpr_write_b32 a31, v51
    v_accvgpr_read_b32 v44, a44
    v_accvgpr_read_b32 v45, a45
    v_accvgpr_read_b32 v46, a46
    v_accvgpr_read_b32 v47, a47
    v_accvgpr_read_b32 v48, a60
    v_accvgpr_read_b32 v49, a61
    v_accvgpr_read_b32 v50, a62
    v_accvgpr_read_b32 v51, a63
    v_mul_f32 v44, v44, v39
    v_mul_f32 v45, v45, v39
    v_mul_f32 v46, v46, v39
    v_mul_f32 v47, v47, v39
    v_mul_f32 v48, v48, v39
    v_mul_f32 v49, v49, v39
    v_mul_f32 v50, v50, v39
    v_mul_f32 v51, v51, v39
    v_accvgpr_write_b32 a44, v44
    v_accvgpr_write_b32 a45, v45
    v_accvgpr_write_b32 a46, v46
    v_accvgpr_write_b32 a47, v47
    v_accvgpr_write_b32 a60, v48
    v_accvgpr_write_b32 a61, v49
    v_accvgpr_write_b32 a62, v50
    v_accvgpr_write_b32 a63, v51
    v_accvgpr_read_b32 v44, a76
    v_accvgpr_read_b32 v45, a77
    v_accvgpr_read_b32 v46, a78
    v_accvgpr_read_b32 v47, a79
    v_accvgpr_read_b32 v48, a92
    v_accvgpr_read_b32 v49, a93
    v_accvgpr_read_b32 v50, a94
    v_accvgpr_read_b32 v51, a95
    v_mul_f32 v44, v44, v39
    v_mul_f32 v45, v45, v39
    v_mul_f32 v46, v46, v39
    v_mul_f32 v47, v47, v39
    v_mul_f32 v48, v48, v39
    v_mul_f32 v49, v49, v39
    v_mul_f32 v50, v50, v39
    v_mul_f32 v51, v51, v39
    v_accvgpr_write_b32 a76, v44
    v_accvgpr_write_b32 a77, v45
    v_accvgpr_write_b32 a78, v46
    v_accvgpr_write_b32 a79, v47
    v_accvgpr_write_b32 a92, v48
    v_accvgpr_write_b32 a93, v49
    v_accvgpr_write_b32 a94, v50
    v_accvgpr_write_b32 a95, v51
    v_accvgpr_read_b32 v44, a108
    v_accvgpr_read_b32 v45, a109
    v_accvgpr_read_b32 v46, a110
    v_accvgpr_read_b32 v47, a111
    v_accvgpr_read_b32 v48, a124
    v_accvgpr_read_b32 v49, a125
    v_accvgpr_read_b32 v50, a126
    v_accvgpr_read_b32 v51, a127
    v_mul_f32 v44, v44, v39
    v_mul_f32 v45, v45, v39
    v_mul_f32 v46, v46, v39
    v_mul_f32 v47, v47, v39
    v_mul_f32 v48, v48, v39
    v_mul_f32 v49, v49, v39
    v_mul_f32 v50, v50, v39
    v_mul_f32 v51, v51, v39
    v_accvgpr_write_b32 a108, v44
    v_accvgpr_write_b32 a109, v45
    v_accvgpr_write_b32 a110, v46
    v_accvgpr_write_b32 a111, v47
    v_accvgpr_write_b32 a124, v48
    v_accvgpr_write_b32 a125, v49
    v_accvgpr_write_b32 a126, v50
    v_accvgpr_write_b32 a127, v51
    s_nop 3
    s_branch at_back0
at_rare1:
    s_nop 7
    s_nop 7
    v_max3_f32 v124, v128, v129, v130
    v_max3_f32 v124, v124, v131, v144
    v_max3_f32 v124, v124, v145, v146
    v_max3_f32 v124, v124, v147, v160
    v_max3_f32 v124, v124, v161, v162
    v_max3_f32 v124, v124, v163, v176
    v_max3_f32 v124, v124, v177, v178
    v_max3_f32 v124, v124, v179, v179
    v_mov_b32 v36, v124
    v_mov_b32 v37, v124
    s_nop 1
    v_permlane16_swap_b32 v36, v37
    s_nop 1
    v_max_f32 v36, v36, v37
    v_mov_b32 v37, v36
    s_nop 1
    v_permlane32_swap_b32 v36, v37
    s_nop 1
    v_max_f32 v38, v36, v37
    v_max_f32 v38, 0, v38
    v_sub_f32 v39, 0, v38
    v_exp_f32 v39, v39
    v_sub_f32 v128, v128, v38
    v_sub_f32 v129, v129, v38
    v_sub_f32 v130, v130, v38
    v_sub_f32 v131, v131, v38
    v_sub_f32 v144, v144, v38
    v_sub_f32 v145, v145, v38
    v_sub_f32 v146, v146, v38
    v_sub_f32 v147, v147, v38
    v_sub_f32 v160, v160, v38
    v_sub_f32 v161, v161, v38
    v_sub_f32 v162, v162, v38
    v_sub_f32 v163, v163, v38
    v_sub_f32 v176, v176, v38
    v_sub_f32 v177, v177, v38
    v_sub_f32 v178, v178, v38
    v_sub_f32 v179, v179, v38
    v_sub_f32 v64, v64, v38
    v_sub_f32 v65, v65, v38
    v_sub_f32 v66, v66, v38
    v_sub_f32 v67, v67, v38
    v_mul_f32 v80, v80, v39
    v_mul_f32 v81, v81, v39
    v_mul_f32 v82, v82, v39
    v_mul_f32 v83, v83, v39
    v_accvgpr_read_b32 v44, a0
    v_accvgpr_read_b32 v45, a1
    v_accvgpr_read_b32 v46, a2
    v_accvgpr_read_b32 v47, a3
    v_accvgpr_read_b32 v48, a16
    v_accvgpr_read_b32 v49, a17
    v_accvgpr_read_b32 v50, a18
    v_accvgpr_read_b32 v51, a19
    v_mul_f32 v44, v44, v39
    v_mul_f32 v45, v45, v39
    v_mul_f32 v46, v46, v39
    v_mul_f32 v47, v47, v39
    v_mul_f32 v48, v48, v39
    v_mul_f32 v49, v49, v39
    v_mul_f32 v50, v50, v39
    v_mul_f32 v51, v51, v39
    v_accvgpr_write_b32 a0, v44
    v_accvgpr_write_b32 a1, v45
    v_accvgpr_write_b32 a2, v46
    v_accvgpr_write_b32 a3, v47
    v_accvgpr_write_b32 a16, v48
    v_accvgpr_write_b32 a17, v49
    v_accvgpr_write_b32 a18, v50
    v_accvgpr_write_b32 a19, v51
    v_accvgpr_read_b32 v44, a32
    v_accvgpr_read_b32 v45, a33
    v_accvgpr_read_b32 v46, a34
    v_accvgpr_read_b32 v47, a35
    v_accvgpr_read_b32 v48, a48
    v_accvgpr_read_b32 v49, a49
    v_accvgpr_read_b32 v50, a50
    v_accvgpr_read_b32 v51, a51
    v_mul_f32 v44, v44, v39
    v_mul_f32 v45, v45, v39
    v_mul_f32 v46, v46, v39
    v_mul_f32 v47, v47, v39
    v_mul_f32 v48, v48, v39
    v_mul_f32 v49, v49, v39
    v_mul_f32 v50, v50, v39
    v_mul_f32 v51, v51, v39
    v_accvgpr_write_b32 a32, v44
    v_accvgpr_write_b32 a33, v45
    v_accvgpr_write_b32 a34, v46
    v_accvgpr_write_b32 a35, v47
    v_accvgpr_write_b32 a48, v48
    v_accvgpr_write_b32 a49, v49
    v_accvgpr_write_b32 a50, v50
    v_accvgpr_write_b32 a51, v51
    v_accvgpr_read_b32 v44, a64
    v_accvgpr_read_b32 v45, a65
    v_accvgpr_read_b32 v46, a66
    v_accvgpr_read_b32 v47, a67
    v_accvgpr_read_b32 v48, a80
    v_accvgpr_read_b32 v49, a81
    v_accvgpr_read_b32 v50, a82
    v_accvgpr_read_b32 v51, a83
    v_mul_f32 v44, v44, v39
    v_mul_f32 v45, v45, v39
    v_mul_f32 v46, v46, v39
    v_mul_f32 v47, v47, v39
    v_mul_f32 v48, v48, v39
    v_mul_f32 v49, v49, v39
    v_mul_f32 v50, v50, v39
    v_mul_f32 v51, v51, v39
    v_accvgpr_write_b32 a64, v44
    v_accvgpr_write_b32 a65, v45
    v_accvgpr_write_b32 a66, v46
    v_accvgpr_write_b32 a67, v47
    v_accvgpr_write_b32 a80, v48
    v_accvgpr_write_b32 a81, v49
    v_accvgpr_write_b32 a82, v50
    v_accvgpr_write_b32 a83, v51
    v_accvgpr_read_b32 v44, a96
    v_accvgpr_read_b32 v45, a97
    v_accvgpr_read_b32 v46, a98
    v_accvgpr_read_b32 v47, a99
    v_accvgpr_read_b32 v48, a112
    v_accvgpr_read_b32 v49, a113
    v_accvgpr_read_b32 v50, a114
    v_accvgpr_read_b32 v51, a115
    v_mul_f32 v44, v44, v39
    v_mul_f32 v45, v45, v39
    v_mul_f32 v46, v46, v39
    v_mul_f32 v47, v47, v39
    v_mul_f32 v48, v48, v39
    v_mul_f32 v49, v49, v39
    v_mul_f32 v50, v50, v39
    v_mul_f32 v51, v51, v39
    v_accvgpr_write_b32 a96, v44
    v_accvgpr_write_b32 a97, v45
    v_accvgpr_write_b32 a98, v46
    v_accvgpr_write_b32 a99, v47
    v_accvgpr_write_b32 a112, v48
    v_accvgpr_write_b32 a113, v49
    v_accvgpr_write_b32 a114, v50
    v_accvgpr_write_b32 a115, v51
    v_max3_f32 v124, v132, v133, v134
    v_max3_f32 v124, v124, v135, v148
    v_max3_f32 v124, v124, v149, v150
    v_max3_f32 v124, v124, v151, v164
    v_max3_f32 v124, v124, v165, v166
    v_max3_f32 v124, v124, v167, v180
    v_max3_f32 v124, v124, v181, v182
    v_max3_f32 v124, v124, v183, v183
    v_mov_b32 v36, v124
    v_mov_b32 v37, v124
    s_nop 1
    v_permlane16_swap_b32 v36, v37
    s_nop 1
    v_max_f32 v36, v36, v37
    v_mov_b32 v37, v36
    s_nop 1
    v_permlane32_swap_b32 v36, v37
    s_nop 1
    v_max_f32 v38, v36, v37
    v_max_f32 v38, 0, v38
    v_sub_f32 v39, 0, v38
    v_exp_f32 v39, v39
    v_sub_f32 v132, v132, v38
    v_sub_f32 v133, v133, v38
    v_sub_f32 v134, v134, v38
    v_sub_f32 v135, v135, v38
    v_sub_f32 v148, v148, v38
    v_sub_f32 v149, v149, v38
    v_sub_f32 v150, v150, v38
    v_sub_f32 v151, v151, v38
    v_sub_f32 v164, v164, v38
    v_sub_f32 v165, v165, v38
    v_sub_f32 v166, v166, v38
    v_sub_f32 v167, v167, v38
    v_sub_f32 v180, v180, v38
    v_sub_f32 v181, v181, v38
    v_sub_f32 v182, v182, v38
    v_sub_f32 v183, v183, v38
    v_sub_f32 v68, v68, v38
    v_sub_f32 v69, v69, v38
    v_sub_f32 v70, v70, v38
    v_sub_f32 v71, v71, v38
    v_mul_f32 v84, v84, v39
    v_mul_f32 v85, v85, v39
    v_mul_f32 v86, v86, v39
    v_mul_f32 v87, v87, v39
    v_accvgpr_read_b32 v44, a4
    v_accvgpr_read_b32 v45, a5
    v_accvgpr_read_b32 v46, a6
    v_accvgpr_read_b32 v47, a7
    v_accvgpr_read_b32 v48, a20
    v_accvgpr_read_b32 v49, a21
    v_accvgpr_read_b32 v50, a22
    v_accvgpr_read_b32 v51, a23
    v_mul_f32 v44, v44, v39
    v_mul_f32 v45, v45, v39
    v_mul_f32 v46, v46, v39
    v_mul_f32 v47, v47, v39
    v_mul_f32 v48, v48, v39
    v_mul_f32 v49, v49, v39
    v_mul_f32 v50, v50, v39
    v_mul_f32 v51, v51, v39
    v_accvgpr_write_b32 a4, v44
    v_accvgpr_write_b32 a5, v45
    v_accvgpr_write_b32 a6, v46
    v_accvgpr_write_b32 a7, v47
    v_accvgpr_write_b32 a20, v48
    v_accvgpr_write_b32 a21, v49
    v_accvgpr_write_b32 a22, v50
    v_accvgpr_write_b32 a23, v51
    v_accvgpr_read_b32 v44, a36
    v_accvgpr_read_b32 v45, a37
    v_accvgpr_read_b32 v46, a38
    v_accvgpr_read_b32 v47, a39
    v_accvgpr_read_b32 v48, a52
    v_accvgpr_read_b32 v49, a53
    v_accvgpr_read_b32 v50, a54
    v_accvgpr_read_b32 v51, a55
    v_mul_f32 v44, v44, v39
    v_mul_f32 v45, v45, v39
    v_mul_f32 v46, v46, v39
    v_mul_f32 v47, v47, v39
    v_mul_f32 v48, v48, v39
    v_mul_f32 v49, v49, v39
    v_mul_f32 v50, v50, v39
    v_mul_f32 v51, v51, v39
    v_accvgpr_write_b32 a36, v44
    v_accvgpr_write_b32 a37, v45
    v_accvgpr_write_b32 a38, v46
    v_accvgpr_write_b32 a39, v47
    v_accvgpr_write_b32 a52, v48
    v_accvgpr_write_b32 a53, v49
    v_accvgpr_write_b32 a54, v50
    v_accvgpr_write_b32 a55, v51
    v_accvgpr_read_b32 v44, a68
    v_accvgpr_read_b32 v45, a69
    v_accvgpr_read_b32 v46, a70
    v_accvgpr_read_b32 v47, a71
    v_accvgpr_read_b32 v48, a84
    v_accvgpr_read_b32 v49, a85
    v_accvgpr_read_b32 v50, a86
    v_accvgpr_read_b32 v51, a87
    v_mul_f32 v44, v44, v39
    v_mul_f32 v45, v45, v39
    v_mul_f32 v46, v46, v39
    v_mul_f32 v47, v47, v39
    v_mul_f32 v48, v48, v39
    v_mul_f32 v49, v49, v39
    v_mul_f32 v50, v50, v39
    v_mul_f32 v51, v51, v39
    v_accvgpr_write_b32 a68, v44
    v_accvgpr_write_b32 a69, v45
    v_accvgpr_write_b32 a70, v46
    v_accvgpr_write_b32 a71, v47
    v_accvgpr_write_b32 a84, v48
    v_accvgpr_write_b32 a85, v49
    v_accvgpr_write_b32 a86, v50
    v_accvgpr_write_b32 a87, v51
    v_accvgpr_read_b32 v44, a100
    v_accvgpr_read_b32 v45, a101
    v_accvgpr_read_b32 v46, a102
    v_accvgpr_read_b32 v47, a103
    v_accvgpr_read_b32 v48, a116
    v_accvgpr_read_b32 v49, a117
    v_accvgpr_read_b32 v50, a118
    v_accvgpr_read_b32 v51, a119
    v_mul_f32 v44, v44, v39
    v_mul_f32 v45, v45, v39
    v_mul_f32 v46, v46, v39
    v_mul_f32 v47, v47, v39
    v_mul_f32 v48, v48, v39
    v_mul_f32 v49, v49, v39
    v_mul_f32 v50, v50, v39
    v_mul_f32 v51, v51, v39
    v_accvgpr_write_b32 a100, v44
    v_accvgpr_write_b32 a101, v45
    v_accvgpr_write_b32 a102, v46
    v_accvgpr_write_b32 a103, v47
    v_accvgpr_write_b32 a116, v48
    v_accvgpr_write_b32 a117, v49
    v_accvgpr_write_b32 a118, v50
    v_accvgpr_write_b32 a119, v51
    v_max3_f32 v124, v136, v137, v138
    v_max3_f32 v124, v124, v139, v152
    v_max3_f32 v124, v124, v153, v154
    v_max3_f32 v124, v124, v155, v168
    v_max3_f32 v124, v124, v169, v170
    v_max3_f32 v124, v124, v171, v184
    v_max3_f32 v124, v124, v185, v186
    v_max3_f32 v124, v124, v187, v187
    v_mov_b32 v36, v124
    v_mov_b32 v37, v124
    s_nop 1
    v_permlane16_swap_b32 v36, v37
    s_nop 1
    v_max_f32 v36, v36, v37
    v_mov_b32 v37, v36
    s_nop 1
    v_permlane32_swap_b32 v36, v37
    s_nop 1
    v_max_f32 v38, v36, v37
    v_max_f32 v38, 0, v38
    v_sub_f32 v39, 0, v38
    v_exp_f32 v39, v39
    v_sub_f32 v136, v136, v38
    v_sub_f32 v137, v137, v38
    v_sub_f32 v138, v138, v38
    v_sub_f32 v139, v139, v38
    v_sub_f32 v152, v152, v38
    v_sub_f32 v153, v153, v38
    v_sub_f32 v154, v154, v38
    v_sub_f32 v155, v155, v38
    v_sub_f32 v168, v168, v38
    v_sub_f32 v169, v169, v38
    v_sub_f32 v170, v170, v38
    v_sub_f32 v171, v171, v38
    v_sub_f32 v184, v184, v38
    v_sub_f32 v185, v185, v38
    v_sub_f32 v186, v186, v38
    v_sub_f32 v187, v187, v38
    v_sub_f32 v72, v72, v38
    v_sub_f32 v73, v73, v38
    v_sub_f32 v74, v74, v38
    v_sub_f32 v75, v75, v38
    v_mul_f32 v88, v88, v39
    v_mul_f32 v89, v89, v39
    v_mul_f32 v90, v90, v39
    v_mul_f32 v91, v91, v39
    v_accvgpr_read_b32 v44, a8
    v_accvgpr_read_b32 v45, a9
    v_accvgpr_read_b32 v46, a10
    v_accvgpr_read_b32 v47, a11
    v_accvgpr_read_b32 v48, a24
    v_accvgpr_read_b32 v49, a25
    v_accvgpr_read_b32 v50, a26
    v_accvgpr_read_b32 v51, a27
    v_mul_f32 v44, v44, v39
    v_mul_f32 v45, v45, v39
    v_mul_f32 v46, v46, v39
    v_mul_f32 v47, v47, v39
    v_mul_f32 v48, v48, v39
    v_mul_f32 v49, v49, v39
    v_mul_f32 v50, v50, v39
    v_mul_f32 v51, v51, v39
    v_accvgpr_write_b32 a8, v44
    v_accvgpr_write_b32 a9, v45
    v_accvgpr_write_b32 a10, v46
    v_accvgpr_write_b32 a11, v47
    v_accvgpr_write_b32 a24, v48
    v_accvgpr_write_b32 a25, v49
    v_accvgpr_write_b32 a26, v50
    v_accvgpr_write_b32 a27, v51
    v_accvgpr_read_b32 v44, a40
    v_accvgpr_read_b32 v45, a41
    v_accvgpr_read_b32 v46, a42
    v_accvgpr_read_b32 v47, a43
    v_accvgpr_read_b32 v48, a56
    v_accvgpr_read_b32 v49, a57
    v_accvgpr_read_b32 v50, a58
    v_accvgpr_read_b32 v51, a59
    v_mul_f32 v44, v44, v39
    v_mul_f32 v45, v45, v39
    v_mul_f32 v46, v46, v39
    v_mul_f32 v47, v47, v39
    v_mul_f32 v48, v48, v39
    v_mul_f32 v49, v49, v39
    v_mul_f32 v50, v50, v39
    v_mul_f32 v51, v51, v39
    v_accvgpr_write_b32 a40, v44
    v_accvgpr_write_b32 a41, v45
    v_accvgpr_write_b32 a42, v46
    v_accvgpr_write_b32 a43, v47
    v_accvgpr_write_b32 a56, v48
    v_accvgpr_write_b32 a57, v49
    v_accvgpr_write_b32 a58, v50
    v_accvgpr_write_b32 a59, v51
    v_accvgpr_read_b32 v44, a72
    v_accvgpr_read_b32 v45, a73
    v_accvgpr_read_b32 v46, a74
    v_accvgpr_read_b32 v47, a75
    v_accvgpr_read_b32 v48, a88
    v_accvgpr_read_b32 v49, a89
    v_accvgpr_read_b32 v50, a90
    v_accvgpr_read_b32 v51, a91
    v_mul_f32 v44, v44, v39
    v_mul_f32 v45, v45, v39
    v_mul_f32 v46, v46, v39
    v_mul_f32 v47, v47, v39
    v_mul_f32 v48, v48, v39
    v_mul_f32 v49, v49, v39
    v_mul_f32 v50, v50, v39
    v_mul_f32 v51, v51, v39
    v_accvgpr_write_b32 a72, v44
    v_accvgpr_write_b32 a73, v45
    v_accvgpr_write_b32 a74, v46
    v_accvgpr_write_b32 a75, v47
    v_accvgpr_write_b32 a88, v48
    v_accvgpr_write_b32 a89, v49
    v_accvgpr_write_b32 a90, v50
    v_accvgpr_write_b32 a91, v51
    v_accvgpr_read_b32 v44, a104
    v_accvgpr_read_b32 v45, a105
    v_accvgpr_read_b32 v46, a106
    v_accvgpr_read_b32 v47, a107
    v_accvgpr_read_b32 v48, a120
    v_accvgpr_read_b32 v49, a121
    v_accvgpr_read_b32 v50, a122
    v_accvgpr_read_b32 v51, a123
    v_mul_f32 v44, v44, v39
    v_mul_f32 v45, v45, v39
    v_mul_f32 v46, v46, v39
    v_mul_f32 v47, v47, v39
    v_mul_f32 v48, v48, v39
    v_mul_f32 v49, v49, v39
    v_mul_f32 v50, v50, v39
    v_mul_f32 v51, v51, v39
    v_accvgpr_write_b32 a104, v44
    v_accvgpr_write_b32 a105, v45
    v_accvgpr_write_b32 a106, v46
    v_accvgpr_write_b32 a107, v47
    v_accvgpr_write_b32 a120, v48
    v_accvgpr_write_b32 a121, v49
    v_accvgpr_write_b32 a122, v50
    v_accvgpr_write_b32 a123, v51
    v_max3_f32 v124, v140, v141, v142
    v_max3_f32 v124, v124, v143, v156
    v_max3_f32 v124, v124, v157, v158
    v_max3_f32 v124, v124, v159, v172
    v_max3_f32 v124, v124, v173, v174
    v_max3_f32 v124, v124, v175, v188
    v_max3_f32 v124, v124, v189, v190
    v_max3_f32 v124, v124, v191, v191
    v_mov_b32 v36, v124
    v_mov_b32 v37, v124
    s_nop 1
    v_permlane16_swap_b32 v36, v37
    s_nop 1
    v_max_f32 v36, v36, v37
    v_mov_b32 v37, v36
    s_nop 1
    v_permlane32_swap_b32 v36, v37
    s_nop 1
    v_max_f32 v38, v36, v37
    v_max_f32 v38, 0, v38
    v_sub_f32 v39, 0, v38
    v_exp_f32 v39, v39
    v_sub_f32 v140, v140, v38
    v_sub_f32 v141, v141, v38
    v_sub_f32 v142, v142, v38
    v_sub_f32 v143, v143, v38
    v_sub_f32 v156, v156, v38
    v_sub_f32 v157, v157, v38
    v_sub_f32 v158, v158, v38
    v_sub_f32 v159, v159, v38
    v_sub_f32 v172, v172, v38
    v_sub_f32 v173, v173, v38
    v_sub_f32 v174, v174, v38
    v_sub_f32 v175, v175, v38
    v_sub_f32 v188, v188, v38
    v_sub_f32 v189, v189, v38
    v_sub_f32 v190, v190, v38
    v_sub_f32 v191, v191, v38
    v_sub_f32 v76, v76, v38
    v_sub_f32 v77, v77, v38
    v_sub_f32 v78, v78, v38
    v_sub_f32 v79, v79, v38
    v_mul_f32 v92, v92, v39
    v_mul_f32 v93, v93, v39
    v_mul_f32 v94, v94, v39
    v_mul_f32 v95, v95, v39
    v_accvgpr_read_b32 v44, a12
    v_accvgpr_read_b32 v45, a13
    v_accvgpr_read_b32 v46, a14
    v_accvgpr_read_b32 v47, a15
    v_accvgpr_read_b32 v48, a28
    v_accvgpr_read_b32 v49, a29
    v_accvgpr_read_b32 v50, a30
    v_accvgpr_read_b32 v51, a31
    v_mul_f32 v44, v44, v39
    v_mul_f32 v45, v45, v39
    v_mul_f32 v46, v46, v39
    v_mul_f32 v47, v47, v39
    v_mul_f32 v48, v48, v39
    v_mul_f32 v49, v49, v39
    v_mul_f32 v50, v50, v39
    v_mul_f32 v51, v51, v39
    v_accvgpr_write_b32 a12, v44
    v_accvgpr_write_b32 a13, v45
    v_accvgpr_write_b32 a14, v46
    v_accvgpr_write_b32 a15, v47
    v_accvgpr_write_b32 a28, v48
    v_accvgpr_write_b32 a29, v49
    v_accvgpr_write_b32 a30, v50
    v_accvgpr_write_b32 a31, v51
    v_accvgpr_read_b32 v44, a44
    v_accvgpr_read_b32 v45, a45
    v_accvgpr_read_b32 v46, a46
    v_accvgpr_read_b32 v47, a47
    v_accvgpr_read_b32 v48, a60
    v_accvgpr_read_b32 v49, a61
    v_accvgpr_read_b32 v50, a62
    v_accvgpr_read_b32 v51, a63
    v_mul_f32 v44, v44, v39
    v_mul_f32 v45, v45, v39
    v_mul_f32 v46, v46, v39
    v_mul_f32 v47, v47, v39
    v_mul_f32 v48, v48, v39
    v_mul_f32 v49, v49, v39
    v_mul_f32 v50, v50, v39
    v_mul_f32 v51, v51, v39
    v_accvgpr_write_b32 a44, v44
    v_accvgpr_write_b32 a45, v45
    v_accvgpr_write_b32 a46, v46
    v_accvgpr_write_b32 a47, v47
    v_accvgpr_write_b32 a60, v48
    v_accvgpr_write_b32 a61, v49
    v_accvgpr_write_b32 a62, v50
    v_accvgpr_write_b32 a63, v51
    v_accvgpr_read_b32 v44, a76
    v_accvgpr_read_b32 v45, a77
    v_accvgpr_read_b32 v46, a78
    v_accvgpr_read_b32 v47, a79
    v_accvgpr_read_b32 v48, a92
    v_accvgpr_read_b32 v49, a93
    v_accvgpr_read_b32 v50, a94
    v_accvgpr_read_b32 v51, a95
    v_mul_f32 v44, v44, v39
    v_mul_f32 v45, v45, v39
    v_mul_f32 v46, v46, v39
    v_mul_f32 v47, v47, v39
    v_mul_f32 v48, v48, v39
    v_mul_f32 v49, v49, v39
    v_mul_f32 v50, v50, v39
    v_mul_f32 v51, v51, v39
    v_accvgpr_write_b32 a76, v44
    v_accvgpr_write_b32 a77, v45
    v_accvgpr_write_b32 a78, v46
    v_accvgpr_write_b32 a79, v47
    v_accvgpr_write_b32 a92, v48
    v_accvgpr_write_b32 a93, v49
    v_accvgpr_write_b32 a94, v50
    v_accvgpr_write_b32 a95, v51
    v_accvgpr_read_b32 v44, a108
    v_accvgpr_read_b32 v45, a109
    v_accvgpr_read_b32 v46, a110
    v_accvgpr_read_b32 v47, a111
    v_accvgpr_read_b32 v48, a124
    v_accvgpr_read_b32 v49, a125
    v_accvgpr_read_b32 v50, a126
    v_accvgpr_read_b32 v51, a127
    v_mul_f32 v44, v44, v39
    v_mul_f32 v45, v45, v39
    v_mul_f32 v46, v46, v39
    v_mul_f32 v47, v47, v39
    v_mul_f32 v48, v48, v39
    v_mul_f32 v49, v49, v39
    v_mul_f32 v50, v50, v39
    v_mul_f32 v51, v51, v39
    v_accvgpr_write_b32 a108, v44
    v_accvgpr_write_b32 a109, v45
    v_accvgpr_write_b32 a110, v46
    v_accvgpr_write_b32 a111, v47
    v_accvgpr_write_b32 a124, v48
    v_accvgpr_write_b32 a125, v49
    v_accvgpr_write_b32 a126, v50
    v_accvgpr_write_b32 a127, v51
    s_nop 3
    s_branch at_back1
at_rare2:
    s_nop 7
    s_nop 7
    v_max3_f32 v124, v192, v193, v194
    v_max3_f32 v124, v124, v195, v208
    v_max3_f32 v124, v124, v209, v210
    v_max3_f32 v124, v124, v211, v224
    v_max3_f32 v124, v124, v225, v226
    v_max3_f32 v124, v124, v227, v240
    v_max3_f32 v124, v124, v241, v242
    v_max3_f32 v124, v124, v243, v243
    v_mov_b32 v36, v124
    v_mov_b32 v37, v124
    s_nop 1
    v_permlane16_swap_b32 v36, v37
    s_nop 1
    v_max_f32 v36, v36, v37
    v_mov_b32 v37, v36
    s_nop 1
    v_permlane32_swap_b32 v36, v37
    s_nop 1
    v_max_f32 v38, v36, v37
    v_max_f32 v38, 0, v38
    v_sub_f32 v39, 0, v38
    v_exp_f32 v39, v39
    v_sub_f32 v192, v192, v38
    v_sub_f32 v193, v193, v38
    v_sub_f32 v194, v194, v38
    v_sub_f32 v195, v195, v38
    v_sub_f32 v208, v208, v38
    v_sub_f32 v209, v209, v38
    v_sub_f32 v210, v210, v38
    v_sub_f32 v211, v211, v38
    v_sub_f32 v224, v224, v38
    v_sub_f32 v225, v225, v38
    v_sub_f32 v226, v226, v38
    v_sub_f32 v227, v227, v38
    v_sub_f32 v240, v240, v38
    v_sub_f32 v241, v241, v38
    v_sub_f32 v242, v242, v38
    v_sub_f32 v243, v243, v38
    v_sub_f32 v64, v64, v38
    v_sub_f32 v65, v65, v38
    v_sub_f32 v66, v66, v38
    v_sub_f32 v67, v67, v38
    v_mul_f32 v80, v80, v39
    v_mul_f32 v81, v81, v39
    v_mul_f32 v82, v82, v39
    v_mul_f32 v83, v83, v39
    v_accvgpr_read_b32 v44, a0
    v_accvgpr_read_b32 v45, a1
    v_accvgpr_read_b32 v46, a2
    v_accvgpr_read_b32 v47, a3
    v_accvgpr_read_b32 v48, a16
    v_accvgpr_read_b32 v49, a17
    v_accvgpr_read_b32 v50, a18
    v_accvgpr_read_b32 v51, a19
    v_mul_f32 v44, v44, v39
    v_mul_f32 v45, v45, v39
    v_mul_f32 v46, v46, v39
    v_mul_f32 v47, v47, v39
    v_mul_f32 v48, v48, v39
    v_mul_f32 v49, v49, v39
    v_mul_f32 v50, v50, v39
    v_mul_f32 v51, v51, v39
    v_accvgpr_write_b32 a0, v44
    v_accvgpr_write_b32 a1, v45
    v_accvgpr_write_b32 a2, v46
    v_accvgpr_write_b32 a3, v47
    v_accvgpr_write_b32 a16, v48
    v_accvgpr_write_b32 a17, v49
    v_accvgpr_write_b32 a18, v50
    v_accvgpr_write_b32 a19, v51
    v_accvgpr_read_b32 v44, a32
    v_accvgpr_read_b32 v45, a33
    v_accvgpr_read_b32 v46, a34
    v_accvgpr_read_b32 v47, a35
    v_accvgpr_read_b32 v48, a48
    v_accvgpr_read_b32 v49, a49
    v_accvgpr_read_b32 v50, a50
    v_accvgpr_read_b32 v51, a51
    v_mul_f32 v44, v44, v39
    v_mul_f32 v45, v45, v39
    v_mul_f32 v46, v46, v39
    v_mul_f32 v47, v47, v39
    v_mul_f32 v48, v48, v39
    v_mul_f32 v49, v49, v39
    v_mul_f32 v50, v50, v39
    v_mul_f32 v51, v51, v39
    v_accvgpr_write_b32 a32, v44
    v_accvgpr_write_b32 a33, v45
    v_accvgpr_write_b32 a34, v46
    v_accvgpr_write_b32 a35, v47
    v_accvgpr_write_b32 a48, v48
    v_accvgpr_write_b32 a49, v49
    v_accvgpr_write_b32 a50, v50
    v_accvgpr_write_b32 a51, v51
    v_accvgpr_read_b32 v44, a64
    v_accvgpr_read_b32 v45, a65
    v_accvgpr_read_b32 v46, a66
    v_accvgpr_read_b32 v47, a67
    v_accvgpr_read_b32 v48, a80
    v_accvgpr_read_b32 v49, a81
    v_accvgpr_read_b32 v50, a82
    v_accvgpr_read_b32 v51, a83
    v_mul_f32 v44, v44, v39
    v_mul_f32 v45, v45, v39
    v_mul_f32 v46, v46, v39
    v_mul_f32 v47, v47, v39
    v_mul_f32 v48, v48, v39
    v_mul_f32 v49, v49, v39
    v_mul_f32 v50, v50, v39
    v_mul_f32 v51, v51, v39
    v_accvgpr_write_b32 a64, v44
    v_accvgpr_write_b32 a65, v45
    v_accvgpr_write_b32 a66, v46
    v_accvgpr_write_b32 a67, v47
    v_accvgpr_write_b32 a80, v48
    v_accvgpr_write_b32 a81, v49
    v_accvgpr_write_b32 a82, v50
    v_accvgpr_write_b32 a83, v51
    v_accvgpr_read_b32 v44, a96
    v_accvgpr_read_b32 v45, a97
    v_accvgpr_read_b32 v46, a98
    v_accvgpr_read_b32 v47, a99
    v_accvgpr_read_b32 v48, a112
    v_accvgpr_read_b32 v49, a113
    v_accvgpr_read_b32 v50, a114
    v_accvgpr_read_b32 v51, a115
    v_mul_f32 v44, v44, v39
    v_mul_f32 v45, v45, v39
    v_mul_f32 v46, v46, v39
    v_mul_f32 v47, v47, v39
    v_mul_f32 v48, v48, v39
    v_mul_f32 v49, v49, v39
    v_mul_f32 v50, v50, v39
    v_mul_f32 v51, v51, v39
    v_accvgpr_write_b32 a96, v44
    v_accvgpr_write_b32 a97, v45
    v_accvgpr_write_b32 a98, v46
    v_accvgpr_write_b32 a99, v47
    v_accvgpr_write_b32 a112, v48
    v_accvgpr_write_b32 a113, v49
    v_accvgpr_write_b32 a114, v50
    v_accvgpr_write_b32 a115, v51
    v_max3_f32 v124, v196, v197, v198
    v_max3_f32 v124, v124, v199, v212
    v_max3_f32 v124, v124, v213, v214
    v_max3_f32 v124, v124, v215, v228
    v_max3_f32 v124, v124, v229, v230
    v_max3_f32 v124, v124, v231, v244
    v_max3_f32 v124, v124, v245, v246
    v_max3_f32 v124, v124, v247, v247
    v_mov_b32 v36, v124
    v_mov_b32 v37, v124
    s_nop 1
    v_permlane16_swap_b32 v36, v37
    s_nop 1
    v_max_f32 v36, v36, v37
    v_mov_b32 v37, v36
    s_nop 1
    v_permlane32_swap_b32 v36, v37
    s_nop 1
    v_max_f32 v38, v36, v37
    v_max_f32 v38, 0, v38
    v_sub_f32 v39, 0, v38
    v_exp_f32 v39, v39
    v_sub_f32 v196, v196, v38
    v_sub_f32 v197, v197, v38
    v_sub_f32 v198, v198, v38
    v_sub_f32 v199, v199, v38
    v_sub_f32 v212, v212, v38
    v_sub_f32 v213, v213, v38
    v_sub_f32 v214, v214, v38
    v_sub_f32 v215, v215, v38
    v_sub_f32 v228, v228, v38
    v_sub_f32 v229, v229, v38
    v_sub_f32 v230, v230, v38
    v_sub_f32 v231, v231, v38
    v_sub_f32 v244, v244, v38
    v_sub_f32 v245, v245, v38
    v_sub_f32 v246, v246, v38
    v_sub_f32 v247, v247, v38
    v_sub_f32 v68, v68, v38
    v_sub_f32 v69, v69, v38
    v_sub_f32 v70, v70, v38
    v_sub_f32 v71, v71, v38
    v_mul_f32 v84, v84, v39
    v_mul_f32 v85, v85, v39
    v_mul_f32 v86, v86, v39
    v_mul_f32 v87, v87, v39
    v_accvgpr_read_b32 v44, a4
    v_accvgpr_read_b32 v45, a5
    v_accvgpr_read_b32 v46, a6
    v_accvgpr_read_b32 v47, a7
    v_accvgpr_read_b32 v48, a20
    v_accvgpr_read_b32 v49, a21
    v_accvgpr_read_b32 v50, a22
    v_accvgpr_read_b32 v51, a23
    v_mul_f32 v44, v44, v39
    v_mul_f32 v45, v45, v39
    v_mul_f32 v46, v46, v39
    v_mul_f32 v47, v47, v39
    v_mul_f32 v48, v48, v39
    v_mul_f32 v49, v49, v39
    v_mul_f32 v50, v50, v39
    v_mul_f32 v51, v51, v39
    v_accvgpr_write_b32 a4, v44
    v_accvgpr_write_b32 a5, v45
    v_accvgpr_write_b32 a6, v46
    v_accvgpr_write_b32 a7, v47
    v_accvgpr_write_b32 a20, v48
    v_accvgpr_write_b32 a21, v49
    v_accvgpr_write_b32 a22, v50
    v_accvgpr_write_b32 a23, v51
    v_accvgpr_read_b32 v44, a36
    v_accvgpr_read_b32 v45, a37
    v_accvgpr_read_b32 v46, a38
    v_accvgpr_read_b32 v47, a39
    v_accvgpr_read_b32 v48, a52
    v_accvgpr_read_b32 v49, a53
    v_accvgpr_read_b32 v50, a54
    v_accvgpr_read_b32 v51, a55
    v_mul_f32 v44, v44, v39
    v_mul_f32 v45, v45, v39
    v_mul_f32 v46, v46, v39
    v_mul_f32 v47, v47, v39
    v_mul_f32 v48, v48, v39
    v_mul_f32 v49, v49, v39
    v_mul_f32 v50, v50, v39
    v_mul_f32 v51, v51, v39
    v_accvgpr_write_b32 a36, v44
    v_accvgpr_write_b32 a37, v45
    v_accvgpr_write_b32 a38, v46
    v_accvgpr_write_b32 a39, v47
    v_accvgpr_write_b32 a52, v48
    v_accvgpr_write_b32 a53, v49
    v_accvgpr_write_b32 a54, v50
    v_accvgpr_write_b32 a55, v51
    v_accvgpr_read_b32 v44, a68
    v_accvgpr_read_b32 v45, a69
    v_accvgpr_read_b32 v46, a70
    v_accvgpr_read_b32 v47, a71
    v_accvgpr_read_b32 v48, a84
    v_accvgpr_read_b32 v49, a85
    v_accvgpr_read_b32 v50, a86
    v_accvgpr_read_b32 v51, a87
    v_mul_f32 v44, v44, v39
    v_mul_f32 v45, v45, v39
    v_mul_f32 v46, v46, v39
    v_mul_f32 v47, v47, v39
    v_mul_f32 v48, v48, v39
    v_mul_f32 v49, v49, v39
    v_mul_f32 v50, v50, v39
    v_mul_f32 v51, v51, v39
    v_accvgpr_write_b32 a68, v44
    v_accvgpr_write_b32 a69, v45
    v_accvgpr_write_b32 a70, v46
    v_accvgpr_write_b32 a71, v47
    v_accvgpr_write_b32 a84, v48
    v_accvgpr_write_b32 a85, v49
    v_accvgpr_write_b32 a86, v50
    v_accvgpr_write_b32 a87, v51
    v_accvgpr_read_b32 v44, a100
    v_accvgpr_read_b32 v45, a101
    v_accvgpr_read_b32 v46, a102
    v_accvgpr_read_b32 v47, a103
    v_accvgpr_read_b32 v48, a116
    v_accvgpr_read_b32 v49, a117
    v_accvgpr_read_b32 v50, a118
    v_accvgpr_read_b32 v51, a119
    v_mul_f32 v44, v44, v39
    v_mul_f32 v45, v45, v39
    v_mul_f32 v46, v46, v39
    v_mul_f32 v47, v47, v39
    v_mul_f32 v48, v48, v39
    v_mul_f32 v49, v49, v39
    v_mul_f32 v50, v50, v39
    v_mul_f32 v51, v51, v39
    v_accvgpr_write_b32 a100, v44
    v_accvgpr_write_b32 a101, v45
    v_accvgpr_write_b32 a102, v46
    v_accvgpr_write_b32 a103, v47
    v_accvgpr_write_b32 a116, v48
    v_accvgpr_write_b32 a117, v49
    v_accvgpr_write_b32 a118, v50
    v_accvgpr_write_b32 a119, v51
    v_max3_f32 v124, v200, v201, v202
    v_max3_f32 v124, v124, v203, v216
    v_max3_f32 v124, v124, v217, v218
    v_max3_f32 v124, v124, v219, v232
    v_max3_f32 v124, v124, v233, v234
    v_max3_f32 v124, v124, v235, v248
    v_max3_f32 v124, v124, v249, v250
    v_max3_f32 v124, v124, v251, v251
    v_mov_b32 v36, v124
    v_mov_b32 v37, v124
    s_nop 1
    v_permlane16_swap_b32 v36, v37
    s_nop 1
    v_max_f32 v36, v36, v37
    v_mov_b32 v37, v36
    s_nop 1
    v_permlane32_swap_b32 v36, v37
    s_nop 1
    v_max_f32 v38, v36, v37
    v_max_f32 v38, 0, v38
    v_sub_f32 v39, 0, v38
    v_exp_f32 v39, v39
    v_sub_f32 v200, v200, v38
    v_sub_f32 v201, v201, v38
    v_sub_f32 v202, v202, v38
    v_sub_f32 v203, v203, v38
    v_sub_f32 v216, v216, v38
    v_sub_f32 v217, v217, v38
    v_sub_f32 v218, v218, v38
    v_sub_f32 v219, v219, v38
    v_sub_f32 v232, v232, v38
    v_sub_f32 v233, v233, v38
    v_sub_f32 v234, v234, v38
    v_sub_f32 v235, v235, v38
    v_sub_f32 v248, v248, v38
    v_sub_f32 v249, v249, v38
    v_sub_f32 v250, v250, v38
    v_sub_f32 v251, v251, v38
    v_sub_f32 v72, v72, v38
    v_sub_f32 v73, v73, v38
    v_sub_f32 v74, v74, v38
    v_sub_f32 v75, v75, v38
    v_mul_f32 v88, v88, v39
    v_mul_f32 v89, v89, v39
    v_mul_f32 v90, v90, v39
    v_mul_f32 v91, v91, v39
    v_accvgpr_read_b32 v44, a8
    v_accvgpr_read_b32 v45, a9
    v_accvgpr_read_b32 v46, a10
    v_accvgpr_read_b32 v47, a11
    v_accvgpr_read_b32 v48, a24
    v_accvgpr_read_b32 v49, a25
    v_accvgpr_read_b32 v50, a26
    v_accvgpr_read_b32 v51, a27
    v_mul_f32 v44, v44, v39
    v_mul_f32 v45, v45, v39
    v_mul_f32 v46, v46, v39
    v_mul_f32 v47, v47, v39
    v_mul_f32 v48, v48, v39
    v_mul_f32 v49, v49, v39
    v_mul_f32 v50, v50, v39
    v_mul_f32 v51, v51, v39
    v_accvgpr_write_b32 a8, v44
    v_accvgpr_write_b32 a9, v45
    v_accvgpr_write_b32 a10, v46
    v_accvgpr_write_b32 a11, v47
    v_accvgpr_write_b32 a24, v48
    v_accvgpr_write_b32 a25, v49
    v_accvgpr_write_b32 a26, v50
    v_accvgpr_write_b32 a27, v51
    v_accvgpr_read_b32 v44, a40
    v_accvgpr_read_b32 v45, a41
    v_accvgpr_read_b32 v46, a42
    v_accvgpr_read_b32 v47, a43
    v_accvgpr_read_b32 v48, a56
    v_accvgpr_read_b32 v49, a57
    v_accvgpr_read_b32 v50, a58
    v_accvgpr_read_b32 v51, a59
    v_mul_f32 v44, v44, v39
    v_mul_f32 v45, v45, v39
    v_mul_f32 v46, v46, v39
    v_mul_f32 v47, v47, v39
    v_mul_f32 v48, v48, v39
    v_mul_f32 v49, v49, v39
    v_mul_f32 v50, v50, v39
    v_mul_f32 v51, v51, v39
    v_accvgpr_write_b32 a40, v44
    v_accvgpr_write_b32 a41, v45
    v_accvgpr_write_b32 a42, v46
    v_accvgpr_write_b32 a43, v47
    v_accvgpr_write_b32 a56, v48
    v_accvgpr_write_b32 a57, v49
    v_accvgpr_write_b32 a58, v50
    v_accvgpr_write_b32 a59, v51
    v_accvgpr_read_b32 v44, a72
    v_accvgpr_read_b32 v45, a73
    v_accvgpr_read_b32 v46, a74
    v_accvgpr_read_b32 v47, a75
    v_accvgpr_read_b32 v48, a88
    v_accvgpr_read_b32 v49, a89
    v_accvgpr_read_b32 v50, a90
    v_accvgpr_read_b32 v51, a91
    v_mul_f32 v44, v44, v39
    v_mul_f32 v45, v45, v39
    v_mul_f32 v46, v46, v39
    v_mul_f32 v47, v47, v39
    v_mul_f32 v48, v48, v39
    v_mul_f32 v49, v49, v39
    v_mul_f32 v50, v50, v39
    v_mul_f32 v51, v51, v39
    v_accvgpr_write_b32 a72, v44
    v_accvgpr_write_b32 a73, v45
    v_accvgpr_write_b32 a74, v46
    v_accvgpr_write_b32 a75, v47
    v_accvgpr_write_b32 a88, v48
    v_accvgpr_write_b32 a89, v49
    v_accvgpr_write_b32 a90, v50
    v_accvgpr_write_b32 a91, v51
    v_accvgpr_read_b32 v44, a104
    v_accvgpr_read_b32 v45, a105
    v_accvgpr_read_b32 v46, a106
    v_accvgpr_read_b32 v47, a107
    v_accvgpr_read_b32 v48, a120
    v_accvgpr_read_b32 v49, a121
    v_accvgpr_read_b32 v50, a122
    v_accvgpr_read_b32 v51, a123
    v_mul_f32 v44, v44, v39
    v_mul_f32 v45, v45, v39
    v_mul_f32 v46, v46, v39
    v_mul_f32 v47, v47, v39
    v_mul_f32 v48, v48, v39
    v_mul_f32 v49, v49, v39
    v_mul_f32 v50, v50, v39
    v_mul_f32 v51, v51, v39
    v_accvgpr_write_b32 a104, v44
    v_accvgpr_write_b32 a105, v45
    v_accvgpr_write_b32 a106, v46
    v_accvgpr_write_b32 a107, v47
    v_accvgpr_write_b32 a120, v48
    v_accvgpr_write_b32 a121, v49
    v_accvgpr_write_b32 a122, v50
    v_accvgpr_write_b32 a123, v51
    v_max3_f32 v124, v204, v205, v206
    v_max3_f32 v124, v124, v207, v220
    v_max3_f32 v124, v124, v221, v222
    v_max3_f32 v124, v124, v223, v236
    v_max3_f32 v124, v124, v237, v238
    v_max3_f32 v124, v124, v239, v252
    v_max3_f32 v124, v124, v253, v254
    v_max3_f32 v124, v124, v255, v255
    v_mov_b32 v36, v124
    v_mov_b32 v37, v124
    s_nop 1
    v_permlane16_swap_b32 v36, v37
    s_nop 1
    v_max_f32 v36, v36, v37
    v_mov_b32 v37, v36
    s_nop 1
    v_permlane32_swap_b32 v36, v37
    s_nop 1
    v_max_f32 v38, v36, v37
    v_max_f32 v38, 0, v38
    v_sub_f32 v39, 0, v38
    v_exp_f32 v39, v39
    v_sub_f32 v204, v204, v38
    v_sub_f32 v205, v205, v38
    v_sub_f32 v206, v206, v38
    v_sub_f32 v207, v207, v38
    v_sub_f32 v220, v220, v38
    v_sub_f32 v221, v221, v38
    v_sub_f32 v222, v222, v38
    v_sub_f32 v223, v223, v38
    v_sub_f32 v236, v236, v38
    v_sub_f32 v237, v237, v38
    v_sub_f32 v238, v238, v38
    v_sub_f32 v239, v239, v38
    v_sub_f32 v252, v252, v38
    v_sub_f32 v253, v253, v38
    v_sub_f32 v254, v254, v38
    v_sub_f32 v255, v255, v38
    v_sub_f32 v76, v76, v38
    v_sub_f32 v77, v77, v38
    v_sub_f32 v78, v78, v38
    v_sub_f32 v79, v79, v38
    v_mul_f32 v92, v92, v39
    v_mul_f32 v93, v93, v39
    v_mul_f32 v94, v94, v39
    v_mul_f32 v95, v95, v39
    v_accvgpr_read_b32 v44, a12
    v_accvgpr_read_b32 v45, a13
    v_accvgpr_read_b32 v46, a14
    v_accvgpr_read_b32 v47, a15
    v_accvgpr_read_b32 v48, a28
    v_accvgpr_read_b32 v49, a29
    v_accvgpr_read_b32 v50, a30
    v_accvgpr_read_b32 v51, a31
    v_mul_f32 v44, v44, v39
    v_mul_f32 v45, v45, v39
    v_mul_f32 v46, v46, v39
    v_mul_f32 v47, v47, v39
    v_mul_f32 v48, v48, v39
    v_mul_f32 v49, v49, v39
    v_mul_f32 v50, v50, v39
    v_mul_f32 v51, v51, v39
    v_accvgpr_write_b32 a12, v44
    v_accvgpr_write_b32 a13, v45
    v_accvgpr_write_b32 a14, v46
    v_accvgpr_write_b32 a15, v47
    v_accvgpr_write_b32 a28, v48
    v_accvgpr_write_b32 a29, v49
    v_accvgpr_write_b32 a30, v50
    v_accvgpr_write_b32 a31, v51
    v_accvgpr_read_b32 v44, a44
    v_accvgpr_read_b32 v45, a45
    v_accvgpr_read_b32 v46, a46
    v_accvgpr_read_b32 v47, a47
    v_accvgpr_read_b32 v48, a60
    v_accvgpr_read_b32 v49, a61
    v_accvgpr_read_b32 v50, a62
    v_accvgpr_read_b32 v51, a63
    v_mul_f32 v44, v44, v39
    v_mul_f32 v45, v45, v39
    v_mul_f32 v46, v46, v39
    v_mul_f32 v47, v47, v39
    v_mul_f32 v48, v48, v39
    v_mul_f32 v49, v49, v39
    v_mul_f32 v50, v50, v39
    v_mul_f32 v51, v51, v39
    v_accvgpr_write_b32 a44, v44
    v_accvgpr_write_b32 a45, v45
    v_accvgpr_write_b32 a46, v46
    v_accvgpr_write_b32 a47, v47
    v_accvgpr_write_b32 a60, v48
    v_accvgpr_write_b32 a61, v49
    v_accvgpr_write_b32 a62, v50
    v_accvgpr_write_b32 a63, v51
    v_accvgpr_read_b32 v44, a76
    v_accvgpr_read_b32 v45, a77
    v_accvgpr_read_b32 v46, a78
    v_accvgpr_read_b32 v47, a79
    v_accvgpr_read_b32 v48, a92
    v_accvgpr_read_b32 v49, a93
    v_accvgpr_read_b32 v50, a94
    v_accvgpr_read_b32 v51, a95
    v_mul_f32 v44, v44, v39
    v_mul_f32 v45, v45, v39
    v_mul_f32 v46, v46, v39
    v_mul_f32 v47, v47, v39
    v_mul_f32 v48, v48, v39
    v_mul_f32 v49, v49, v39
    v_mul_f32 v50, v50, v39
    v_mul_f32 v51, v51, v39
    v_accvgpr_write_b32 a76, v44
    v_accvgpr_write_b32 a77, v45
    v_accvgpr_write_b32 a78, v46
    v_accvgpr_write_b32 a79, v47
    v_accvgpr_write_b32 a92, v48
    v_accvgpr_write_b32 a93, v49
    v_accvgpr_write_b32 a94, v50
    v_accvgpr_write_b32 a95, v51
    v_accvgpr_read_b32 v44, a108
    v_accvgpr_read_b32 v45, a109
    v_accvgpr_read_b32 v46, a110
    v_accvgpr_read_b32 v47, a111
    v_accvgpr_read_b32 v48, a124
    v_accvgpr_read_b32 v49, a125
    v_accvgpr_read_b32 v50, a126
    v_accvgpr_read_b32 v51, a127
    v_mul_f32 v44, v44, v39
    v_mul_f32 v45, v45, v39
    v_mul_f32 v46, v46, v39
    v_mul_f32 v47, v47, v39
    v_mul_f32 v48, v48, v39
    v_mul_f32 v49, v49, v39
    v_mul_f32 v50, v50, v39
    v_mul_f32 v51, v51, v39
    v_accvgpr_write_b32 a108, v44
    v_accvgpr_write_b32 a109, v45
    v_accvgpr_write_b32 a110, v46
    v_accvgpr_write_b32 a111, v47
    v_accvgpr_write_b32 a124, v48
    v_accvgpr_write_b32 a125, v49
    v_accvgpr_write_b32 a126, v50
    v_accvgpr_write_b32 a127, v51
    s_nop 3
    s_branch at_back2
at_rare3:
    s_nop 7
    s_nop 7
    v_max3_f32 v124, v128, v129, v130
    v_max3_f32 v124, v124, v131, v144
    v_max3_f32 v124, v124, v145, v146
    v_max3_f32 v124, v124, v147, v160
    v_max3_f32 v124, v124, v161, v162
    v_max3_f32 v124, v124, v163, v176
    v_max3_f32 v124, v124, v177, v178
    v_max3_f32 v124, v124, v179, v179
    v_mov_b32 v36, v124
    v_mov_b32 v37, v124
    s_nop 1
    v_permlane16_swap_b32 v36, v37
    s_nop 1
    v_max_f32 v36, v36, v37
    v_mov_b32 v37, v36
    s_nop 1
    v_permlane32_swap_b32 v36, v37
    s_nop 1
    v_max_f32 v38, v36, v37
    v_max_f32 v38, 0, v38
    v_sub_f32 v39, 0, v38
    v_exp_f32 v39, v39
    v_sub_f32 v128, v128, v38
    v_sub_f32 v129, v129, v38
    v_sub_f32 v130, v130, v38
    v_sub_f32 v131, v131, v38
    v_sub_f32 v144, v144, v38
    v_sub_f32 v145, v145, v38
    v_sub_f32 v146, v146, v38
    v_sub_f32 v147, v147, v38
    v_sub_f32 v160, v160, v38
    v_sub_f32 v161, v161, v38
    v_sub_f32 v162, v162, v38
    v_sub_f32 v163, v163, v38
    v_sub_f32 v176, v176, v38
    v_sub_f32 v177, v177, v38
    v_sub_f32 v178, v178, v38
    v_sub_f32 v179, v179, v38
    v_sub_f32 v64, v64, v38
    v_sub_f32 v65, v65, v38
    v_sub_f32 v66, v66, v38
    v_sub_f32 v67, v67, v38
    v_mul_f32 v80, v80, v39
    v_mul_f32 v81, v81, v39
    v_mul_f32 v82, v82, v39
    v_mul_f32 v83, v83, v39
    v_accvgpr_read_b32 v44, a0
    v_accvgpr_read_b32 v45, a1
    v_accvgpr_read_b32 v46, a2
    v_accvgpr_read_b32 v47, a3
    v_accvgpr_read_b32 v48, a16
    v_accvgpr_read_b32 v49, a17
    v_accvgpr_read_b32 v50, a18
    v_accvgpr_read_b32 v51, a19
    v_mul_f32 v44, v44, v39
    v_mul_f32 v45, v45, v39
    v_mul_f32 v46, v46, v39
    v_mul_f32 v47, v47, v39
    v_mul_f32 v48, v48, v39
    v_mul_f32 v49, v49, v39
    v_mul_f32 v50, v50, v39
    v_mul_f32 v51, v51, v39
    v_accvgpr_write_b32 a0, v44
    v_accvgpr_write_b32 a1, v45
    v_accvgpr_write_b32 a2, v46
    v_accvgpr_write_b32 a3, v47
    v_accvgpr_write_b32 a16, v48
    v_accvgpr_write_b32 a17, v49
    v_accvgpr_write_b32 a18, v50
    v_accvgpr_write_b32 a19, v51
    v_accvgpr_read_b32 v44, a32
    v_accvgpr_read_b32 v45, a33
    v_accvgpr_read_b32 v46, a34
    v_accvgpr_read_b32 v47, a35
    v_accvgpr_read_b32 v48, a48
    v_accvgpr_read_b32 v49, a49
    v_accvgpr_read_b32 v50, a50
    v_accvgpr_read_b32 v51, a51
    v_mul_f32 v44, v44, v39
    v_mul_f32 v45, v45, v39
    v_mul_f32 v46, v46, v39
    v_mul_f32 v47, v47, v39
    v_mul_f32 v48, v48, v39
    v_mul_f32 v49, v49, v39
    v_mul_f32 v50, v50, v39
    v_mul_f32 v51, v51, v39
    v_accvgpr_write_b32 a32, v44
    v_accvgpr_write_b32 a33, v45
    v_accvgpr_write_b32 a34, v46
    v_accvgpr_write_b32 a35, v47
    v_accvgpr_write_b32 a48, v48
    v_accvgpr_write_b32 a49, v49
    v_accvgpr_write_b32 a50, v50
    v_accvgpr_write_b32 a51, v51
    v_accvgpr_read_b32 v44, a64
    v_accvgpr_read_b32 v45, a65
    v_accvgpr_read_b32 v46, a66
    v_accvgpr_read_b32 v47, a67
    v_accvgpr_read_b32 v48, a80
    v_accvgpr_read_b32 v49, a81
    v_accvgpr_read_b32 v50, a82
    v_accvgpr_read_b32 v51, a83
    v_mul_f32 v44, v44, v39
    v_mul_f32 v45, v45, v39
    v_mul_f32 v46, v46, v39
    v_mul_f32 v47, v47, v39
    v_mul_f32 v48, v48, v39
    v_mul_f32 v49, v49, v39
    v_mul_f32 v50, v50, v39
    v_mul_f32 v51, v51, v39
    v_accvgpr_write_b32 a64, v44
    v_accvgpr_write_b32 a65, v45
    v_accvgpr_write_b32 a66, v46
    v_accvgpr_write_b32 a67, v47
    v_accvgpr_write_b32 a80, v48
    v_accvgpr_write_b32 a81, v49
    v_accvgpr_write_b32 a82, v50
    v_accvgpr_write_b32 a83, v51
    v_accvgpr_read_b32 v44, a96
    v_accvgpr_read_b32 v45, a97
    v_accvgpr_read_b32 v46, a98
    v_accvgpr_read_b32 v47, a99
    v_accvgpr_read_b32 v48, a112
    v_accvgpr_read_b32 v49, a113
    v_accvgpr_read_b32 v50, a114
    v_accvgpr_read_b32 v51, a115
    v_mul_f32 v44, v44, v39
    v_mul_f32 v45, v45, v39
    v_mul_f32 v46, v46, v39
    v_mul_f32 v47, v47, v39
    v_mul_f32 v48, v48, v39
    v_mul_f32 v49, v49, v39
    v_mul_f32 v50, v50, v39
    v_mul_f32 v51, v51, v39
    v_accvgpr_write_b32 a96, v44
    v_accvgpr_write_b32 a97, v45
    v_accvgpr_write_b32 a98, v46
    v_accvgpr_write_b32 a99, v47
    v_accvgpr_write_b32 a112, v48
    v_accvgpr_write_b32 a113, v49
    v_accvgpr_write_b32 a114, v50
    v_accvgpr_write_b32 a115, v51
    v_max3_f32 v124, v132, v133, v134
    v_max3_f32 v124, v124, v135, v148
    v_max3_f32 v124, v124, v149, v150
    v_max3_f32 v124, v124, v151, v164
    v_max3_f32 v124, v124, v165, v166
    v_max3_f32 v124, v124, v167, v180
    v_max3_f32 v124, v124, v181, v182
    v_max3_f32 v124, v124, v183, v183
    v_mov_b32 v36, v124
    v_mov_b32 v37, v124
    s_nop 1
    v_permlane16_swap_b32 v36, v37
    s_nop 1
    v_max_f32 v36, v36, v37
    v_mov_b32 v37, v36
    s_nop 1
    v_permlane32_swap_b32 v36, v37
    s_nop 1
    v_max_f32 v38, v36, v37
    v_max_f32 v38, 0, v38
    v_sub_f32 v39, 0, v38
    v_exp_f32 v39, v39
    v_sub_f32 v132, v132, v38
    v_sub_f32 v133, v133, v38
    v_sub_f32 v134, v134, v38
    v_sub_f32 v135, v135, v38
    v_sub_f32 v148, v148, v38
    v_sub_f32 v149, v149, v38
    v_sub_f32 v150, v150, v38
    v_sub_f32 v151, v151, v38
    v_sub_f32 v164, v164, v38
    v_sub_f32 v165, v165, v38
    v_sub_f32 v166, v166, v38
    v_sub_f32 v167, v167, v38
    v_sub_f32 v180, v180, v38
    v_sub_f32 v181, v181, v38
    v_sub_f32 v182, v182, v38
    v_sub_f32 v183, v183, v38
    v_sub_f32 v68, v68, v38
    v_sub_f32 v69, v69, v38
    v_sub_f32 v70, v70, v38
    v_sub_f32 v71, v71, v38
    v_mul_f32 v84, v84, v39
    v_mul_f32 v85, v85, v39
    v_mul_f32 v86, v86, v39
    v_mul_f32 v87, v87, v39
    v_accvgpr_read_b32 v44, a4
    v_accvgpr_read_b32 v45, a5
    v_accvgpr_read_b32 v46, a6
    v_accvgpr_read_b32 v47, a7
    v_accvgpr_read_b32 v48, a20
    v_accvgpr_read_b32 v49, a21
    v_accvgpr_read_b32 v50, a22
    v_accvgpr_read_b32 v51, a23
    v_mul_f32 v44, v44, v39
    v_mul_f32 v45, v45, v39
    v_mul_f32 v46, v46, v39
    v_mul_f32 v47, v47, v39
    v_mul_f32 v48, v48, v39
    v_mul_f32 v49, v49, v39
    v_mul_f32 v50, v50, v39
    v_mul_f32 v51, v51, v39
    v_accvgpr_write_b32 a4, v44
    v_accvgpr_write_b32 a5, v45
    v_accvgpr_write_b32 a6, v46
    v_accvgpr_write_b32 a7, v47
    v_accvgpr_write_b32 a20, v48
    v_accvgpr_write_b32 a21, v49
    v_accvgpr_write_b32 a22, v50
    v_accvgpr_write_b32 a23, v51
    v_accvgpr_read_b32 v44, a36
    v_accvgpr_read_b32 v45, a37
    v_accvgpr_read_b32 v46, a38
    v_accvgpr_read_b32 v47, a39
    v_accvgpr_read_b32 v48, a52
    v_accvgpr_read_b32 v49, a53
    v_accvgpr_read_b32 v50, a54
    v_accvgpr_read_b32 v51, a55
    v_mul_f32 v44, v44, v39
    v_mul_f32 v45, v45, v39
    v_mul_f32 v46, v46, v39
    v_mul_f32 v47, v47, v39
    v_mul_f32 v48, v48, v39
    v_mul_f32 v49, v49, v39
    v_mul_f32 v50, v50, v39
    v_mul_f32 v51, v51, v39
    v_accvgpr_write_b32 a36, v44
    v_accvgpr_write_b32 a37, v45
    v_accvgpr_write_b32 a38, v46
    v_accvgpr_write_b32 a39, v47
    v_accvgpr_write_b32 a52, v48
    v_accvgpr_write_b32 a53, v49
    v_accvgpr_write_b32 a54, v50
    v_accvgpr_write_b32 a55, v51
    v_accvgpr_read_b32 v44, a68
    v_accvgpr_read_b32 v45, a69
    v_accvgpr_read_b32 v46, a70
    v_accvgpr_read_b32 v47, a71
    v_accvgpr_read_b32 v48, a84
    v_accvgpr_read_b32 v49, a85
    v_accvgpr_read_b32 v50, a86
    v_accvgpr_read_b32 v51, a87
    v_mul_f32 v44, v44, v39
    v_mul_f32 v45, v45, v39
    v_mul_f32 v46, v46, v39
    v_mul_f32 v47, v47, v39
    v_mul_f32 v48, v48, v39
    v_mul_f32 v49, v49, v39
    v_mul_f32 v50, v50, v39
    v_mul_f32 v51, v51, v39
    v_accvgpr_write_b32 a68, v44
    v_accvgpr_write_b32 a69, v45
    v_accvgpr_write_b32 a70, v46
    v_accvgpr_write_b32 a71, v47
    v_accvgpr_write_b32 a84, v48
    v_accvgpr_write_b32 a85, v49
    v_accvgpr_write_b32 a86, v50
    v_accvgpr_write_b32 a87, v51
    v_accvgpr_read_b32 v44, a100
    v_accvgpr_read_b32 v45, a101
    v_accvgpr_read_b32 v46, a102
    v_accvgpr_read_b32 v47, a103
    v_accvgpr_read_b32 v48, a116
    v_accvgpr_read_b32 v49, a117
    v_accvgpr_read_b32 v50, a118
    v_accvgpr_read_b32 v51, a119
    v_mul_f32 v44, v44, v39
    v_mul_f32 v45, v45, v39
    v_mul_f32 v46, v46, v39
    v_mul_f32 v47, v47, v39
    v_mul_f32 v48, v48, v39
    v_mul_f32 v49, v49, v39
    v_mul_f32 v50, v50, v39
    v_mul_f32 v51, v51, v39
    v_accvgpr_write_b32 a100, v44
    v_accvgpr_write_b32 a101, v45
    v_accvgpr_write_b32 a102, v46
    v_accvgpr_write_b32 a103, v47
    v_accvgpr_write_b32 a116, v48
    v_accvgpr_write_b32 a117, v49
    v_accvgpr_write_b32 a118, v50
    v_accvgpr_write_b32 a119, v51
    v_max3_f32 v124, v136, v137, v138
    v_max3_f32 v124, v124, v139, v152
    v_max3_f32 v124, v124, v153, v154
    v_max3_f32 v124, v124, v155, v168
    v_max3_f32 v124, v124, v169, v170
    v_max3_f32 v124, v124, v171, v184
    v_max3_f32 v124, v124, v185, v186
    v_max3_f32 v124, v124, v187, v187
    v_mov_b32 v36, v124
    v_mov_b32 v37, v124
    s_nop 1
    v_permlane16_swap_b32 v36, v37
    s_nop 1
    v_max_f32 v36, v36, v37
    v_mov_b32 v37, v36
    s_nop 1
    v_permlane32_swap_b32 v36, v37
    s_nop 1
    v_max_f32 v38, v36, v37
    v_max_f32 v38, 0, v38
    v_sub_f32 v39, 0, v38
    v_exp_f32 v39, v39
    v_sub_f32 v136, v136, v38
    v_sub_f32 v137, v137, v38
    v_sub_f32 v138, v138, v38
    v_sub_f32 v139, v139, v38
    v_sub_f32 v152, v152, v38
    v_sub_f32 v153, v153, v38
    v_sub_f32 v154, v154, v38
    v_sub_f32 v155, v155, v38
    v_sub_f32 v168, v168, v38
    v_sub_f32 v169, v169, v38
    v_sub_f32 v170, v170, v38
    v_sub_f32 v171, v171, v38
    v_sub_f32 v184, v184, v38
    v_sub_f32 v185, v185, v38
    v_sub_f32 v186, v186, v38
    v_sub_f32 v187, v187, v38
    v_sub_f32 v72, v72, v38
    v_sub_f32 v73, v73, v38
    v_sub_f32 v74, v74, v38
    v_sub_f32 v75, v75, v38
    v_mul_f32 v88, v88, v39
    v_mul_f32 v89, v89, v39
    v_mul_f32 v90, v90, v39
    v_mul_f32 v91, v91, v39
    v_accvgpr_read_b32 v44, a8
    v_accvgpr_read_b32 v45, a9
    v_accvgpr_read_b32 v46, a10
    v_accvgpr_read_b32 v47, a11
    v_accvgpr_read_b32 v48, a24
    v_accvgpr_read_b32 v49, a25
    v_accvgpr_read_b32 v50, a26
    v_accvgpr_read_b32 v51, a27
    v_mul_f32 v44, v44, v39
    v_mul_f32 v45, v45, v39
    v_mul_f32 v46, v46, v39
    v_mul_f32 v47, v47, v39
    v_mul_f32 v48, v48, v39
    v_mul_f32 v49, v49, v39
    v_mul_f32 v50, v50, v39
    v_mul_f32 v51, v51, v39
    v_accvgpr_write_b32 a8, v44
    v_accvgpr_write_b32 a9, v45
    v_accvgpr_write_b32 a10, v46
    v_accvgpr_write_b32 a11, v47
    v_accvgpr_write_b32 a24, v48
    v_accvgpr_write_b32 a25, v49
    v_accvgpr_write_b32 a26, v50
    v_accvgpr_write_b32 a27, v51
    v_accvgpr_read_b32 v44, a40
    v_accvgpr_read_b32 v45, a41
    v_accvgpr_read_b32 v46, a42
    v_accvgpr_read_b32 v47, a43
    v_accvgpr_read_b32 v48, a56
    v_accvgpr_read_b32 v49, a57
    v_accvgpr_read_b32 v50, a58
    v_accvgpr_read_b32 v51, a59
    v_mul_f32 v44, v44, v39
    v_mul_f32 v45, v45, v39
    v_mul_f32 v46, v46, v39
    v_mul_f32 v47, v47, v39
    v_mul_f32 v48, v48, v39
    v_mul_f32 v49, v49, v39
    v_mul_f32 v50, v50, v39
    v_mul_f32 v51, v51, v39
    v_accvgpr_write_b32 a40, v44
    v_accvgpr_write_b32 a41, v45
    v_accvgpr_write_b32 a42, v46
    v_accvgpr_write_b32 a43, v47
    v_accvgpr_write_b32 a56, v48
    v_accvgpr_write_b32 a57, v49
    v_accvgpr_write_b32 a58, v50
    v_accvgpr_write_b32 a59, v51
    v_accvgpr_read_b32 v44, a72
    v_accvgpr_read_b32 v45, a73
    v_accvgpr_read_b32 v46, a74
    v_accvgpr_read_b32 v47, a75
    v_accvgpr_read_b32 v48, a88
    v_accvgpr_read_b32 v49, a89
    v_accvgpr_read_b32 v50, a90
    v_accvgpr_read_b32 v51, a91
    v_mul_f32 v44, v44, v39
    v_mul_f32 v45, v45, v39
    v_mul_f32 v46, v46, v39
    v_mul_f32 v47, v47, v39
    v_mul_f32 v48, v48, v39
    v_mul_f32 v49, v49, v39
    v_mul_f32 v50, v50, v39
    v_mul_f32 v51, v51, v39
    v_accvgpr_write_b32 a72, v44
    v_accvgpr_write_b32 a73, v45
    v_accvgpr_write_b32 a74, v46
    v_accvgpr_write_b32 a75, v47
    v_accvgpr_write_b32 a88, v48
    v_accvgpr_write_b32 a89, v49
    v_accvgpr_write_b32 a90, v50
    v_accvgpr_write_b32 a91, v51
    v_accvgpr_read_b32 v44, a104
    v_accvgpr_read_b32 v45, a105
    v_accvgpr_read_b32 v46, a106
    v_accvgpr_read_b32 v47, a107
    v_accvgpr_read_b32 v48, a120
    v_accvgpr_read_b32 v49, a121
    v_accvgpr_read_b32 v50, a122
    v_accvgpr_read_b32 v51, a123
    v_mul_f32 v44, v44, v39
    v_mul_f32 v45, v45, v39
    v_mul_f32 v46, v46, v39
    v_mul_f32 v47, v47, v39
    v_mul_f32 v48, v48, v39
    v_mul_f32 v49, v49, v39
    v_mul_f32 v50, v50, v39
    v_mul_f32 v51, v51, v39
    v_accvgpr_write_b32 a104, v44
    v_accvgpr_write_b32 a105, v45
    v_accvgpr_write_b32 a106, v46
    v_accvgpr_write_b32 a107, v47
    v_accvgpr_write_b32 a120, v48
    v_accvgpr_write_b32 a121, v49
    v_accvgpr_write_b32 a122, v50
    v_accvgpr_write_b32 a123, v51
    v_max3_f32 v124, v140, v141, v142
    v_max3_f32 v124, v124, v143, v156
    v_max3_f32 v124, v124, v157, v158
    v_max3_f32 v124, v124, v159, v172
    v_max3_f32 v124, v124, v173, v174
    v_max3_f32 v124, v124, v175, v188
    v_max3_f32 v124, v124, v189, v190
    v_max3_f32 v124, v124, v191, v191
    v_mov_b32 v36, v124
    v_mov_b32 v37, v124
    s_nop 1
    v_permlane16_swap_b32 v36, v37
    s_nop 1
    v_max_f32 v36, v36, v37
    v_mov_b32 v37, v36
    s_nop 1
    v_permlane32_swap_b32 v36, v37
    s_nop 1
    v_max_f32 v38, v36, v37
    v_max_f32 v38, 0, v38
    v_sub_f32 v39, 0, v38
    v_exp_f32 v39, v39
    v_sub_f32 v140, v140, v38
    v_sub_f32 v141, v141, v38
    v_sub_f32 v142, v142, v38
    v_sub_f32 v143, v143, v38
    v_sub_f32 v156, v156, v38
    v_sub_f32 v157, v157, v38
    v_sub_f32 v158, v158, v38
    v_sub_f32 v159, v159, v38
    v_sub_f32 v172, v172, v38
    v_sub_f32 v173, v173, v38
    v_sub_f32 v174, v174, v38
    v_sub_f32 v175, v175, v38
    v_sub_f32 v188, v188, v38
    v_sub_f32 v189, v189, v38
    v_sub_f32 v190, v190, v38
    v_sub_f32 v191, v191, v38
    v_sub_f32 v76, v76, v38
    v_sub_f32 v77, v77, v38
    v_sub_f32 v78, v78, v38
    v_sub_f32 v79, v79, v38
    v_mul_f32 v92, v92, v39
    v_mul_f32 v93, v93, v39
    v_mul_f32 v94, v94, v39
    v_mul_f32 v95, v95, v39
    v_accvgpr_read_b32 v44, a12
    v_accvgpr_read_b32 v45, a13
    v_accvgpr_read_b32 v46, a14
    v_accvgpr_read_b32 v47, a15
    v_accvgpr_read_b32 v48, a28
    v_accvgpr_read_b32 v49, a29
    v_accvgpr_read_b32 v50, a30
    v_accvgpr_read_b32 v51, a31
    v_mul_f32 v44, v44, v39
    v_mul_f32 v45, v45, v39
    v_mul_f32 v46, v46, v39
    v_mul_f32 v47, v47, v39
    v_mul_f32 v48, v48, v39
    v_mul_f32 v49, v49, v39
    v_mul_f32 v50, v50, v39
    v_mul_f32 v51, v51, v39
    v_accvgpr_write_b32 a12, v44
    v_accvgpr_write_b32 a13, v45
    v_accvgpr_write_b32 a14, v46
    v_accvgpr_write_b32 a15, v47
    v_accvgpr_write_b32 a28, v48
    v_accvgpr_write_b32 a29, v49
    v_accvgpr_write_b32 a30, v50
    v_accvgpr_write_b32 a31, v51
    v_accvgpr_read_b32 v44, a44
    v_accvgpr_read_b32 v45, a45
    v_accvgpr_read_b32 v46, a46
    v_accvgpr_read_b32 v47, a47
    v_accvgpr_read_b32 v48, a60
    v_accvgpr_read_b32 v49, a61
    v_accvgpr_read_b32 v50, a62
    v_accvgpr_read_b32 v51, a63
    v_mul_f32 v44, v44, v39
    v_mul_f32 v45, v45, v39
    v_mul_f32 v46, v46, v39
    v_mul_f32 v47, v47, v39
    v_mul_f32 v48, v48, v39
    v_mul_f32 v49, v49, v39
    v_mul_f32 v50, v50, v39
    v_mul_f32 v51, v51, v39
    v_accvgpr_write_b32 a44, v44
    v_accvgpr_write_b32 a45, v45
    v_accvgpr_write_b32 a46, v46
    v_accvgpr_write_b32 a47, v47
    v_accvgpr_write_b32 a60, v48
    v_accvgpr_write_b32 a61, v49
    v_accvgpr_write_b32 a62, v50
    v_accvgpr_write_b32 a63, v51
    v_accvgpr_read_b32 v44, a76
    v_accvgpr_read_b32 v45, a77
    v_accvgpr_read_b32 v46, a78
    v_accvgpr_read_b32 v47, a79
    v_accvgpr_read_b32 v48, a92
    v_accvgpr_read_b32 v49, a93
    v_accvgpr_read_b32 v50, a94
    v_accvgpr_read_b32 v51, a95
    v_mul_f32 v44, v44, v39
    v_mul_f32 v45, v45, v39
    v_mul_f32 v46, v46, v39
    v_mul_f32 v47, v47, v39
    v_mul_f32 v48, v48, v39
    v_mul_f32 v49, v49, v39
    v_mul_f32 v50, v50, v39
    v_mul_f32 v51, v51, v39
    v_accvgpr_write_b32 a76, v44
    v_accvgpr_write_b32 a77, v45
    v_accvgpr_write_b32 a78, v46
    v_accvgpr_write_b32 a79, v47
    v_accvgpr_write_b32 a92, v48
    v_accvgpr_write_b32 a93, v49
    v_accvgpr_write_b32 a94, v50
    v_accvgpr_write_b32 a95, v51
    v_accvgpr_read_b32 v44, a108
    v_accvgpr_read_b32 v45, a109
    v_accvgpr_read_b32 v46, a110
    v_accvgpr_read_b32 v47, a111
    v_accvgpr_read_b32 v48, a124
    v_accvgpr_read_b32 v49, a125
    v_accvgpr_read_b32 v50, a126
    v_accvgpr_read_b32 v51, a127
    v_mul_f32 v44, v44, v39
    v_mul_f32 v45, v45, v39
    v_mul_f32 v46, v46, v39
    v_mul_f32 v47, v47, v39
    v_mul_f32 v48, v48, v39
    v_mul_f32 v49, v49, v39
    v_mul_f32 v50, v50, v39
    v_mul_f32 v51, v51, v39
    v_accvgpr_write_b32 a108, v44
    v_accvgpr_write_b32 a109, v45
    v_accvgpr_write_b32 a110, v46
    v_accvgpr_write_b32 a111, v47
    v_accvgpr_write_b32 a124, v48
    v_accvgpr_write_b32 a125, v49
    v_accvgpr_write_b32 a126, v50
    v_accvgpr_write_b32 a127, v51
    s_nop 3
    s_branch at_back3
at_done:
    s_endpgm

.globl gemm2_kernel
.p2align 8
.type gemm2_kernel,@function
gemm2_kernel:
    s_cmp_ge_u32 s2, 256
    s_cbranch_scc1 g2_done
    s_load_dwordx2 s[4:5], s[0:1], 88
    s_load_dwordx2 s[6:7], s[0:1], 32
    s_load_dwordx2 s[28:29], s[0:1], 64
    v_lshrrev_b32 v1, 6, v0
    v_and_b32 v2, 63, v0
    s_nop 0
    v_readfirstlane_b32 s32, v1
    s_and_b32 s42, s2, 7
    s_lshr_b32 s43, s2, 3
    s_lshr_b32 s50, s43, 4
    s_and_b32 s43, s43, 15
    s_lshr_b32 s33, s42, 1
    s_lshl_b32 s33, s33, 2
    s_lshr_b32 s44, s43, 2
    s_add_u32 s33, s33, s44
    s_and_b32 s34, s42, 1
    s_lshl_b32 s34, s34, 2
    s_and_b32 s44, s43, 3
    s_add_u32 s34, s34, s44
    s_lshr_b32 s51, s32, 1
    s_and_b32 s52, s32, 1
    s_cmp_eq_u32 s50, 0
    s_movk_i32 s42, 8192
    s_movk_i32 s43, 7168
    s_cselect_b32 s53, s42, s43
    s_cselect_b32 s54, 16, 14
    v_and_b32 v3, 15, v2
    v_lshrrev_b32 v84, 4, v2
    v_lshrrev_b32 v85, 2, v3
    v_and_b32 v86, 3, v3
    v_lshrrev_b32 v87, 1, v3
    v_lshlrev_b32 v88, 7, v3
    s_lshl_b32 s42, s51, 13
    v_add_u32 v88, s42, v88
    v_or_b32 v89, 0, v84
    v_xor_b32 v89, v89, v87
    v_lshl_add_u32 v68, v89, 4, v88
    v_or_b32 v89, 4, v84
    v_xor_b32 v89, v89, v87
    v_lshl_add_u32 v69, v89, 4, v88
    v_and_b32 v87, 1, v84
    v_lshl_or_b32 v87, v87, 2, v85
    s_lshl_b32 s42, s52, 2
    v_xor_b32 v87, s42, v87
    v_lshl_add_u32 v88, v84, 3, v85
    v_lshlrev_b32 v88, 8, v88
    v_lshl_add_u32 v88, v86, 3, v88
    v_add_u32 v88, 0x10000, v88
    v_xor_b32 v89, 0, v87
    v_lshl_add_u32 v70, v89, 5, v88
    v_xor_b32 v89, 1, v87
    v_lshl_add_u32 v71, v89, 5, v88
    v_xor_b32 v89, 2, v87
    v_lshl_add_u32 v72, v89, 5, v88
    v_xor_b32 v89, 3, v87
    v_lshl_add_u32 v73, v89, 5, v88
    v_lshrrev_b32 v87, 3, v2
    v_and_b32 v88, 7, v2
    v_add_u32 v89, 0, v87
    v_mul_lo_u32 v89, v89, s53
    v_or_b32 v74, 0, v84
    v_xor_b32 v74, v74, v88
    v_lshl_add_u32 v74, v74, 4, v89
    v_add_u32 v89, 8, v87
    v_mul_lo_u32 v89, v89, s53
    v_or_b32 v75, 4, v84
    v_xor_b32 v75, v75, v88
    v_lshl_add_u32 v75, v75, 4, v89
    v_subrev_u32 v75, 1024, v75
    v_add_u32 v89, 16, v87
    v_mul_lo_u32 v89, v89, s53
    v_or_b32 v76, 0, v84
    v_xor_b32 v76, v76, v88
    v_lshl_add_u32 v76, v76, 4, v89
    v_subrev_u32 v76, 2048, v76
    v_add_u32 v89, 24, v87
    v_mul_lo_u32 v89, v89, s53
    v_or_b32 v77, 4, v84
    v_xor_b32 v77, v77, v88
    v_lshl_add_u32 v77, v77, 4, v89
    v_subrev_u32 v77, 3072, v77
    s_lshl_b32 s42, s34, 8
    v_lshlrev_b32 v87, 11, v84
    v_add_u32 v87, s42, v87
    v_or_b32 v89, 0, v84
    v_lshlrev_b32 v89, 1, v89
    v_xor_b32 v89, v89, v3
    v_lshl_add_u32 v78, v89, 4, v87
    v_or_b32 v89, 0, v84
    v_lshlrev_b32 v89, 1, v89
    v_xor_b32 v89, v89, v3
    v_lshl_add_u32 v79, v89, 4, v87
    v_add_u32 v79, 7168, v79
    v_or_b32 v89, 4, v84
    v_lshlrev_b32 v89, 1, v89
    v_xor_b32 v89, v89, v3
    v_lshl_add_u32 v80, v89, 4, v87
    v_add_u32 v80, 14336, v80
    v_or_b32 v89, 4, v84
    v_lshlrev_b32 v89, 1, v89
    v_xor_b32 v89, v89, v3
    v_lshl_add_u32 v81, v89, 4, v87
    v_add_u32 v81, 21504, v81
    s_waitcnt lgkmcnt(0)
    s_add_u32 s8, s4, 0x4800000
    s_addc_u32 s9, s5, 0
    s_add_u32 s42, s4, 0x1400000
    s_addc_u32 s43, s5, 0
    s_add_u32 s20, s4, 0x3400000
    s_addc_u32 s21, s5, 0
    s_add_u32 s44, s4, 0x3800000
    s_addc_u32 s45, s5, 0
    s_cmp_eq_u32 s50, 0
    s_cselect_b32 s8, s8, s42
    s_cselect_b32 s9, s9, s43
    s_cselect_b32 s12, s6, s28
    s_cselect_b32 s13, s7, s29
    s_cselect_b32 s20, s20, s44
    s_cselect_b32 s21, s21, s45
    s_mov_b32 s42, 0x1000000
    s_mov_b32 s43, 0xe00000
    s_cselect_b32 s10, s42, s43
    s_mov_b32 s42, 0x800000
    s_mov_b32 s43, 0x700000
    s_cselect_b32 s14, s42, s43
    s_mov_b32 s11, 0x20000
    s_mov_b32 s15, 0x20000
    s_mov_b32 s22, 0x400000
    s_mov_b32 s23, 0x20000
    s_lshl_b32 s42, s33, 7
    s_lshl_b32 s43, s32, 5
    s_add_u32 s42, s42, s43
    s_mul_i32 s35, s42, s53
    s_lshl_b32 s36, s32, 15
    s_lshl_b32 s38, s32, 12
    s_add_u32 m0, s38, 0x0
    s_nop 0
    buffer_load_dwordx4 v74, s[8:11], s35 offen lds
    buffer_load_dwordx4 v75, s[8:11], s35 offen offset:1024 lds
    buffer_load_dwordx4 v76, s[8:11], s35 offen offset:2048 lds
    buffer_load_dwordx4 v77, s[8:11], s35 offen offset:3072 lds
    s_add_u32 m0, s38, 0x10000
    s_add_u32 s35, s35, 128
    buffer_load_dwordx4 v78, s[12:15], s36 offen lds
    buffer_load_dwordx4 v79, s[12:15], s36 offen offset:1024 lds
    buffer_load_dwordx4 v80, s[12:15], s36 offen offset:2048 lds
    buffer_load_dwordx4 v81, s[12:15], s36 offen offset:3072 lds
    s_add_u32 s36, s36, 0x20000
    s_add_u32 m0, s38, 0x4000
    s_nop 0
    buffer_load_dwordx4 v74, s[8:11], s35 offen lds
    buffer_load_dwordx4 v75, s[8:11], s35 offen offset:1024 lds
    buffer_load_dwordx4 v76, s[8:11], s35 offen offset:2048 lds
    buffer_load_dwordx4 v77, s[8:11], s35 offen offset:3072 lds
    s_add_u32 m0, s38, 0x14000
    s_add_u32 s35, s35, 128
    buffer_load_dwordx4 v78, s[12:15], s36 offen lds
    buffer_load_dwordx4 v79, s[12:15], s36 offen offset:1024 lds
    buffer_load_dwordx4 v80, s[12:15], s36 offen offset:2048 lds
    buffer_load_dwordx4 v81, s[12:15], s36 offen offset:3072 lds
    s_add_u32 s36, s36, 0x20000
    s_add_u32 m0, s38, 0x8000
    s_nop 0
    buffer_load_dwordx4 v74, s[8:11], s35 offen lds
    buffer_load_dwordx4 v75, s[8:11], s35 offen offset:1024 lds
    buffer_load_dwordx4 v76, s[8:11], s35 offen offset:2048 lds
    buffer_load_dwordx4 v77, s[8:11], s35 offen offset:3072 lds
    s_add_u32 m0, s38, 0x18000
    s_add_u32 s35, s35, 128
    buffer_load_dwordx4 v78, s[12:15], s36 offen lds
    buffer_load_dwordx4 v79, s[12:15], s36 offen offset:1024 lds
    buffer_load_dwordx4 v80, s[12:15], s36 offen offset:2048 lds
    buffer_load_dwordx4 v81, s[12:15], s36 offen offset:3072 lds
    s_add_u32 s36, s36, 0x20000
    v_accvgpr_write_b32 a0, 0
    v_accvgpr_write_b32 a1, 0
    v_accvgpr_write_b32 a2, 0
    v_accvgpr_write_b32 a3, 0
    v_accvgpr_write_b32 a4, 0
    v_accvgpr_write_b32 a5, 0
    v_accvgpr_write_b32 a6, 0
    v_accvgpr_write_b32 a7, 0
    v_accvgpr_write_b32 a8, 0
    v_accvgpr_write_b32 a9, 0
    v_accvgpr_write_b32 a10, 0
    v_accvgpr_write_b32 a11, 0
    v_accvgpr_write_b32 a12, 0
    v_accvgpr_write_b32 a13, 0
    v_accvgpr_write_b32 a14, 0
    v_accvgpr_write_b32 a15, 0
    v_accvgpr_write_b32 a16, 0
    v_accvgpr_write_b32 a17, 0
    v_accvgpr_write_b32 a18, 0
    v_accvgpr_write_b32 a19, 0
    v_accvgpr_write_b32 a20, 0
    v_accvgpr_write_b32 a21, 0
    v_accvgpr_write_b32 a22, 0
    v_accvgpr_write_b32 a23, 0
    v_accvgpr_write_b32 a24, 0
    v_accvgpr_write_b32 a25, 0
    v_accvgpr_write_b32 a26, 0
    v_accvgpr_write_b32 a27, 0
    v_accvgpr_write_b32 a28, 0
    v_accvgpr_write_b32 a29, 0
    v_accvgpr_write_b32 a30, 0
    v_accvgpr_write_b32 a31, 0
    v_accvgpr_write_b32 a32, 0
    v_accvgpr_write_b32 a33, 0
    v_accvgpr_write_b32 a34, 0
    v_accvgpr_write_b32 a35, 0
    v_accvgpr_write_b32 a36, 0
    v_accvgpr_write_b32 a37, 0
    v_accvgpr_write_b32 a38, 0
    v_accvgpr_write_b32 a39, 0
    v_accvgpr_write_b32 a40, 0
    v_accvgpr_write_b32 a41, 0
    v_accvgpr_write_b32 a42, 0
    v_accvgpr_write_b32 a43, 0
    v_accvgpr_write_b32 a44, 0
    v_accvgpr_write_b32 a45, 0
    v_accvgpr_write_b32 a46, 0
    v_accvgpr_write_b32 a47, 0
    v_accvgpr_write_b32 a48, 0
    v_accvgpr_write_b32 a49, 0
    v_accvgpr_write_b32 a50, 0
    v_accvgpr_write_b32 a51, 0
    v_accvgpr_write_b32 a52, 0
    v_accvgpr_write_b32 a53, 0
    v_accvgpr_write_b32 a54, 0
    v_accvgpr_write_b32 a55, 0
    v_accvgpr_write_b32 a56, 0
    v_accvgpr_write_b32 a57, 0
    v_accvgpr_write_b32 a58, 0
    v_accvgpr_write_b32 a59, 0
    v_accvgpr_write_b32 a60, 0
    v_accvgpr_write_b32 a61, 0
    v_accvgpr_write_b32 a62, 0
    v_accvgpr_write_b32 a63, 0
    s_waitcnt vmcnt(16) lgkmcnt(0)
    s_barrier
    ds_read_b64_tr_b16 v[36:37], v70 offset:0
    ds_read_b64_tr_b16 v[38:39], v70 offset:1024
    ds_read_b128 v[4:7], v68 offset:0
    s_add_u32 m0, s38, 0xc000
    s_nop 0
    buffer_load_dwordx4 v74, s[8:11], s35 offen lds
    ds_read_b64_tr_b16 v[40:41], v71 offset:0
    ds_read_b64_tr_b16 v[42:43], v71 offset:1024
    ds_read_b128 v[8:11], v68 offset:2048
    buffer_load_dwordx4 v75, s[8:11], s35 offen offset:1024 lds
    ds_read_b64_tr_b16 v[44:45], v72 offset:0
    ds_read_b64_tr_b16 v[46:47], v72 offset:1024
    ds_read_b128 v[12:15], v68 offset:4096
    buffer_load_dwordx4 v76, s[8:11], s35 offen offset:2048 lds
    ds_read_b64_tr_b16 v[48:49], v73 offset:0
    ds_read_b64_tr_b16 v[50:51], v73 offset:1024
    ds_read_b128 v[16:19], v68 offset:6144
    buffer_load_dwordx4 v77, s[8:11], s35 offen offset:3072 lds
    s_mov_b32 s41, 0
g2_loop:
    s_waitcnt lgkmcnt(10)
    s_waitcnt lgkmcnt(0)
    v_mfma_f32_16x16x32_bf16 a[0:3], v[36:39], v[4:7], a[0:3]
    ds_read_b64_tr_b16 v[52:53], v70 offset:8192
    ds_read_b64_tr_b16 v[54:55], v70 offset:9216
    ds_read_b128 v[20:23], v69 offset:0
    v_mfma_f32_16x16x32_bf16 a[4:7], v[36:39], v[8:11], a[4:7]
    v_mfma_f32_16x16x32_bf16 a[8:11], v[36:39], v[12:15], a[8:11]
    s_add_u32 m0, s38, 0x1c000
    s_add_u32 s35, s35, 128
    v_mfma_f32_16x16x32_bf16 a[12:15], v[36:39], v[16:19], a[12:15]
    buffer_load_dwordx4 v78, s[12:15], s36 offen lds
    v_mfma_f32_16x16x32_bf16 a[16:19], v[40:43], v[4:7], a[16:19]
    ds_read_b64_tr_b16 v[56:57], v71 offset:8192
    ds_read_b64_tr_b16 v[58:59], v71 offset:9216
    ds_read_b128 v[24:27], v69 offset:2048
    v_mfma_f32_16x16x32_bf16 a[20:23], v[40:43], v[8:11], a[20:23]
    v_mfma_f32_16x16x32_bf16 a[24:27], v[40:43], v[12:15], a[24:27]
    buffer_load_dwordx4 v79, s[12:15], s36 offen offset:1024 lds
    v_mfma_f32_16x16x32_bf16 a[28:31], v[40:43], v[16:19], a[28:31]
    v_mfma_f32_16x16x32_bf16 a[32:35], v[44:47], v[4:7], a[32:35]
    ds_read_b64_tr_b16 v[60:61], v72 offset:8192
    ds_read_b64_tr_b16 v[62:63], v72 offset:9216
    ds_read_b128 v[28:31], v69 offset:4096
    v_mfma_f32_16x16x32_bf16 a[36:39], v[44:47], v[8:11], a[36:39]
    v_mfma_f32_16x16x32_bf16 a[40:43], v[44:47], v[12:15], a[40:43]
    buffer_load_dwordx4 v80, s[12:15], s36 offen offset:2048 lds
    v_mfma_f32_16x16x32_bf16 a[44:47], v[44:47], v[16:19], a[44:47]
    v_mfma_f32_16x16x32_bf16 a[48:51], v[48:51], v[4:7], a[48:51]
    ds_read_b64_tr_b16 v[64:65], v73 offset:8192
    ds_read_b64_tr_b16 v[66:67], v73 offset:9216
    ds_read_b128 v[32:35], v69 offset:6144
    v_mfma_f32_16x16x32_bf16 a[52:55], v[48:51], v[8:11], a[52:55]
    v_mfma_f32_16x16x32_bf16 a[56:59], v[48:51], v[12:15], a[56:59]
    buffer_load_dwordx4 v81, s[12:15], s36 offen offset:3072 lds
    s_add_u32 s36, s36, 0x20000
    v_mfma_f32_16x16x32_bf16 a[60:63], v[48:51], v[16:19], a[60:63]
    s_waitcnt lgkmcnt(10)
    s_waitcnt lgkmcnt(0)
    v_mfma_f32_16x16x32_bf16 a[0:3], v[52:55], v[20:23], a[0:3]
    s_waitcnt vmcnt(16) lgkmcnt(0)
    s_barrier
    ds_read_b64_tr_b16 v[36:37], v70 offset:16384
    ds_read_b64_tr_b16 v[38:39], v70 offset:17408
    v_mfma_f32_16x16x32_bf16 a[4:7], v[52:55], v[24:27], a[4:7]
    ds_read_b128 v[4:7], v68 offset:16384
    v_mfma_f32_16x16x32_bf16 a[8:11], v[52:55], v[28:31], a[8:11]
    s_add_u32 m0, s38, 0x0
    s_nop 0
    v_mfma_f32_16x16x32_bf16 a[12:15], v[52:55], v[32:35], a[12:15]
    buffer_load_dwordx4 v74, s[8:11], s35 offen lds
    v_mfma_f32_16x16x32_bf16 a[16:19], v[56:59], v[20:23], a[16:19]
    ds_read_b64_tr_b16 v[40:41], v71 offset:16384
    ds_read_b64_tr_b16 v[42:43], v71 offset:17408
    ds_read_b128 v[8:11], v68 offset:18432
    v_mfma_f32_16x16x32_bf16 a[20:23], v[56:59], v[24:27], a[20:23]
    v_mfma_f32_16x16x32_bf16 a[24:27], v[56:59], v[28:31], a[24:27]
    buffer_load_dwordx4 v75, s[8:11], s35 offen offset:1024 lds
    v_mfma_f32_16x16x32_bf16 a[28:31], v[56:59], v[32:35], a[28:31]
    v_mfma_f32_16x16x32_bf16 a[32:35], v[60:63], v[20:23], a[32:35]
    ds_read_b64_tr_b16 v[44:45], v72 offset:16384
    ds_read_b64_tr_b16 v[46:47], v72 offset:17408
    ds_read_b128 v[12:15], v68 offset:20480
    v_mfma_f32_16x16x32_bf16 a[36:39], v[60:63], v[24:27], a[36:39]
    v_mfma_f32_16x16x32_bf16 a[40:43], v[60:63], v[28:31], a[40:43]
    buffer_load_dwordx4 v76, s[8:11], s35 offen offset:2048 lds
    v_mfma_f32_16x16x32_bf16 a[44:47], v[60:63], v[32:35], a[44:47]
    v_mfma_f32_16x16x32_bf16 a[48:51], v[64:67], v[20:23], a[48:51]
    ds_read_b64_tr_b16 v[48:49], v73 offset:16384
    ds_read_b64_tr_b16 v[50:51], v73 offset:17408
    ds_read_b128 v[16:19], v68 offset:22528
    v_mfma_f32_16x16x32_bf16 a[52:55], v[64:67], v[24:27], a[52:55]
    v_mfma_f32_16x16x32_bf16 a[56:59], v[64:67], v[28:31], a[56:59]
    buffer_load_dwordx4 v77, s[8:11], s35 offen offset:3072 lds
    v_mfma_f32_16x16x32_bf16 a[60:63], v[64:67], v[32:35], a[60:63]
    s_waitcnt lgkmcnt(10)
    s_waitcnt lgkmcnt(0)
    v_mfma_f32_16x16x32_bf16 a[0:3], v[36:39], v[4:7], a[0:3]
    ds_read_b64_tr_b16 v[52:53], v70 offset:24576
    ds_read_b64_tr_b16 v[54:55], v70 offset:25600
    ds_read_b128 v[20:23], v69 offset:16384
    v_mfma_f32_16x16x32_bf16 a[4:7], v[36:39], v[8:11], a[4:7]
    v_mfma_f32_16x16x32_bf16 a[8:11], v[36:39], v[12:15], a[8:11]
    s_add_u32 m0, s38, 0x10000
    s_add_u32 s35, s35, 128
    v_mfma_f32_16x16x32_bf16 a[12:15], v[36:39], v[16:19], a[12:15]
    buffer_load_dwordx4 v78, s[12:15], s36 offen lds
    v_mfma_f32_16x16x32_bf16 a[16:19], v[40:43], v[4:7], a[16:19]
    ds_read_b64_tr_b16 v[56:57], v71 offset:24576
    ds_read_b64_tr_b16 v[58:59], v71 offset:25600
    ds_read_b128 v[24:27], v69 offset:18432
    v_mfma_f32_16x16x32_bf16 a[20:23], v[40:43], v[8:11], a[20:23]
    v_mfma_f32_16x16x32_bf16 a[24:27], v[40:43], v[12:15], a[24:27]
    buffer_load_dwordx4 v79, s[12:15], s36 offen offset:1024 lds
    v_mfma_f32_16x16x32_bf16 a[28:31], v[40:43], v[16:19], a[28:31]
    v_mfma_f32_16x16x32_bf16 a[32:35], v[44:47], v[4:7], a[32:35]
    ds_read_b64_tr_b16 v[60:61], v72 offset:24576
    ds_read_b64_tr_b16 v[62:63], v72 offset:25600
    ds_read_b128 v[28:31], v69 offset:20480
    v_mfma_f32_16x16x32_bf16 a[36:39], v[44:47], v[8:11], a[36:39]
    v_mfma_f32_16x16x32_bf16 a[40:43], v[44:47], v[12:15], a[40:43]
    buffer_load_dwordx4 v80, s[12:15], s36 offen offset:2048 lds
    v_mfma_f32_16x16x32_bf16 a[44:47], v[44:47], v[16:19], a[44:47]
    v_mfma_f32_16x16x32_bf16 a[48:51], v[48:51], v[4:7], a[48:51]
    ds_read_b64_tr_b16 v[64:65], v73 offset:24576
    ds_read_b64_tr_b16 v[66:67], v73 offset:25600
    ds_read_b128 v[32:35], v69 offset:22528
    v_mfma_f32_16x16x32_bf16 a[52:55], v[48:51], v[8:11], a[52:55]
    v_mfma_f32_16x16x32_bf16 a[56:59], v[48:51], v[12:15], a[56:59]
    buffer_load_dwordx4 v81, s[12:15], s36 offen offset:3072 lds
    s_add_u32 s36, s36, 0x20000
    v_mfma_f32_16x16x32_bf16 a[60:63], v[48:51], v[16:19], a[60:63]
    s_waitcnt lgkmcnt(10)
    s_waitcnt lgkmcnt(0)
    v_mfma_f32_16x16x32_bf16 a[0:3], v[52:55], v[20:23], a[0:3]
    s_waitcnt vmcnt(16) lgkmcnt(0)
    s_barrier
    ds_read_b64_tr_b16 v[36:37], v70 offset:32768
    ds_read_b64_tr_b16 v[38:39], v70 offset:33792
    v_mfma_f32_16x16x32_bf16 a[4:7], v[52:55], v[24:27], a[4:7]
    ds_read_b128 v[4:7], v68 offset:32768
    v_mfma_f32_16x16x32_bf16 a[8:11], v[52:55], v[28:31], a[8:11]
    s_add_u32 m0, s38, 0x4000
    s_nop 0
    v_mfma_f32_16x16x32_bf16 a[12:15], v[52:55], v[32:35], a[12:15]
    buffer_load_dwordx4 v74, s[8:11], s35 offen lds
    v_mfma_f32_16x16x32_bf16 a[16:19], v[56:59], v[20:23], a[16:19]
    ds_read_b64_tr_b16 v[40:41], v71 offset:32768
    ds_read_b64_tr_b16 v[42:43], v71 offset:33792
    ds_read_b128 v[8:11], v68 offset:34816
    v_mfma_f32_16x16x32_bf16 a[20:23], v[56:59], v[24:27], a[20:23]
    v_mfma_f32_16x16x32_bf16 a[24:27], v[56:59], v[28:31], a[24:27]
    buffer_load_dwordx4 v75, s[8:11], s35 offen offset:1024 lds
    v_mfma_f32_16x16x32_bf16 a[28:31], v[56:59], v[32:35], a[28:31]
    v_mfma_f32_16x16x32_bf16 a[32:35], v[60:63], v[20:23], a[32:35]
    ds_read_b64_tr_b16 v[44:45], v72 offset:32768
    ds_read_b64_tr_b16 v[46:47], v72 offset:33792
    ds_read_b128 v[12:15], v68 offset:36864
    v_mfma_f32_16x16x32_bf16 a[36:39], v[60:63], v[24:27], a[36:39]
    v_mfma_f32_16x16x32_bf16 a[40:43], v[60:63], v[28:31], a[40:43]
    buffer_load_dwordx4 v76, s[8:11], s35 offen offset:2048 lds
    v_mfma_f32_16x16x32_bf16 a[44:47], v[60:63], v[32:35], a[44:47]
    v_mfma_f32_16x16x32_bf16 a[48:51], v[64:67], v[20:23], a[48:51]
    ds_read_b64_tr_b16 v[48:49], v73 offset:32768
    ds_read_b64_tr_b16 v[50:51], v73 offset:33792
    ds_read_b128 v[16:19], v68 offset:38912
    v_mfma_f32_16x16x32_bf16 a[52:55], v[64:67], v[24:27], a[52:55]
    v_mfma_f32_16x16x32_bf16 a[56:59], v[64:67], v[28:31], a[56:59]
    buffer_load_dwordx4 v77, s[8:11], s35 offen offset:3072 lds
    v_mfma_f32_16x16x32_bf16 a[60:63], v[64:67], v[32:35], a[60:63]
    s_waitcnt lgkmcnt(10)
    s_waitcnt lgkmcnt(0)
    v_mfma_f32_16x16x32_bf16 a[0:3], v[36:39], v[4:7], a[0:3]
    ds_read_b64_tr_b16 v[52:53], v70 offset:40960
    ds_read_b64_tr_b16 v[54:55], v70 offset:41984
    ds_read_b128 v[20:23], v69 offset:32768
    v_mfma_f32_16x16x32_bf16 a[4:7], v[36:39], v[8:11], a[4:7]
    v_mfma_f32_16x16x32_bf16 a[8:11], v[36:39], v[12:15], a[8:11]
    s_add_u32 m0, s38, 0x14000
    s_add_u32 s35, s35, 128
    v_mfma_f32_16x16x32_bf16 a[12:15], v[36:39], v[16:19], a[12:15]
    buffer_load_dwordx4 v78, s[12:15], s36 offen lds
    v_mfma_f32_16x16x32_bf16 a[16:19], v[40:43], v[4:7], a[16:19]
    ds_read_b64_tr_b16 v[56:57], v71 offset:40960
    ds_read_b64_tr_b16 v[58:59], v71 offset:41984
    ds_read_b128 v[24:27], v69 offset:34816
    v_mfma_f32_16x16x32_bf16 a[20:23], v[40:43], v[8:11], a[20:23]
    v_mfma_f32_16x16x32_bf16 a[24:27], v[40:43], v[12:15], a[24:27]
    buffer_load_dwordx4 v79, s[12:15], s36 offen offset:1024 lds
    v_mfma_f32_16x16x32_bf16 a[28:31], v[40:43], v[16:19], a[28:31]
    v_mfma_f32_16x16x32_bf16 a[32:35], v[44:47], v[4:7], a[32:35]
    ds_read_b64_tr_b16 v[60:61], v72 offset:40960
    ds_read_b64_tr_b16 v[62:63], v72 offset:41984
    ds_read_b128 v[28:31], v69 offset:36864
    v_mfma_f32_16x16x32_bf16 a[36:39], v[44:47], v[8:11], a[36:39]
    v_mfma_f32_16x16x32_bf16 a[40:43], v[44:47], v[12:15], a[40:43]
    buffer_load_dwordx4 v80, s[12:15], s36 offen offset:2048 lds
    v_mfma_f32_16x16x32_bf16 a[44:47], v[44:47], v[16:19], a[44:47]
    v_mfma_f32_16x16x32_bf16 a[48:51], v[48:51], v[4:7], a[48:51]
    ds_read_b64_tr_b16 v[64:65], v73 offset:40960
    ds_read_b64_tr_b16 v[66:67], v73 offset:41984
    ds_read_b128 v[32:35], v69 offset:38912
    v_mfma_f32_16x16x32_bf16 a[52:55], v[48:51], v[8:11], a[52:55]
    v_mfma_f32_16x16x32_bf16 a[56:59], v[48:51], v[12:15], a[56:59]
    buffer_load_dwordx4 v81, s[12:15], s36 offen offset:3072 lds
    s_add_u32 s36, s36, 0x20000
    v_mfma_f32_16x16x32_bf16 a[60:63], v[48:51], v[16:19], a[60:63]
    s_waitcnt lgkmcnt(10)
    s_waitcnt lgkmcnt(0)
    v_mfma_f32_16x16x32_bf16 a[0:3], v[52:55], v[20:23], a[0:3]
    s_waitcnt vmcnt(16) lgkmcnt(0)
    s_barrier
    ds_read_b64_tr_b16 v[36:37], v70 offset:49152
    ds_read_b64_tr_b16 v[38:39], v70 offset:50176
    v_mfma_f32_16x16x32_bf16 a[4:7], v[52:55], v[24:27], a[4:7]
    ds_read_b128 v[4:7], v68 offset:49152
    v_mfma_f32_16x16x32_bf16 a[8:11], v[52:55], v[28:31], a[8:11]
    s_add_u32 m0, s38, 0x8000
    s_nop 0
    v_mfma_f32_16x16x32_bf16 a[12:15], v[52:55], v[32:35], a[12:15]
    buffer_load_dwordx4 v74, s[8:11], s35 offen lds
    v_mfma_f32_16x16x32_bf16 a[16:19], v[56:59], v[20:23], a[16:19]
    ds_read_b64_tr_b16 v[40:41], v71 offset:49152
    ds_read_b64_tr_b16 v[42:43], v71 offset:50176
    ds_read_b128 v[8:11], v68 offset:51200
    v_mfma_f32_16x16x32_bf16 a[20:23], v[56:59], v[24:27], a[20:23]
    v_mfma_f32_16x16x32_bf16 a[24:27], v[56:59], v[28:31], a[24:27]
    buffer_load_dwordx4 v75, s[8:11], s35 offen offset:1024 lds
    v_mfma_f32_16x16x32_bf16 a[28:31], v[56:59], v[32:35], a[28:31]
    v_mfma_f32_16x16x32_bf16 a[32:35], v[60:63], v[20:23], a[32:35]
    ds_read_b64_tr_b16 v[44:45], v72 offset:49152
    ds_read_b64_tr_b16 v[46:47], v72 offset:50176
    ds_read_b128 v[12:15], v68 offset:53248
    v_mfma_f32_16x16x32_bf16 a[36:39], v[60:63], v[24:27], a[36:39]
    v_mfma_f32_16x16x32_bf16 a[40:43], v[60:63], v[28:31], a[40:43]
    buffer_load_dwordx4 v76, s[8:11], s35 offen offset:2048 lds
    v_mfma_f32_16x16x32_bf16 a[44:47], v[60:63], v[32:35], a[44:47]
    v_mfma_f32_16x16x32_bf16 a[48:51], v[64:67], v[20:23], a[48:51]
    ds_read_b64_tr_b16 v[48:49], v73 offset:49152
    ds_read_b64_tr_b16 v[50:51], v73 offset:50176
    ds_read_b128 v[16:19], v68 offset:55296
    v_mfma_f32_16x16x32_bf16 a[52:55], v[64:67], v[24:27], a[52:55]
    v_mfma_f32_16x16x32_bf16 a[56:59], v[64:67], v[28:31], a[56:59]
    buffer_load_dwordx4 v77, s[8:11], s35 offen offset:3072 lds
    v_mfma_f32_16x16x32_bf16 a[60:63], v[64:67], v[32:35], a[60:63]
    s_waitcnt lgkmcnt(10)
    s_waitcnt lgkmcnt(0)
    v_mfma_f32_16x16x32_bf16 a[0:3], v[36:39], v[4:7], a[0:3]
    ds_read_b64_tr_b16 v[52:53], v70 offset:57344
    ds_read_b64_tr_b16 v[54:55], v70 offset:58368
    ds_read_b128 v[20:23], v69 offset:49152
    v_mfma_f32_16x16x32_bf16 a[4:7], v[36:39], v[8:11], a[4:7]
    v_mfma_f32_16x16x32_bf16 a[8:11], v[36:39], v[12:15], a[8:11]
    s_add_u32 m0, s38, 0x18000
    s_add_u32 s35, s35, 128
    v_mfma_f32_16x16x32_bf16 a[12:15], v[36:39], v[16:19], a[12:15]
    buffer_load_dwordx4 v78, s[12:15], s36 offen lds
    v_mfma_f32_16x16x32_bf16 a[16:19], v[40:43], v[4:7], a[16:19]
    ds_read_b64_tr_b16 v[56:57], v71 offset:57344
    ds_read_b64_tr_b16 v[58:59], v71 offset:58368
    ds_read_b128 v[24:27], v69 offset:51200
    v_mfma_f32_16x16x32_bf16 a[20:23], v[40:43], v[8:11], a[20:23]
    v_mfma_f32_16x16x32_bf16 a[24:27], v[40:43], v[12:15], a[24:27]
    buffer_load_dwordx4 v79, s[12:15], s36 offen offset:1024 lds
    v_mfma_f32_16x16x32_bf16 a[28:31], v[40:43], v[16:19], a[28:31]
    v_mfma_f32_16x16x32_bf16 a[32:35], v[44:47], v[4:7], a[32:35]
    ds_read_b64_tr_b16 v[60:61], v72 offset:57344
    ds_read_b64_tr_b16 v[62:63], v72 offset:58368
    ds_read_b128 v[28:31], v69 offset:53248
    v_mfma_f32_16x16x32_bf16 a[36:39], v[44:47], v[8:11], a[36:39]
    v_mfma_f32_16x16x32_bf16 a[40:43], v[44:47], v[12:15], a[40:43]
    buffer_load_dwordx4 v80, s[12:15], s36 offen offset:2048 lds
    v_mfma_f32_16x16x32_bf16 a[44:47], v[44:47], v[16:19], a[44:47]
    v_mfma_f32_16x16x32_bf16 a[48:51], v[48:51], v[4:7], a[48:51]
    ds_read_b64_tr_b16 v[64:65], v73 offset:57344
    ds_read_b64_tr_b16 v[66:67], v73 offset:58368
    ds_read_b128 v[32:35], v69 offset:55296
    v_mfma_f32_16x16x32_bf16 a[52:55], v[48:51], v[8:11], a[52:55]
    v_mfma_f32_16x16x32_bf16 a[56:59], v[48:51], v[12:15], a[56:59]
    buffer_load_dwordx4 v81, s[12:15], s36 offen offset:3072 lds
    s_add_u32 s36, s36, 0x20000
    v_mfma_f32_16x16x32_bf16 a[60:63], v[48:51], v[16:19], a[60:63]
    s_waitcnt lgkmcnt(10)
    s_waitcnt lgkmcnt(0)
    v_mfma_f32_16x16x32_bf16 a[0:3], v[52:55], v[20:23], a[0:3]
    s_waitcnt vmcnt(16) lgkmcnt(0)
    s_barrier
    ds_read_b64_tr_b16 v[36:37], v70 offset:0
    ds_read_b64_tr_b16 v[38:39], v70 offset:1024
    v_mfma_f32_16x16x32_bf16 a[4:7], v[52:55], v[24:27], a[4:7]
    ds_read_b128 v[4:7], v68 offset:0
    v_mfma_f32_16x16x32_bf16 a[8:11], v[52:55], v[28:31], a[8:11]
    s_add_u32 m0, s38, 0xc000
    s_nop 0
    v_mfma_f32_16x16x32_bf16 a[12:15], v[52:55], v[32:35], a[12:15]
    buffer_load_dwordx4 v74, s[8:11], s35 offen lds
    v_mfma_f32_16x16x32_bf16 a[16:19], v[56:59], v[20:23], a[16:19]
    ds_read_b64_tr_b16 v[40:41], v71 offset:0
    ds_read_b64_tr_b16 v[42:43], v71 offset:1024
    ds_read_b128 v[8:11], v68 offset:2048
    v_mfma_f32_16x16x32_bf16 a[20:23], v[56:59], v[24:27], a[20:23]
    v_mfma_f32_16x16x32_bf16 a[24:27], v[56:59], v[28:31], a[24:27]
    buffer_load_dwordx4 v75, s[8:11], s35 offen offset:1024 lds
    v_mfma_f32_16x16x32_bf16 a[28:31], v[56:59], v[32:35], a[28:31]
    v_mfma_f32_16x16x32_bf16 a[32:35], v[60:63], v[20:23], a[32:35]
    ds_read_b64_tr_b16 v[44:45], v72 offset:0
    ds_read_b64_tr_b16 v[46:47], v72 offset:1024
    ds_read_b128 v[12:15], v68 offset:4096
    v_mfma_f32_16x16x32_bf16 a[36:39], v[60:63], v[24:27], a[36:39]
    v_mfma_f32_16x16x32_bf16 a[40:43], v[60:63], v[28:31], a[40:43]
    buffer_load_dwordx4 v76, s[8:11], s35 offen offset:2048 lds
    v_mfma_f32_16x16x32_bf16 a[44:47], v[60:63], v[32:35], a[44:47]
    v_mfma_f32_16x16x32_bf16 a[48:51], v[64:67], v[20:23], a[48:51]
    ds_read_b64_tr_b16 v[48:49], v73 offset:0
    ds_read_b64_tr_b16 v[50:51], v73 offset:1024
    ds_read_b128 v[16:19], v68 offset:6144
    v_mfma_f32_16x16x32_bf16 a[52:55], v[64:67], v[24:27], a[52:55]
    v_mfma_f32_16x16x32_bf16 a[56:59], v[64:67], v[28:31], a[56:59]
    buffer_load_dwordx4 v77, s[8:11], s35 offen offset:3072 lds
    v_mfma_f32_16x16x32_bf16 a[60:63], v[64:67], v[32:35], a[60:63]
    s_add_u32 s41, s41, 1
    s_cmp_lt_u32 s41, s54
    s_cbranch_scc1 g2_loop
    s_waitcnt vmcnt(0) lgkmcnt(0)
    s_nop 7
    s_nop 7
    v_and_b32 v87, 1, v84
    v_lshrrev_b32 v88, 1, v84
    v_lshlrev_b32 v87, 5, v87
    v_lshl_add_u32 v87, v88, 4, v87
    v_lshl_add_u32 v64, v3, 11, v87
    s_lshl_b32 s42, s33, 7
    s_lshl_b32 s43, s51, 6
    s_add_u32 s42, s42, s43
    s_lshl_b32 s47, s42, 11
    s_lshl_b32 s42, s34, 8
    s_add_u32 s47, s47, s42
    s_lshl_b32 s42, s52, 7
    s_add_u32 s47, s47, s42
    v_accvgpr_read_b32 v4, a0
    v_accvgpr_read_b32 v5, a1
    v_accvgpr_read_b32 v6, a2
    v_accvgpr_read_b32 v7, a3
    v_accvgpr_read_b32 v8, a16
    v_accvgpr_read_b32 v9, a17
    v_accvgpr_read_b32 v10, a18
    v_accvgpr_read_b32 v11, a19
    v_cvt_pk_bf16_f32 v12, v4, v5
    v_cvt_pk_bf16_f32 v13, v6, v7
    v_cvt_pk_bf16_f32 v14, v8, v9
    v_cvt_pk_bf16_f32 v15, v10, v11
    s_nop 1
    v_permlane16_swap_b32 v12, v14
    v_permlane16_swap_b32 v13, v15
    buffer_store_dwordx4 v[12:15], v64, s[20:23], s47 offen offset:0
    v_accvgpr_read_b32 v16, a32
    v_accvgpr_read_b32 v17, a33
    v_accvgpr_read_b32 v18, a34
    v_accvgpr_read_b32 v19, a35
    v_accvgpr_read_b32 v20, a48
    v_accvgpr_read_b32 v21, a49
    v_accvgpr_read_b32 v22, a50
    v_accvgpr_read_b32 v23, a51
    v_cvt_pk_bf16_f32 v24, v16, v17
    v_cvt_pk_bf16_f32 v25, v18, v19
    v_cvt_pk_bf16_f32 v26, v20, v21
    v_cvt_pk_bf16_f32 v27, v22, v23
    s_nop 1
    v_permlane16_swap_b32 v24, v26
    v_permlane16_swap_b32 v25, v27
    buffer_store_dwordx4 v[24:27], v64, s[20:23], s47 offen offset:64
    s_add_u32 s47, s47, 0x8000
    v_accvgpr_read_b32 v28, a4
    v_accvgpr_read_b32 v29, a5
    v_accvgpr_read_b32 v30, a6
    v_accvgpr_read_b32 v31, a7
    v_accvgpr_read_b32 v32, a20
    v_accvgpr_read_b32 v33, a21
    v_accvgpr_read_b32 v34, a22
    v_accvgpr_read_b32 v35, a23
    v_cvt_pk_bf16_f32 v36, v28, v29
    v_cvt_pk_bf16_f32 v37, v30, v31
    v_cvt_pk_bf16_f32 v38, v32, v33
    v_cvt_pk_bf16_f32 v39, v34, v35
    s_nop 1
    v_permlane16_swap_b32 v36, v38
    v_permlane16_swap_b32 v37, v39
    buffer_store_dwordx4 v[36:39], v64, s[20:23], s47 offen offset:0
    v_accvgpr_read_b32 v40, a36
    v_accvgpr_read_b32 v41, a37
    v_accvgpr_read_b32 v42, a38
    v_accvgpr_read_b32 v43, a39
    v_accvgpr_read_b32 v44, a52
    v_accvgpr_read_b32 v45, a53
    v_accvgpr_read_b32 v46, a54
    v_accvgpr_read_b32 v47, a55
    v_cvt_pk_bf16_f32 v48, v40, v41
    v_cvt_pk_bf16_f32 v49, v42, v43
    v_cvt_pk_bf16_f32 v50, v44, v45
    v_cvt_pk_bf16_f32 v51, v46, v47
    s_nop 1
    v_permlane16_swap_b32 v48, v50
    v_permlane16_swap_b32 v49, v51
    buffer_store_dwordx4 v[48:51], v64, s[20:23], s47 offen offset:64
    s_add_u32 s47, s47, 0x8000
    v_accvgpr_read_b32 v4, a8
    v_accvgpr_read_b32 v5, a9
    v_accvgpr_read_b32 v6, a10
    v_accvgpr_read_b32 v7, a11
    v_accvgpr_read_b32 v8, a24
    v_accvgpr_read_b32 v9, a25
    v_accvgpr_read_b32 v10, a26
    v_accvgpr_read_b32 v11, a27
    v_cvt_pk_bf16_f32 v12, v4, v5
    v_cvt_pk_bf16_f32 v13, v6, v7
    v_cvt_pk_bf16_f32 v14, v8, v9
    v_cvt_pk_bf16_f32 v15, v10, v11
    s_nop 1
    v_permlane16_swap_b32 v12, v14
    v_permlane16_swap_b32 v13, v15
    buffer_store_dwordx4 v[12:15], v64, s[20:23], s47 offen offset:0
    v_accvgpr_read_b32 v16, a40
    v_accvgpr_read_b32 v17, a41
    v_accvgpr_read_b32 v18, a42
    v_accvgpr_read_b32 v19, a43
    v_accvgpr_read_b32 v20, a56
    v_accvgpr_read_b32 v21, a57
    v_accvgpr_read_b32 v22, a58
    v_accvgpr_read_b32 v23, a59
    v_cvt_pk_bf16_f32 v24, v16, v17
    v_cvt_pk_bf16_f32 v25, v18, v19
    v_cvt_pk_bf16_f32 v26, v20, v21
    v_cvt_pk_bf16_f32 v27, v22, v23
    s_nop 1
    v_permlane16_swap_b32 v24, v26
    v_permlane16_swap_b32 v25, v27
    buffer_store_dwordx4 v[24:27], v64, s[20:23], s47 offen offset:64
    s_add_u32 s47, s47, 0x8000
    v_accvgpr_read_b32 v28, a12
    v_accvgpr_read_b32 v29, a13
    v_accvgpr_read_b32 v30, a14
    v_accvgpr_read_b32 v31, a15
    v_accvgpr_read_b32 v32, a28
    v_accvgpr_read_b32 v33, a29
    v_accvgpr_read_b32 v34, a30
    v_accvgpr_read_b32 v35, a31
    v_cvt_pk_bf16_f32 v36, v28, v29
    v_cvt_pk_bf16_f32 v37, v30, v31
    v_cvt_pk_bf16_f32 v38, v32, v33
    v_cvt_pk_bf16_f32 v39, v34, v35
    s_nop 1
    v_permlane16_swap_b32 v36, v38
    v_permlane16_swap_b32 v37, v39
    buffer_store_dwordx4 v[36:39], v64, s[20:23], s47 offen offset:0
    v_accvgpr_read_b32 v40, a44
    v_accvgpr_read_b32 v41, a45
    v_accvgpr_read_b32 v42, a46
    v_accvgpr_read_b32 v43, a47
    v_accvgpr_read_b32 v44, a60
    v_accvgpr_read_b32 v45, a61
    v_accvgpr_read_b32 v46, a62
    v_accvgpr_read_b32 v47, a63
    v_cvt_pk_bf16_f32 v48, v40, v41
    v_cvt_pk_bf16_f32 v49, v42, v43
    v_cvt_pk_bf16_f32 v50, v44, v45
    v_cvt_pk_bf16_f32 v51, v46, v47
    s_nop 1
    v_permlane16_swap_b32 v48, v50
    v_permlane16_swap_b32 v49, v51
    buffer_store_dwordx4 v[48:51], v64, s[20:23], s47 offen offset:64
g2_done:
    s_endpgm

.globl final_kernel
.p2align 8
.type final_kernel,@function
final_kernel:
    s_cmp_ge_u32 s2, 1024
    s_cbranch_scc1 fn_done
    s_load_dwordx2 s[4:5], s[0:1], 0
    s_load_dwordx2 s[6:7], s[0:1], 88
    s_load_dwordx2 s[24:25], s[0:1], 72
    s_lshl_b32 s3, s2, 12
    v_lshl_add_u32 v1, v0, 4, s3
    s_waitcnt lgkmcnt(0)
    s_mov_b32 s8, s4
    s_mov_b32 s9, s5
    s_mov_b32 s10, 0x400000
    s_mov_b32 s11, 0x20000
    s_add_u32 s12, s6, 0x3400000
    s_addc_u32 s13, s7, 0
    s_mov_b32 s14, 0x400000
    s_mov_b32 s15, 0x20000
    s_add_u32 s16, s6, 0x3800000
    s_addc_u32 s17, s7, 0
    s_mov_b32 s18, 0x400000
    s_mov_b32 s19, 0x20000
    s_mov_b32 s20, s24
    s_mov_b32 s21, s25
    s_mov_b32 s22, 0x400000
    s_mov_b32 s23, 0x20000
    buffer_load_dwordx4 v[4:7], v1, s[16:19], 0 offen
    buffer_load_dwordx4 v[8:11], v1, s[12:15], 0 offen
    buffer_load_dwordx4 v[12:15], v1, s[8:11], 0 offen
    s_mov_b32 s26, 0xffff0000
    s_mov_b32 s27, 0xbfb8aa3b
    s_waitcnt vmcnt(2)
    v_lshlrev_b32 v16, 16, v4
    v_and_b32 v17, s26, v4
    v_lshlrev_b32 v18, 16, v5
    v_and_b32 v19, s26, v5
    v_lshlrev_b32 v20, 16, v6
    v_and_b32 v21, s26, v6
    v_lshlrev_b32 v22, 16, v7
    v_and_b32 v23, s26, v7
    v_mul_f32 v24, s27, v16
    v_mul_f32 v25, s27, v17
    v_mul_f32 v26, s27, v18
    v_mul_f32 v27, s27, v19
    v_mul_f32 v28, s27, v20
    v_mul_f32 v29, s27, v21
    v_mul_f32 v30, s27, v22
    v_mul_f32 v31, s27, v23
    v_exp_f32 v24, v24
    v_exp_f32 v25, v25
    v_exp_f32 v26, v26
    v_exp_f32 v27, v27
    v_exp_f32 v28, v28
    v_exp_f32 v29, v29
    v_exp_f32 v30, v30
    v_exp_f32 v31, v31
    v_add_f32 v24, 1.0, v24
    v_add_f32 v25, 1.0, v25
    v_add_f32 v26, 1.0, v26
    v_add_f32 v27, 1.0, v27
    v_add_f32 v28, 1.0, v28
    v_add_f32 v29, 1.0, v29
    v_add_f32 v30, 1.0, v30
    v_add_f32 v31, 1.0, v31
    v_rcp_f32 v24, v24
    v_rcp_f32 v25, v25
    v_rcp_f32 v26, v26
    v_rcp_f32 v27, v27
    v_rcp_f32 v28, v28
    v_rcp_f32 v29, v29
    v_rcp_f32 v30, v30
    v_rcp_f32 v31, v31
    s_nop 0
    v_mul_f32 v16, v16, v24
    v_mul_f32 v17, v17, v25
    v_mul_f32 v18, v18, v26
    v_mul_f32 v19, v19, v27
    v_mul_f32 v20, v20, v28
    v_mul_f32 v21, v21, v29
    v_mul_f32 v22, v22, v30
    v_mul_f32 v23, v23, v31
    v_cvt_pk_bf16_f32 v4, v16, v17
    v_cvt_pk_bf16_f32 v5, v18, v19
    v_cvt_pk_bf16_f32 v6, v20, v21
    v_cvt_pk_bf16_f32 v7, v22, v23
    v_lshlrev_b32 v16, 16, v4
    v_and_b32 v17, s26, v4
    v_lshlrev_b32 v18, 16, v5
    v_and_b32 v19, s26, v5
    v_lshlrev_b32 v20, 16, v6
    v_and_b32 v21, s26, v6
    v_lshlrev_b32 v22, 16, v7
    v_and_b32 v23, s26, v7
    s_waitcnt vmcnt(1)
    v_lshlrev_b32 v24, 16, v8
    v_and_b32 v25, s26, v8
    v_lshlrev_b32 v26, 16, v9
    v_and_b32 v27, s26, v9
    v_lshlrev_b32 v28, 16, v10
    v_and_b32 v29, s26, v10
    v_lshlrev_b32 v30, 16, v11
    v_and_b32 v31, s26, v11
    v_mul_f32 v16, v16, v24
    v_mul_f32 v17, v17, v25
    v_mul_f32 v18, v18, v26
    v_mul_f32 v19, v19, v27
    v_mul_f32 v20, v20, v28
    v_mul_f32 v21, v21, v29
    v_mul_f32 v22, v22, v30
    v_mul_f32 v23, v23, v31
    v_cvt_pk_bf16_f32 v4, v16, v17
    v_cvt_pk_bf16_f32 v5, v18, v19
    v_cvt_pk_bf16_f32 v6, v20, v21
    v_cvt_pk_bf16_f32 v7, v22, v23
    v_lshlrev_b32 v16, 16, v4
    v_and_b32 v17, s26, v4
    v_lshlrev_b32 v18, 16, v5
    v_and_b32 v19, s26, v5
    v_lshlrev_b32 v20, 16, v6
    v_and_b32 v21, s26, v6
    v_lshlrev_b32 v22, 16, v7
    v_and_b32 v23, s26, v7
    s_waitcnt vmcnt(0)
    v_lshlrev_b32 v24, 16, v12
    v_and_b32 v25, s26, v12
    v_lshlrev_b32 v26, 16, v13
    v_and_b32 v27, s26, v13
    v_lshlrev_b32 v28, 16, v14
    v_and_b32 v29, s26, v14
    v_lshlrev_b32 v30, 16, v15
    v_and_b32 v31, s26, v15
    v_add_f32 v16, v16, v24
    v_add_f32 v17, v17, v25
    v_add_f32 v18, v18, v26
    v_add_f32 v19, v19, v27
    v_add_f32 v20, v20, v28
    v_add_f32 v21, v21, v29
    v_add_f32 v22, v22, v30
    v_add_f32 v23, v23, v31
    v_cvt_pk_bf16_f32 v4, v16, v17
    v_cvt_pk_bf16_f32 v5, v18, v19
    v_cvt_pk_bf16_f32 v6, v20, v21
    v_cvt_pk_bf16_f32 v7, v22, v23
    buffer_store_dwordx4 v[4:7], v1, s[20:23], 0 offen
fn_done:
    s_endpgm

.section .rodata,"a"
.p2align 6
.amdhsa_kernel ln_kernel
  .amdhsa_next_free_vgpr 80
  .amdhsa_next_free_sgpr 48
  .amdhsa_accum_offset 80
  .amdhsa_group_segment_fixed_size 0
  .amdhsa_kernarg_size 96
  .amdhsa_user_sgpr_count 2
  .amdhsa_user_sgpr_kernarg_segment_ptr 1
  .amdhsa_system_sgpr_workgroup_id_x 1
.end_amdhsa_kernel

.p2align 6
.amdhsa_kernel fused_kernel
  .amdhsa_next_free_vgpr 512
  .amdhsa_next_free_sgpr 92
  .amdhsa_accum_offset 256
  .amdhsa_group_segment_fixed_size 0
  .amdhsa_kernarg_size 96
  .amdhsa_user_sgpr_count 2
  .amdhsa_user_sgpr_kernarg_segment_ptr 1
  .amdhsa_system_sgpr_workgroup_id_x 1
.end_amdhsa_kernel

.p2align 6
.amdhsa_kernel gemm2_kernel
  .amdhsa_next_free_vgpr 160
  .amdhsa_next_free_sgpr 64
  .amdhsa_accum_offset 96
  .amdhsa_group_segment_fixed_size 0
  .amdhsa_kernarg_size 96
  .amdhsa_user_sgpr_count 2
  .amdhsa_user_sgpr_kernarg_segment_ptr 1
  .amdhsa_system_sgpr_workgroup_id_x 1
.end_amdhsa_kernel

.p2align 6
.amdhsa_kernel final_kernel
  .amdhsa_next_free_vgpr 32
  .amdhsa_next_free_sgpr 40
  .amdhsa_accum_offset 32
  .amdhsa_group_segment_fixed_size 0
  .amdhsa_kernarg_size 96
  .amdhsa_user_sgpr_count 2
  .amdhsa_user_sgpr_kernarg_segment_ptr 1
  .amdhsa_system_sgpr_workgroup_id_x 1
.end_amdhsa_kernel
```
